```python
import torch

def _softmax(x, axis=-1):
    return torch.softmax(x, dim=axis)

def _gelu(x):
    return torch.nn.functional.gelu(x, approximate='tanh')

def _silu(x):
    return torch.nn.functional.silu(x)

def _sigmoid(x):
    return torch.sigmoid(x)

def _layernorm(x, axis=-1, eps=1e-05):
    m = x.mean(dim=axis, keepdim=True)
    v = x.var(dim=axis, keepdim=True, unbiased=False)
    return (x - m) / torch.sqrt(v + eps)

def _scatter_add(tgt, idx, src, axis=0):
    return tgt.clone().index_add_(axis, idx, src)

def _segment_sum(src, seg, n):
    out = torch.zeros((n,) + src.shape[1:], dtype=src.dtype)
    return out.index_add_(0, seg, src)

def _pad(x, pw):
    flat = tuple((v for pair in reversed(pw) for v in pair))
    return torch.nn.functional.pad(x, flat)
kernel_name = 'adaLN_cond__ssm_conv_h3__glu_gated_reglu__prompt'

def setup_inputs():

    _w = lambda a: (lambda t: t.to(torch.bfloat16) if t.is_floating_point() else t)(torch.as_tensor(a))

    def _A_setup():
        B, S, D = (1, 2048, 512)
        ks = 4
        return {'q': _w((lambda *s: torch.randn(*s, dtype=torch.bfloat16) * 0.05)(B, S, D)), 'k': _w((lambda *s: torch.randn(*s, dtype=torch.bfloat16) * 0.8)(B, S, D)), 'v': _w((lambda *s: torch.randn(*s, dtype=torch.bfloat16) * 0.8)(B, S, D)), 'shift_k': _w((lambda *s: torch.randn(*s, dtype=torch.bfloat16) * 0.8)(D, ks) * 0.5), 'ssm_k': _w((lambda *s: torch.randn(*s, dtype=torch.bfloat16) * 0.8)(D, S) * (1.0 / S ** 0.5)), 'ssm_D': _w((lambda *s: torch.randn(*s, dtype=torch.bfloat16) * 0.8)(D))}
    _A_in = _A_setup()

    def _B_setup():
        B, S, D, F = (1, 2048, 512, 1792)
        return {'x': _w((lambda *s: torch.randn(*s, dtype=torch.bfloat16) * 0.05)(B, S, D)), 'W_gate': _w((lambda *s: torch.randn(*s, dtype=torch.bfloat16) * 0.8)(D, F) * (2.0 / D) ** 0.5), 'W_up': _w((lambda *s: torch.randn(*s, dtype=torch.bfloat16) * 0.8)(D, F) * (2.0 / D) ** 0.5), 'W_down': _w((lambda *s: torch.randn(*s, dtype=torch.bfloat16) * 0.8)(F, D) * (1.0 / F) ** 0.5)}
    _B_in = _B_setup()
    return {'A_q': _A_in['q'], 'A_k': _A_in['k'], 'A_v': _A_in['v'], 'A_shift_k': _A_in['shift_k'], 'A_ssm_k': _A_in['ssm_k'], 'A_ssm_D': _A_in['ssm_D'], 'B_x': _B_in['x'], 'B_W_gate': _B_in['W_gate'], 'B_W_up': _B_in['W_up'], 'B_W_down': _B_in['W_down'], 'c': _w((lambda *s: torch.randn(*s, dtype=torch.bfloat16) * 0.2)(1, 512) * 8.0), 'w_mod': _w((lambda *s: torch.randn(*s, dtype=torch.bfloat16) * 0.2)(512, 6 * 512) * 512 ** (-0.5) * 8.0)}

def reference(A_q, A_k, A_v, A_shift_k, A_ssm_k, A_ssm_D, B_x, B_W_gate, B_W_up, B_W_down, c, w_mod):

    def _A_ref(q, k, v, shift_k, ssm_k, ssm_D):
        B, S, D = q.shape
        ks = shift_k.shape[-1]
        k_pad = _pad(k, ((0, 0), (ks - 1, 0), (0, 0)))
        k_shift = torch.zeros_like(k)
        for t in range(ks):
            k_shift = k_shift + k_pad[:, t:t + S, :] * shift_k[:, ks - 1 - t][None, None, :]
        kv = k_shift * v
        L = 2 * S
        kv_pad = _pad(kv, ((0, 0), (0, S), (0, 0)))
        kf_pad = _pad(ssm_k, ((0, 0), (0, S)))
        kv_f = (lambda x, axes=(-2, -1): torch.fft.rfft2(x.float(), dim=axes))(kv_pad[:, None, :, :], axes=(1, 2))
        kf_f = (lambda x, axes=(-2, -1): torch.fft.rfft2(x.float(), dim=axes))(kf_pad[:, None, :], axes=(1, 2))
        kf_f = (lambda x, *d: x.permute(*d))(kf_f, 1, 2, 0)
        y_f = kv_f * kf_f[None, :, :, :]
        y = (lambda x, s, axes=(-2, -1): torch.fft.irfft2(x, s=s, dim=axes).to(torch.bfloat16))(y_f, (1, L), axes=(1, 2))[:, 0, :S, :]
        y = y + kv * ssm_D[None, None, :]
        return q * y

    def _B_ref(x, W_gate, W_up, W_down):
        gate = torch.einsum('bsd,df->bsf', x, W_gate)
        up = torch.einsum('bsd,df->bsf', x, W_up)
        gate = gate * (lambda x, dt: x.to(dt))(gate > 0, gate.dtype)
        h = gate * up
        return torch.einsum('bsf,fd->bsd', h, W_down)
    x = A_q
    mod = (_silu(c) @ w_mod).reshape(c.shape[0], 6, 1, -1)
    sa, ca, ga, sb, cb, gb = (mod[:, 0].clone(), mod[:, 1].clone(), mod[:, 2].clone(), mod[:, 3].clone(), mod[:, 4].clone(), mod[:, 5].clone())
    h = _layernorm(x, axis=-1) * (1 + ca) + sa
    x = x + ga * _A_ref(h, A_k, A_v, A_shift_k, A_ssm_k, A_ssm_D)
    h = _layernorm(x, axis=-1) * (1 + cb) + sb
    x = x + gb * _B_ref(h, B_W_gate, B_W_up, B_W_down)
    return x
```

```asm
; @launch kernel=k0_prep_kernel grid=(872,1,1) block=(256,1,1) lds=2048
; @launch kernel=k1_main_kernel grid=(256,1,1) block=(512,1,1) lds=163840
.amdgcn_target "amdgcn-amd-amdhsa--gfx950"
.text
.globl k0_prep_kernel
.p2align 12
.p2align 8
.type k0_prep_kernel,@function
k0_prep_kernel:
    s_cmp_ge_u32 s2, 360
K0PG0:
    s_cbranch_execz K0RET
    s_cbranch_scc1 K0_TWG
    s_cmp_ge_u32 s2, 352
    s_cbranch_scc1 K0_WD
    s_cmp_ge_u32 s2, 256
    s_cbranch_scc1 K0_MOD
    s_load_dwordx4 s[4:7], s[0:1], 0
    s_load_dwordx4 s[8:11], s[0:1], 16
    s_load_dwordx2 s[12:13], s[0:1], 112
    s_load_dwordx2 s[52:53], s[0:1], 32
    s_load_dwordx4 s[56:59], s[0:1], 56
    s_load_dwordx2 s[54:55], s[0:1], 72
    s_and_b32 s14, s2, 7
    s_lshl_b32 s14, s14, 2
    s_lshr_b32 s15, s2, 6
    s_add_u32 s14, s14, s15
    s_bfe_u32 s15, s2, 0x30003
    v_and_b32 v1, 31, v0
    v_lshrrev_b32 v2, 5, v0
    s_lshl_b32 s16, s14, 6
    v_lshlrev_b32 v3, 3, v2
    v_add_u32 v3, s16, v3
    s_lshl_b32 s17, s15, 7
    v_lshlrev_b32 v4, 2, v1
    v_add_u32 v4, s17, v4
    v_lshl_add_u32 v5, v3, 10, v4
    v_subrev_u32 v6, 3072, v5
    v_subrev_u32 v7, 2048, v5
    v_subrev_u32 v8, 1024, v5
    v_add_u32 v9, 4096, v5
    v_lshlrev_b32 v44, 2, v4
    v_lshrrev_b32 v45, 6, v0
    v_and_b32 v46, 63, v0
    s_lshl_b32 s18, s15, 3
    s_add_u32 s18, s18, s16
    v_lshlrev_b32 v47, 1, v45
    v_add_u32 v47, s18, v47
    v_lshlrev_b32 v48, 4, v46
    v_lshl_add_u32 v48, v47, 10, v48
    s_waitcnt lgkmcnt(0)
    s_mov_b32 s20, s4
    s_and_b32 s21, s5, 0xffff
    s_mov_b32 s22, 2097152
    s_mov_b32 s23, 0x00020000
    s_mov_b32 s24, s6
    s_and_b32 s25, s7, 0xffff
    s_mov_b32 s26, 2097152
    s_mov_b32 s27, 0x00020000
    s_mov_b32 s28, s8
    s_and_b32 s29, s9, 0xffff
    s_mov_b32 s30, 2097152
    s_mov_b32 s31, 0x00020000
    s_mov_b32 s32, s10
    s_and_b32 s33, s11, 0xffff
    s_mov_b32 s34, 4096
    s_mov_b32 s35, 0x00020000
    s_mov_b32 s36, s12
    s_and_b32 s37, s13, 0xffff
    s_mov_b32 s38, 268435456
    s_mov_b32 s39, 0x00020000
    buffer_load_dwordx4 v[40:43], v44, s[32:35], 0 offen
    buffer_load_dword v10, v6, s[24:27], 0 offen
    buffer_load_dword v11, v7, s[24:27], 0 offen
    buffer_load_dword v12, v8, s[24:27], 0 offen
    buffer_load_dword v13, v5, s[24:27], 0 offen offset:0
    buffer_load_dword v14, v5, s[24:27], 0 offen offset:1024
    buffer_load_dword v15, v5, s[24:27], 0 offen offset:2048
    buffer_load_dword v16, v5, s[24:27], 0 offen offset:3072
    buffer_load_dword v17, v9, s[24:27], 0 offen offset:0
    buffer_load_dword v18, v9, s[24:27], 0 offen offset:1024
    buffer_load_dword v19, v9, s[24:27], 0 offen offset:2048
    buffer_load_dword v20, v9, s[24:27], 0 offen offset:3072
    buffer_load_dword v21, v5, s[28:31], 0 offen offset:0
    buffer_load_dword v22, v5, s[28:31], 0 offen offset:1024
    buffer_load_dword v23, v5, s[28:31], 0 offen offset:2048
    buffer_load_dword v24, v5, s[28:31], 0 offen offset:3072
    buffer_load_dword v25, v9, s[28:31], 0 offen offset:0
    buffer_load_dword v26, v9, s[28:31], 0 offen offset:1024
    buffer_load_dword v27, v9, s[28:31], 0 offen offset:2048
    buffer_load_dword v28, v9, s[28:31], 0 offen offset:3072
    buffer_load_dword v29, v5, s[20:23], 0 offen offset:0
    buffer_load_dword v30, v5, s[20:23], 0 offen offset:1024
    buffer_load_dword v31, v5, s[20:23], 0 offen offset:2048
    buffer_load_dword v32, v5, s[20:23], 0 offen offset:3072
    buffer_load_dword v33, v9, s[20:23], 0 offen offset:0
    buffer_load_dword v34, v9, s[20:23], 0 offen offset:1024
    buffer_load_dword v35, v9, s[20:23], 0 offen offset:2048
    buffer_load_dword v36, v9, s[20:23], 0 offen offset:3072
    buffer_load_dwordx4 v[52:55], v48, s[20:23], 0 offen
    buffer_load_dwordx4 v[56:59], v48, s[20:23], 0 offen offset:1024
    v_lshlrev_b32 v49, 11, v4
    v_lshlrev_b32 v50, 1, v3
    v_add_u32_e64 v51, v49, v50
    v_add_u32 v51, 2097152, v51
    v_sub_u32 v50, 4080, v50
    v_add_u32 v49, v49, v50
    v_readfirstlane_b32 s19, v45
    s_waitcnt lgkmcnt(0)
    s_mov_b64 exec, 0
    s_cmp_lg_u32 s19, 0
    s_nop 1
    s_cbranch_scc1 TCHt0
    s_call_b64 s[68:69], K0PG1
TCHt0:
    s_cmp_lg_u32 s19, 1
    s_cbranch_scc1 TCHt1
    s_call_b64 s[68:69], K0PG2
TCHt1:
    s_cmp_lg_u32 s19, 2
    s_cbranch_scc1 TCHt2
    s_call_b64 s[68:69], K0PG3
TCHt2:
    s_cmp_lg_u32 s19, 3
    s_cbranch_scc1 TCHt3
    s_call_b64 s[68:69], K0PG4
TCHt3:
    s_mov_b64 exec, -1
    v_readfirstlane_b32 s68, v0
    s_waitcnt vmcnt(29)
    v_lshlrev_b32_e64 v60, 16, v40
    v_and_b32 v61, 0xffff0000, v40
    v_lshlrev_b32_e64 v62, 16, v41
    v_and_b32 v63, 0xffff0000, v41
    v_lshlrev_b32_e64 v64, 16, v42
    v_and_b32 v65, 0xffff0000, v42
    v_lshlrev_b32_e64 v66, 16, v43
    v_and_b32 v67, 0xffff0000, v43
    s_waitcnt vmcnt(18)
    v_readfirstlane_b32 s19, v45
    s_bfe_u32 s64, s2, 0x20001
    s_lshl_b32 s64, s64, 5
    s_lshr_b32 s65, s2, 3
    s_add_u32 s64, s64, s65
    s_mul_i32 s64, s64, 14336
    s_and_b32 s65, s2, 1
    v_min_u32 v124, 55, v46
    s_cmp_lg_u32 s19, 0
    s_nop 0
    s_cbranch_scc1 K0_PQ1
    s_mov_b32 s60, s52
    s_and_b32 s61, s53, 0xffff
    s_mov_b32 s62, 2097152
    s_mov_b32 s63, 0x00020000
    v_lshlrev_b32 v124, 6, v46
    s_lshl_b32 s64, s2, 12
    s_add_u32 s65, s64, 0x100000
    s_branch K0_PQ4
K0_PQ1:
    s_cmp_lg_u32 s19, 3
    s_cbranch_scc1 K0_PQ2
    s_mov_b32 s60, s54
    s_and_b32 s61, s55, 0xffff
    s_mov_b32 s62, 1835008
    s_mov_b32 s63, 0x00020000
    v_lshrrev_b32 v125, 3, v124
    v_and_b32 v124, 7, v124
    v_lshlrev_b32 v124, 6, v124
    v_lshl_add_u32 v124, v125, 10, v124
    s_lshl_b32 s65, s65, 9
    s_nop 0
    s_branch K0_PQ3
K0_PQ2:
    s_mov_b32 s60, s56
    s_and_b32 s61, s57, 0xffff
    s_mov_b32 s62, 1835008
    s_mov_b32 s63, 0x00020000
    s_cmp_lg_u32 s19, 2
    s_cbranch_scc1 K0_PQ5
    s_mov_b32 s60, s58
    s_and_b32 s61, s59, 0xffff
    s_mov_b32 s62, 1835008
    s_mov_b32 s63, 0x00020000
K0_PQ5:
    v_cmp_lt_u32 vcc, 27, v124
K0PG1:
    s_cbranch_execz K0RET
    v_lshlrev_b32 v124, 6, v124
    v_add_u32 v125, 1792, v124
    v_cndmask_b32_e64 v124, v124, v125, vcc
    s_mul_i32 s65, s65, 1792
    s_nop 0
K0_PQ3:
    s_add_u32 s64, s64, s65
    s_add_u32 s65, s64, 7168
K0_PQ4:
    buffer_load_dword v126, v124, s[60:63], s64 offen sc0 sc1
    buffer_load_dword v127, v124, s[60:63], s65 offen sc0 sc1
K0_PQ6:
    v_lshlrev_b32_e64 v70, 16, v10
    v_and_b32 v82, 0xffff0000, v10
    v_lshlrev_b32_e64 v71, 16, v11
    v_and_b32 v83, 0xffff0000, v11
    v_lshlrev_b32_e64 v72, 16, v12
    v_and_b32 v84, 0xffff0000, v12
    v_lshlrev_b32_e64 v73, 16, v13
    v_and_b32 v85, 0xffff0000, v13
    v_lshlrev_b32_e64 v74, 16, v14
    v_and_b32 v86, 0xffff0000, v14
    v_lshlrev_b32_e64 v75, 16, v15
    v_and_b32 v87, 0xffff0000, v15
    v_lshlrev_b32_e64 v76, 16, v16
    v_and_b32 v88, 0xffff0000, v16
    v_lshlrev_b32_e64 v77, 16, v17
    v_and_b32 v89, 0xffff0000, v17
    v_lshlrev_b32_e64 v78, 16, v18
    v_and_b32 v90, 0xffff0000, v18
    v_lshlrev_b32_e64 v79, 16, v19
    v_and_b32 v91, 0xffff0000, v19
    v_lshlrev_b32_e64 v80, 16, v20
    v_and_b32 v92, 0xffff0000, v20
    s_waitcnt vmcnt(12)
    v_mul_f32 v96, v70, v63
    v_mul_f32_e64 v97, v82, v67
    v_cvt_pk_bf16_f32 v98, v96, v97
    v_lshlrev_b32_e64 v94, 16, v98
    v_and_b32 v95, 0xffff0000, v98
    v_mul_f32 v96, v71, v62
    v_mul_f32 v97, v83, v66
    v_cvt_pk_bf16_f32 v98, v96, v97
    v_lshlrev_b32_e64 v96, 16, v98
    v_and_b32 v97, 0xffff0000, v98
    v_add_f32 v94, v94, v96
    v_add_f32 v95, v95, v97
    v_cvt_pk_bf16_f32 v98, v94, v95
    v_lshlrev_b32_e64 v94, 16, v98
    v_and_b32 v95, 0xffff0000, v98
    v_mul_f32 v96, v72, v61
    v_mul_f32 v97, v84, v65
    v_cvt_pk_bf16_f32 v98, v96, v97
    v_lshlrev_b32_e64 v96, 16, v98
    v_and_b32 v97, 0xffff0000, v98
    v_add_f32 v94, v94, v96
    v_add_f32 v95, v95, v97
    v_cvt_pk_bf16_f32 v98, v94, v95
    v_lshlrev_b32_e64 v94, 16, v98
    v_and_b32 v95, 0xffff0000, v98
    v_mul_f32 v96, v73, v60
    v_mul_f32 v97, v85, v64
    v_cvt_pk_bf16_f32 v98, v96, v97
    v_lshlrev_b32_e64 v96, 16, v98
    v_and_b32 v97, 0xffff0000, v98
    v_add_f32 v94, v94, v96
    v_add_f32 v95, v95, v97
    v_cvt_pk_bf16_f32 v98, v94, v95
    v_lshlrev_b32_e64 v94, 16, v98
    v_and_b32 v95, 0xffff0000, v98
    v_lshlrev_b32_e64 v96, 16, v21
    v_and_b32 v97, 0xffff0000, v21
    v_mul_f32 v96, v94, v96
    v_mul_f32 v97, v95, v97
    v_cvt_pk_bf16_f32 v100, v96, v97
    v_mul_f32 v96, v71, v63
    v_mul_f32 v97, v83, v67
    v_cvt_pk_bf16_f32 v98, v96, v97
    v_lshlrev_b32_e64 v94, 16, v98
    v_and_b32 v95, 0xffff0000, v98
    v_mul_f32 v96, v72, v62
    v_mul_f32 v97, v84, v66
    v_cvt_pk_bf16_f32 v98, v96, v97
    v_lshlrev_b32_e64 v96, 16, v98
    v_and_b32 v97, 0xffff0000, v98
    v_add_f32 v94, v94, v96
    v_add_f32 v95, v95, v97
    v_cvt_pk_bf16_f32 v98, v94, v95
    v_lshlrev_b32_e64 v94, 16, v98
    v_and_b32 v95, 0xffff0000, v98
    v_mul_f32 v96, v73, v61
    v_mul_f32 v97, v85, v65
    v_cvt_pk_bf16_f32 v98, v96, v97
    v_lshlrev_b32_e64 v96, 16, v98
    v_and_b32 v97, 0xffff0000, v98
    v_add_f32 v94, v94, v96
    v_add_f32 v95, v95, v97
    v_cvt_pk_bf16_f32 v98, v94, v95
    v_lshlrev_b32_e64 v94, 16, v98
    v_and_b32 v95, 0xffff0000, v98
    v_mul_f32 v96, v74, v60
    v_mul_f32 v97, v86, v64
    v_cvt_pk_bf16_f32 v98, v96, v97
    v_lshlrev_b32_e64 v96, 16, v98
    v_and_b32 v97, 0xffff0000, v98
    v_add_f32 v94, v94, v96
    v_add_f32 v95, v95, v97
    v_cvt_pk_bf16_f32 v98, v94, v95
    v_lshlrev_b32_e64 v94, 16, v98
    v_and_b32 v95, 0xffff0000, v98
    v_lshlrev_b32_e64 v96, 16, v22
    v_and_b32 v97, 0xffff0000, v22
    v_mul_f32 v96, v94, v96
    v_mul_f32 v97, v95, v97
    v_cvt_pk_bf16_f32 v101, v96, v97
    v_mul_f32 v96, v72, v63
    v_mul_f32 v97, v84, v67
    v_cvt_pk_bf16_f32 v98, v96, v97
    v_lshlrev_b32_e64 v94, 16, v98
    v_and_b32 v95, 0xffff0000, v98
    v_mul_f32 v96, v73, v62
    v_mul_f32 v97, v85, v66
    v_cvt_pk_bf16_f32 v98, v96, v97
    v_lshlrev_b32_e64 v96, 16, v98
    v_and_b32 v97, 0xffff0000, v98
    v_add_f32 v94, v94, v96
    v_add_f32 v95, v95, v97
    v_cvt_pk_bf16_f32 v98, v94, v95
    v_lshlrev_b32_e64 v94, 16, v98
    v_and_b32 v95, 0xffff0000, v98
    v_mul_f32 v96, v74, v61
    v_mul_f32 v97, v86, v65
    v_cvt_pk_bf16_f32 v98, v96, v97
    v_lshlrev_b32_e64 v96, 16, v98
    v_and_b32 v97, 0xffff0000, v98
    v_add_f32 v94, v94, v96
    v_add_f32 v95, v95, v97
    v_cvt_pk_bf16_f32 v98, v94, v95
    v_lshlrev_b32_e64 v94, 16, v98
    v_and_b32 v95, 0xffff0000, v98
    v_mul_f32 v96, v75, v60
    v_mul_f32 v97, v87, v64
    v_cvt_pk_bf16_f32 v98, v96, v97
    v_lshlrev_b32_e64 v96, 16, v98
    v_and_b32 v97, 0xffff0000, v98
    v_add_f32 v94, v94, v96
    v_add_f32 v95, v95, v97
    v_cvt_pk_bf16_f32 v98, v94, v95
    v_lshlrev_b32_e64 v94, 16, v98
    v_and_b32 v95, 0xffff0000, v98
    v_lshlrev_b32_e64 v96, 16, v23
    v_and_b32 v97, 0xffff0000, v23
    v_mul_f32 v96, v94, v96
    v_mul_f32 v97, v95, v97
    v_cvt_pk_bf16_f32 v102, v96, v97
    v_mul_f32_e64 v96, v73, v63
    v_mul_f32 v97, v85, v67
K0PG2:
    s_cbranch_execz K0RET
    v_cvt_pk_bf16_f32 v98, v96, v97
    v_lshlrev_b32_e64 v94, 16, v98
    v_and_b32 v95, 0xffff0000, v98
    v_mul_f32 v96, v74, v62
    v_mul_f32 v97, v86, v66
    v_cvt_pk_bf16_f32 v98, v96, v97
    v_lshlrev_b32_e64 v96, 16, v98
    v_and_b32 v97, 0xffff0000, v98
    v_add_f32 v94, v94, v96
    v_add_f32 v95, v95, v97
    v_cvt_pk_bf16_f32 v98, v94, v95
    v_lshlrev_b32_e64 v94, 16, v98
    v_and_b32 v95, 0xffff0000, v98
    v_mul_f32 v96, v75, v61
    v_mul_f32 v97, v87, v65
    v_cvt_pk_bf16_f32 v98, v96, v97
    v_lshlrev_b32_e64 v96, 16, v98
    v_and_b32 v97, 0xffff0000, v98
    v_add_f32 v94, v94, v96
    v_add_f32 v95, v95, v97
    v_cvt_pk_bf16_f32 v98, v94, v95
    v_lshlrev_b32_e64 v94, 16, v98
    v_and_b32 v95, 0xffff0000, v98
    v_mul_f32 v96, v76, v60
    v_mul_f32 v97, v88, v64
    v_cvt_pk_bf16_f32 v98, v96, v97
    v_lshlrev_b32_e64 v96, 16, v98
    v_and_b32 v97, 0xffff0000, v98
    v_add_f32 v94, v94, v96
    v_add_f32 v95, v95, v97
    v_cvt_pk_bf16_f32 v98, v94, v95
    v_lshlrev_b32_e64 v94, 16, v98
    v_and_b32 v95, 0xffff0000, v98
    v_lshlrev_b32_e64 v96, 16, v24
    v_and_b32 v97, 0xffff0000, v24
    v_mul_f32 v96, v94, v96
    v_mul_f32 v97, v95, v97
    v_cvt_pk_bf16_f32 v103, v96, v97
    v_mul_f32 v96, v74, v63
    v_mul_f32 v97, v86, v67
    v_cvt_pk_bf16_f32 v98, v96, v97
    v_lshlrev_b32_e64 v94, 16, v98
    v_and_b32 v95, 0xffff0000, v98
    v_mul_f32 v96, v75, v62
    v_mul_f32 v97, v87, v66
    v_cvt_pk_bf16_f32 v98, v96, v97
    v_lshlrev_b32_e64 v96, 16, v98
    v_and_b32 v97, 0xffff0000, v98
    v_add_f32 v94, v94, v96
    v_add_f32 v95, v95, v97
    v_cvt_pk_bf16_f32 v98, v94, v95
    v_lshlrev_b32_e64 v94, 16, v98
    v_and_b32 v95, 0xffff0000, v98
    v_mul_f32 v96, v76, v61
    v_mul_f32 v97, v88, v65
    v_cvt_pk_bf16_f32 v98, v96, v97
    v_lshlrev_b32_e64 v96, 16, v98
    v_and_b32 v97, 0xffff0000, v98
    v_add_f32 v94, v94, v96
    v_add_f32 v95, v95, v97
    v_cvt_pk_bf16_f32 v98, v94, v95
    v_lshlrev_b32_e64 v94, 16, v98
    v_and_b32 v95, 0xffff0000, v98
    v_mul_f32 v96, v77, v60
    v_mul_f32 v97, v89, v64
    v_cvt_pk_bf16_f32 v98, v96, v97
    v_lshlrev_b32_e64 v96, 16, v98
    v_and_b32 v97, 0xffff0000, v98
    v_add_f32 v94, v94, v96
    v_add_f32 v95, v95, v97
    v_cvt_pk_bf16_f32 v98, v94, v95
    v_lshlrev_b32_e64 v94, 16, v98
    v_and_b32 v95, 0xffff0000, v98
    v_lshlrev_b32_e64 v96, 16, v25
    v_and_b32 v97, 0xffff0000, v25
    v_mul_f32 v96, v94, v96
    v_mul_f32 v97, v95, v97
    v_cvt_pk_bf16_f32 v104, v96, v97
    v_mul_f32 v96, v75, v63
    v_mul_f32 v97, v87, v67
    v_cvt_pk_bf16_f32 v98, v96, v97
    v_lshlrev_b32_e64 v94, 16, v98
    v_and_b32 v95, 0xffff0000, v98
    v_mul_f32 v96, v76, v62
    v_mul_f32 v97, v88, v66
    v_cvt_pk_bf16_f32 v98, v96, v97
    v_lshlrev_b32_e64 v96, 16, v98
    v_and_b32 v97, 0xffff0000, v98
    v_add_f32 v94, v94, v96
    v_add_f32 v95, v95, v97
    v_cvt_pk_bf16_f32 v98, v94, v95
    v_lshlrev_b32_e64 v94, 16, v98
    v_and_b32 v95, 0xffff0000, v98
    v_mul_f32 v96, v77, v61
    v_mul_f32 v97, v89, v65
    v_cvt_pk_bf16_f32 v98, v96, v97
    v_lshlrev_b32_e64 v96, 16, v98
    v_and_b32 v97, 0xffff0000, v98
    v_add_f32 v94, v94, v96
    v_add_f32 v95, v95, v97
    v_cvt_pk_bf16_f32 v98, v94, v95
    v_lshlrev_b32_e64 v94, 16, v98
    v_and_b32 v95, 0xffff0000, v98
    v_mul_f32 v96, v78, v60
    v_mul_f32 v97, v90, v64
    v_cvt_pk_bf16_f32 v98, v96, v97
    v_lshlrev_b32_e64 v96, 16, v98
    v_and_b32 v97, 0xffff0000, v98
    v_add_f32 v94, v94, v96
    v_add_f32 v95, v95, v97
    v_cvt_pk_bf16_f32 v98, v94, v95
    v_lshlrev_b32_e64 v94, 16, v98
    v_and_b32 v95, 0xffff0000, v98
    v_lshlrev_b32_e64 v96, 16, v26
    v_and_b32 v97, 0xffff0000, v26
    v_mul_f32 v96, v94, v96
    v_mul_f32 v97, v95, v97
    v_cvt_pk_bf16_f32 v105, v96, v97
    v_mul_f32 v96, v76, v63
    v_mul_f32 v97, v88, v67
    v_cvt_pk_bf16_f32 v98, v96, v97
    v_lshlrev_b32_e64 v94, 16, v98
    v_and_b32 v95, 0xffff0000, v98
    v_mul_f32 v96, v77, v62
    v_mul_f32 v97, v89, v66
    v_cvt_pk_bf16_f32 v98, v96, v97
    v_lshlrev_b32_e64 v96, 16, v98
    v_and_b32 v97, 0xffff0000, v98
    v_add_f32 v94, v94, v96
    v_add_f32 v95, v95, v97
    v_cvt_pk_bf16_f32 v98, v94, v95
    v_lshlrev_b32_e64 v94, 16, v98
    v_and_b32 v95, 0xffff0000, v98
    v_mul_f32 v96, v78, v61
    v_mul_f32 v97, v90, v65
    v_cvt_pk_bf16_f32 v98, v96, v97
    v_lshlrev_b32_e64 v96, 16, v98
    v_and_b32 v97, 0xffff0000, v98
    v_add_f32 v94, v94, v96
    v_add_f32 v95, v95, v97
    v_cvt_pk_bf16_f32 v98, v94, v95
    v_lshlrev_b32_e64 v94, 16, v98
    v_and_b32 v95, 0xffff0000, v98
    v_mul_f32 v96, v79, v60
    v_mul_f32 v97, v91, v64
    v_cvt_pk_bf16_f32 v98, v96, v97
    v_lshlrev_b32_e64 v96, 16, v98
    v_and_b32 v97, 0xffff0000, v98
    v_add_f32 v94, v94, v96
    v_add_f32 v95, v95, v97
    v_cvt_pk_bf16_f32 v98, v94, v95
    v_lshlrev_b32_e64 v94, 16, v98
    v_and_b32 v95, 0xffff0000, v98
    v_lshlrev_b32_e64 v96, 16, v27
    v_and_b32 v97, 0xffff0000, v27
    v_mul_f32 v96, v94, v96
    v_mul_f32 v97, v95, v97
    v_cvt_pk_bf16_f32 v106, v96, v97
K0PG3:
    s_cbranch_execz K0RET
    v_mul_f32 v96, v77, v63
    v_mul_f32_e64 v97, v89, v67
    v_cvt_pk_bf16_f32 v98, v96, v97
    v_lshlrev_b32_e64 v94, 16, v98
    v_and_b32 v95, 0xffff0000, v98
    v_mul_f32 v96, v78, v62
    v_mul_f32 v97, v90, v66
    v_cvt_pk_bf16_f32 v98, v96, v97
    v_lshlrev_b32_e64 v96, 16, v98
    v_and_b32 v97, 0xffff0000, v98
    v_add_f32 v94, v94, v96
    v_add_f32 v95, v95, v97
    v_cvt_pk_bf16_f32 v98, v94, v95
    v_lshlrev_b32_e64 v94, 16, v98
    v_and_b32 v95, 0xffff0000, v98
    v_mul_f32 v96, v79, v61
    v_mul_f32 v97, v91, v65
    v_cvt_pk_bf16_f32 v98, v96, v97
    v_lshlrev_b32_e64 v96, 16, v98
    v_and_b32 v97, 0xffff0000, v98
    v_add_f32 v94, v94, v96
    v_add_f32 v95, v95, v97
    v_cvt_pk_bf16_f32 v98, v94, v95
    v_lshlrev_b32_e64 v94, 16, v98
    v_and_b32 v95, 0xffff0000, v98
    v_mul_f32 v96, v80, v60
    v_mul_f32 v97, v92, v64
    v_cvt_pk_bf16_f32 v98, v96, v97
    v_lshlrev_b32_e64 v96, 16, v98
    v_and_b32 v97, 0xffff0000, v98
    v_add_f32 v94, v94, v96
    v_add_f32 v95, v95, v97
    v_cvt_pk_bf16_f32 v98, v94, v95
    v_lshlrev_b32_e64 v94, 16, v98
    v_and_b32 v95, 0xffff0000, v98
    v_lshlrev_b32_e64 v96, 16, v28
    v_and_b32 v97, 0xffff0000, v28
    v_mul_f32 v96, v94, v96
    v_mul_f32 v97, v95, v97
    v_cvt_pk_bf16_f32 v107, v96, v97
    s_mov_b32 s40, 0x05040100
    s_mov_b32 s41, 0x07060302
    v_perm_b32 v108, v106, v107, s40
    v_perm_b32 v112, v106, v107, s41
    v_perm_b32 v109, v104, v105, s40
    v_perm_b32 v113, v104, v105, s41
    v_perm_b32 v110, v102, v103, s40
    v_perm_b32 v114, v102, v103, s41
    v_perm_b32 v111, v100, v101, s40
    v_perm_b32 v115, v100, v101, s41
    buffer_store_dwordx4 v[108:111], v49, s[36:39], 0 offen
    v_add_u32 v50, 4096, v49
    buffer_store_dwordx4 v[112:115], v50, s[36:39], 0 offen
    s_waitcnt vmcnt(6)
    s_nop 0
    v_perm_b32 v116, v30, v29, s40
    v_perm_b32 v120, v30, v29, s41
    v_perm_b32 v117, v32, v31, s40
    v_perm_b32 v121, v32, v31, s41
    v_perm_b32 v118, v34, v33, s40
    v_perm_b32 v122, v34, v33, s41
    v_perm_b32 v119, v36, v35, s40
    v_perm_b32 v123, v36, v35, s41
    buffer_store_dwordx4 v[116:119], v51, s[36:39], 0 offen
    v_add_u32 v50, 4096, v51
    buffer_store_dwordx4 v[120:123], v50, s[36:39], 0 offen
    s_waitcnt vmcnt(6)
    v_lshlrev_b32 v70, 16, v52
    v_and_b32 v71, 0xffff0000, v52
    v_lshlrev_b32_e64 v72, 16, v53
    v_and_b32 v73, 0xffff0000, v53
    v_lshlrev_b32_e64 v74, 16, v54
    v_and_b32 v75, 0xffff0000, v54
    v_lshlrev_b32_e64 v76, 16, v55
    v_and_b32 v77, 0xffff0000, v55
    v_lshlrev_b32_e64 v78, 16, v56
    v_and_b32 v79, 0xffff0000, v56
    v_lshlrev_b32_e64 v80, 16, v57
    v_and_b32 v81, 0xffff0000, v57
    v_lshlrev_b32_e64 v82, 16, v58
    v_and_b32 v83, 0xffff0000, v58
    v_lshlrev_b32_e64 v84, 16, v59
    v_and_b32 v85, 0xffff0000, v59
    v_add_f32 v90, v70, v71
    v_add_f32 v90, v90, v72
    v_add_f32 v90, v90, v73
    v_add_f32 v90, v90, v74
    v_add_f32 v90, v90, v75
    v_add_f32 v90, v90, v76
    v_add_f32 v90, v90, v77
    v_add_f32 v91, v78, v79
    v_add_f32 v91, v91, v80
    v_add_f32 v91, v91, v81
    v_add_f32 v91, v91, v82
    v_add_f32 v91, v91, v83
    v_add_f32_e64 v91, v91, v84
    v_add_f32 v91, v91, v85
    s_nop 1
    v_add_f32_dpp v90, v90, v90 quad_perm:[1,0,3,2] row_mask:0xf bank_mask:0xf
    v_add_f32_dpp v91, v91, v91 quad_perm:[1,0,3,2] row_mask:0xf bank_mask:0xf
    s_nop 0
    v_add_f32_dpp v90, v90, v90 quad_perm:[2,3,0,1] row_mask:0xf bank_mask:0xf
    v_add_f32_dpp v91, v91, v91 quad_perm:[2,3,0,1] row_mask:0xf bank_mask:0xf
    s_nop 0
    v_add_f32_dpp v90, v90, v90 row_half_mirror row_mask:0xf bank_mask:0xf
    v_add_f32_dpp v91, v91, v91 row_half_mirror row_mask:0xf bank_mask:0xf
    s_nop 0
    v_add_f32_dpp v90, v90, v90 row_mirror row_mask:0xf bank_mask:0xf
    v_add_f32_dpp v91, v91, v91 row_mirror row_mask:0xf bank_mask:0xf
    s_nop 0
    s_nop 0
    s_nop 0
    v_readlane_b32 s44, v90, 0
    v_readlane_b32 s45, v90, 16
    v_readlane_b32 s46, v90, 32
    v_readlane_b32 s47, v90, 48
    v_readlane_b32 s48, v91, 0
    v_readlane_b32 s49, v91, 16
    v_readlane_b32 s50, v91, 32
    v_readlane_b32 s51, v91, 48
    s_nop 1
    v_mov_b32 v90, s44
    v_mov_b32 v91, s48
    v_add_f32 v90, s45, v90
    v_add_f32 v91, s49, v91
    v_add_f32 v90, s46, v90
    v_add_f32 v91, s50, v91
    v_add_f32 v90, s47, v90
    v_add_f32_e64 v91, s51, v91
    v_mul_f32 v90, 0x3b000000, v90
    v_mul_f32 v91, 0x3b000000, v91
    v_sub_f32 v70, v70, v90
    v_sub_f32 v71, v71, v90
    v_sub_f32 v72, v72, v90
    v_sub_f32 v73, v73, v90
    v_sub_f32 v74, v74, v90
    v_sub_f32 v75, v75, v90
    v_sub_f32 v76, v76, v90
    v_sub_f32 v77, v77, v90
    v_mul_f32 v92, v70, v70
    v_fmac_f32 v92, v71, v71
    v_fmac_f32 v92, v72, v72
    v_fmac_f32 v92, v73, v73
    v_fmac_f32 v92, v74, v74
    v_fmac_f32 v92, v75, v75
    v_fmac_f32 v92, v76, v76
    v_fmac_f32 v92, v77, v77
    v_sub_f32 v78, v78, v91
    v_sub_f32 v79, v79, v91
    v_sub_f32 v80, v80, v91
    v_sub_f32 v81, v81, v91
    v_sub_f32 v82, v82, v91
    v_sub_f32 v83, v83, v91
    v_sub_f32 v84, v84, v91
    v_sub_f32 v85, v85, v91
    v_mul_f32 v93, v78, v78
    v_fmac_f32 v93, v79, v79
    v_fmac_f32 v93, v80, v80
    v_fmac_f32 v93, v81, v81
    v_fmac_f32 v93, v82, v82
    v_fmac_f32 v93, v83, v83
    v_fmac_f32_e64 v93, v84, v84
    v_fmac_f32 v93, v85, v85
    s_nop 1
    v_add_f32_dpp v92, v92, v92 quad_perm:[1,0,3,2] row_mask:0xf bank_mask:0xf
    v_add_f32_dpp v93, v93, v93 quad_perm:[1,0,3,2] row_mask:0xf bank_mask:0xf
    s_nop 0
    v_add_f32_dpp v92, v92, v92 quad_perm:[2,3,0,1] row_mask:0xf bank_mask:0xf
K0PG4:
    s_cbranch_execz K0RET
    v_add_f32_dpp v93, v93, v93 quad_perm:[2,3,0,1] row_mask:0xf bank_mask:0xf
    s_nop 0
    v_add_f32_dpp v92, v92, v92 row_half_mirror row_mask:0xf bank_mask:0xf
    v_add_f32_dpp v93, v93, v93 row_half_mirror row_mask:0xf bank_mask:0xf
    s_nop 0
    v_add_f32_dpp v92, v92, v92 row_mirror row_mask:0xf bank_mask:0xf
    v_add_f32_dpp v93, v93, v93 row_mirror row_mask:0xf bank_mask:0xf
    s_nop 0
    s_nop 0
    v_readlane_b32 s44, v92, 0
    v_readlane_b32 s45, v92, 16
    v_readlane_b32 s46, v92, 32
    v_readlane_b32 s47, v92, 48
    v_readlane_b32 s48, v93, 0
    v_readlane_b32 s49, v93, 16
    v_readlane_b32 s50, v93, 32
    v_readlane_b32 s51, v93, 48
    s_nop 1
    v_mov_b32 v92, s44
    v_mov_b32 v93, s48
    v_add_f32 v92, s45, v92
    v_add_f32 v93, s49, v93
    v_add_f32 v92, s46, v92
    v_add_f32 v93, s50, v93
    v_add_f32 v92, s47, v92
    v_add_f32_e64 v93, s51, v93
    v_mul_f32 v92, 0x3b000000, v92
    v_mul_f32 v93, 0x3b000000, v93
    v_cvt_pk_bf16_f32 v94, v92, v93
    v_lshlrev_b32_e64 v92, 16, v94
    v_and_b32 v93, 0xffff0000, v94
    v_add_f32 v92, 0x3727c5ac, v92
    v_add_f32 v93, 0x3727c5ac, v93
    v_cvt_pk_bf16_f32 v94, v92, v93
    v_lshlrev_b32_e64 v92, 16, v94
    v_and_b32 v93, 0xffff0000, v94
    v_sqrt_f32_e64 v92, v92
    v_sqrt_f32 v93, v93
    s_nop 0
    v_cvt_pk_bf16_f32 v94, v92, v93
    v_lshlrev_b32_e64 v92, 16, v94
    v_and_b32 v93, 0xffff0000, v94
    v_cvt_pk_bf16_f32 v94, v90, v91
    v_lshlrev_b32_e64 v90, 16, v94
    v_and_b32 v91, 0xffff0000, v94
    v_rcp_f32 v94, v92
    v_rcp_f32 v95, v93
    v_xor_b32 v90, 0x80000000, v90
    v_xor_b32 v91, 0x80000000, v91
    v_fma_f32 v92, -v92, v94, 1.0
    v_fma_f32 v93, -v93, v95, 1.0
    v_fmac_f32 v94, v92, v94
    v_fmac_f32 v95, v93, v95
    v_lshlrev_b32_e64 v96, 2, v47
    v_add_u32 v96, 25165824, v96
    v_add_u32 v97, 8192, v96
    v_cmp_eq_u32 vcc, 0, v46
    s_and_saveexec_b64 s[42:43], vcc
    buffer_store_dwordx2 v[90:91], v96, s[36:39], 0 offen
    buffer_store_dwordx2 v[94:95], v97, s[36:39], 0 offen
    s_waitcnt vmcnt(6)
    s_endpgm
K0_MOD:
    s_load_dwordx4 s[4:7], s[0:1], 80
    s_load_dwordx2 s[12:13], s[0:1], 112
    s_sub_u32 s14, s2, 256
    s_and_b32 s15, s14, 7
    s_lshr_b32 s16, s14, 3
    s_mul_i32 s15, s15, 12
    s_add_u32 s15, s15, s16
    s_lshl_b32 s17, s15, 6
    v_and_b32 v1, 63, v0
    v_lshrrev_b32 v2, 6, v0
    v_lshrrev_b32 v3, 2, v1
    v_and_b32_e64 v4, 3, v1
    v_lshl_add_u32 v5, v2, 7, v3
    s_movk_i32 s18, 6144
    v_mul_lo_u32 v6, v5, s18
    v_lshl_add_u32 v6, v4, 4, v6
    v_add_u32 v6, s17, v6
    v_lshlrev_b32_e64 v7, 1, v5
    s_waitcnt lgkmcnt(0)
    s_mov_b32 s20, s4
    s_and_b32 s21, s5, 0xffff
    s_mov_b32 s22, 1024
    s_mov_b32 s23, 0x00020000
    s_mov_b32 s24, s6
    s_and_b32 s25, s7, 0xffff
    s_mov_b32 s26, 3145728
    s_mov_b32 s27, 0x00020000
    s_mov_b32 s36, s12
    s_and_b32 s37, s13, 0xffff
    s_mov_b32 s38, 268435456
    s_mov_b32 s39, 0x00020000
    buffer_load_ushort v10, v7, s[20:23], 0 offen offset:0
    buffer_load_ushort v11, v7, s[20:23], 0 offen offset:32
    buffer_load_ushort v12, v7, s[20:23], 0 offen offset:64
    buffer_load_ushort v13, v7, s[20:23], 0 offen offset:96
    buffer_load_ushort v14, v7, s[20:23], 0 offen offset:128
    buffer_load_ushort v15, v7, s[20:23], 0 offen offset:160
    buffer_load_ushort v16, v7, s[20:23], 0 offen offset:192
    buffer_load_ushort v17, v7, s[20:23], 0 offen offset:224
    s_mov_b32 s44, 0
    s_mov_b32 s45, 98304
    s_mov_b32 s46, 196608
    s_mov_b32 s47, 294912
    s_mov_b32 s48, 393216
    s_mov_b32 s49, 491520
    s_mov_b32 s50, 589824
    s_mov_b32 s51, 688128
    buffer_load_dwordx4 v[20:23], v6, s[24:27], s44 offen
    buffer_load_dwordx4 v[24:27], v6, s[24:27], s45 offen
    buffer_load_dwordx4 v[28:31], v6, s[24:27], s46 offen
    buffer_load_dwordx4 v[32:35], v6, s[24:27], s47 offen
    buffer_load_dwordx4 v[36:39], v6, s[24:27], s48 offen
    buffer_load_dwordx4 v[40:43], v6, s[24:27], s49 offen
    buffer_load_dwordx4 v[44:47], v6, s[24:27], s50 offen
    buffer_load_dwordx4 v[48:51], v6, s[24:27], s51 offen
    v_readfirstlane_b32 s19, v2
    s_waitcnt lgkmcnt(0)
    s_mov_b64 exec, 0
    s_cmp_lg_u32 s19, 0
    s_nop 1
    s_cbranch_scc1 TCHm0
    s_call_b64 s[68:69], K0PG5
TCHm0:
    s_cmp_lg_u32 s19, 1
    s_cbranch_scc1 TCHm1
    s_call_b64 s[68:69], K0PG6
TCHm1:
    s_mov_b64 exec, -1
    v_readfirstlane_b32 s68, v0
    s_waitcnt vmcnt(8)
    v_lshlrev_b32_e64 v10, 16, v10
    v_mul_f32 v60, 0xbfb8aa3b, v10
    v_lshlrev_b32_e64 v11, 16, v11
    v_mul_f32 v61, 0xbfb8aa3b, v11
    v_lshlrev_b32_e64 v12, 16, v12
    v_mul_f32 v62, 0xbfb8aa3b, v12
    v_lshlrev_b32_e64 v13, 16, v13
    v_mul_f32 v63, 0xbfb8aa3b, v13
    v_lshlrev_b32_e64 v14, 16, v14
    v_mul_f32 v64, 0xbfb8aa3b, v14
    v_lshlrev_b32_e64 v15, 16, v15
    v_mul_f32 v65, 0xbfb8aa3b, v15
    v_lshlrev_b32_e64 v16, 16, v16
    v_mul_f32 v66, 0xbfb8aa3b, v16
    v_lshlrev_b32_e64 v17, 16, v17
    v_mul_f32 v67, 0xbfb8aa3b, v17
    v_exp_f32 v60, v60
    v_exp_f32 v61, v61
    v_exp_f32 v62, v62
    v_exp_f32 v63, v63
    v_exp_f32 v64, v64
    v_exp_f32 v65, v65
    v_exp_f32 v66, v66
    v_exp_f32 v67, v67
    s_nop 0
    v_add_f32 v60, 1.0, v60
    v_add_f32 v61, 1.0, v61
    v_add_f32 v62, 1.0, v62
K0PG5:
    s_cbranch_execz K0RET
    v_add_f32 v63, 1.0, v63
    v_add_f32 v64, 1.0, v64
    v_add_f32 v65, 1.0, v65
    v_add_f32 v66, 1.0, v66
    v_add_f32 v67, 1.0, v67
    v_rcp_f32 v60, v60
    v_rcp_f32 v61, v61
    v_rcp_f32 v62, v62
    v_rcp_f32 v63, v63
    v_rcp_f32 v64, v64
    v_rcp_f32 v65, v65
    v_rcp_f32 v66, v66
    v_rcp_f32 v67, v67
    s_nop 0
    v_mul_f32 v60, v10, v60
    v_mul_f32 v61, v11, v61
    v_mul_f32 v62, v12, v62
    v_mul_f32 v63, v13, v63
    v_mul_f32 v64, v14, v64
    v_mul_f32 v65, v15, v65
    v_mul_f32 v66, v16, v66
    v_mul_f32_e64 v67, v17, v67
    v_cvt_pk_bf16_f32 v68, v60, v61
    v_lshlrev_b32_e64 v60, 16, v68
    v_and_b32 v61, 0xffff0000, v68
    v_cvt_pk_bf16_f32 v68, v62, v63
    v_lshlrev_b32_e64 v62, 16, v68
    v_and_b32 v63, 0xffff0000, v68
    v_cvt_pk_bf16_f32 v68, v64, v65
    v_lshlrev_b32_e64 v64, 16, v68
    v_and_b32 v65, 0xffff0000, v68
    v_cvt_pk_bf16_f32 v68, v66, v67
    v_lshlrev_b32_e64 v66, 16, v68
    v_and_b32 v67, 0xffff0000, v68
    s_waitcnt vmcnt(7)
    v_lshlrev_b32 v80, 16, v20
    v_and_b32 v81, 0xffff0000, v20
    v_mul_f32 v72, v80, v60
    v_mul_f32 v73, v81, v60
    v_lshlrev_b32_e64 v80, 16, v21
    v_and_b32 v81, 0xffff0000, v21
    v_mul_f32 v74, v80, v60
    v_mul_f32 v75, v81, v60
    v_lshlrev_b32_e64 v80, 16, v22
    v_and_b32 v81, 0xffff0000, v22
    v_mul_f32 v76, v80, v60
    v_mul_f32 v77, v81, v60
    v_lshlrev_b32_e64 v80, 16, v23
    v_and_b32 v81, 0xffff0000, v23
    v_mul_f32 v78, v80, v60
    v_mul_f32 v79, v81, v60
    s_waitcnt vmcnt(6)
    v_lshlrev_b32 v80, 16, v24
    v_and_b32 v81, 0xffff0000, v24
    v_fmac_f32 v72, v80, v61
    v_fmac_f32 v73, v81, v61
    v_lshlrev_b32_e64 v80, 16, v25
    v_and_b32 v81, 0xffff0000, v25
    v_fmac_f32 v74, v80, v61
    v_fmac_f32 v75, v81, v61
    v_lshlrev_b32_e64 v80, 16, v26
    v_and_b32 v81, 0xffff0000, v26
    v_fmac_f32 v76, v80, v61
    v_fmac_f32 v77, v81, v61
    v_lshlrev_b32_e64 v80, 16, v27
    v_and_b32 v81, 0xffff0000, v27
    v_fmac_f32 v78, v80, v61
    v_fmac_f32 v79, v81, v61
    s_waitcnt vmcnt(5)
    v_lshlrev_b32 v80, 16, v28
    v_and_b32 v81, 0xffff0000, v28
    v_fmac_f32 v72, v80, v62
    v_fmac_f32 v73, v81, v62
    v_lshlrev_b32_e64 v80, 16, v29
    v_and_b32 v81, 0xffff0000, v29
    v_fmac_f32 v74, v80, v62
    v_fmac_f32 v75, v81, v62
    v_lshlrev_b32_e64 v80, 16, v30
    v_and_b32 v81, 0xffff0000, v30
    v_fmac_f32 v76, v80, v62
    v_fmac_f32 v77, v81, v62
    v_lshlrev_b32_e64 v80, 16, v31
    v_and_b32 v81, 0xffff0000, v31
    v_fmac_f32 v78, v80, v62
    v_fmac_f32 v79, v81, v62
    s_waitcnt vmcnt(4)
    v_lshlrev_b32 v80, 16, v32
    v_and_b32 v81, 0xffff0000, v32
    v_fmac_f32 v72, v80, v63
    v_fmac_f32 v73, v81, v63
    v_lshlrev_b32_e64 v80, 16, v33
    v_and_b32 v81, 0xffff0000, v33
    v_fmac_f32 v74, v80, v63
    v_fmac_f32 v75, v81, v63
    v_lshlrev_b32_e64 v80, 16, v34
    v_and_b32 v81, 0xffff0000, v34
    v_fmac_f32 v76, v80, v63
    v_fmac_f32 v77, v81, v63
    v_lshlrev_b32_e64 v80, 16, v35
    v_and_b32 v81, 0xffff0000, v35
    v_fmac_f32 v78, v80, v63
    v_fmac_f32 v79, v81, v63
    s_waitcnt vmcnt(3)
    v_lshlrev_b32 v80, 16, v36
    v_and_b32 v81, 0xffff0000, v36
    v_fmac_f32 v72, v80, v64
    v_fmac_f32 v73, v81, v64
    v_lshlrev_b32_e64 v80, 16, v37
    v_and_b32 v81, 0xffff0000, v37
    v_fmac_f32 v74, v80, v64
    v_fmac_f32 v75, v81, v64
    v_lshlrev_b32_e64 v80, 16, v38
    v_and_b32 v81, 0xffff0000, v38
    v_fmac_f32 v76, v80, v64
    v_fmac_f32 v77, v81, v64
    v_lshlrev_b32_e64 v80, 16, v39
    v_and_b32 v81, 0xffff0000, v39
    v_fmac_f32 v78, v80, v64
    v_fmac_f32 v79, v81, v64
    s_waitcnt vmcnt(2)
    v_lshlrev_b32 v80, 16, v40
    v_and_b32 v81, 0xffff0000, v40
    v_fmac_f32 v72, v80, v65
    v_fmac_f32 v73, v81, v65
    v_lshlrev_b32_e64 v80, 16, v41
    v_and_b32 v81, 0xffff0000, v41
    v_fmac_f32 v74, v80, v65
    v_fmac_f32 v75, v81, v65
    v_lshlrev_b32_e64 v80, 16, v42
    v_and_b32 v81, 0xffff0000, v42
    v_fmac_f32 v76, v80, v65
    v_fmac_f32 v77, v81, v65
    v_lshlrev_b32_e64 v80, 16, v43
    v_and_b32 v81, 0xffff0000, v43
    v_fmac_f32 v78, v80, v65
    v_fmac_f32 v79, v81, v65
    s_waitcnt vmcnt(1)
    v_lshlrev_b32 v80, 16, v44
    v_and_b32 v81, 0xffff0000, v44
    v_fmac_f32 v72, v80, v66
    v_fmac_f32 v73, v81, v66
    v_lshlrev_b32_e64 v80, 16, v45
    v_and_b32 v81, 0xffff0000, v45
    v_fmac_f32 v74, v80, v66
    v_fmac_f32 v75, v81, v66
    v_lshlrev_b32_e64 v80, 16, v46
    v_and_b32 v81, 0xffff0000, v46
    v_fmac_f32 v76, v80, v66
    v_fmac_f32 v77, v81, v66
    v_lshlrev_b32_e64 v80, 16, v47
    v_and_b32 v81, 0xffff0000, v47
    v_fmac_f32 v78, v80, v66
    v_fmac_f32 v79, v81, v66
    s_waitcnt vmcnt(0)
    v_lshlrev_b32 v80, 16, v48
    v_and_b32 v81, 0xffff0000, v48
    v_fmac_f32 v72, v80, v67
    v_fmac_f32 v73, v81, v67
    v_lshlrev_b32_e64 v80, 16, v49
    v_and_b32 v81, 0xffff0000, v49
    v_fmac_f32 v74, v80, v67
    v_fmac_f32 v75, v81, v67
    v_lshlrev_b32_e64 v80, 16, v50
    v_and_b32 v81, 0xffff0000, v50
    v_fmac_f32 v76, v80, v67
    v_fmac_f32 v77, v81, v67
    v_lshlrev_b32_e64 v80, 16, v51
    v_and_b32 v81, 0xffff0000, v51
    v_fmac_f32_e64 v78, v80, v67
    v_fmac_f32 v79, v81, v67
    s_nop 1
    v_add_f32_dpp v72, v72, v72 row_ror:4 row_mask:0xf bank_mask:0xf
    v_add_f32_dpp v73, v73, v73 row_ror:4 row_mask:0xf bank_mask:0xf
    v_add_f32_dpp v74, v74, v74 row_ror:4 row_mask:0xf bank_mask:0xf
    v_add_f32_dpp v75, v75, v75 row_ror:4 row_mask:0xf bank_mask:0xf
    v_add_f32_dpp v76, v76, v76 row_ror:4 row_mask:0xf bank_mask:0xf
    v_add_f32_dpp v77, v77, v77 row_ror:4 row_mask:0xf bank_mask:0xf
    v_add_f32_dpp v78, v78, v78 row_ror:4 row_mask:0xf bank_mask:0xf
K0PG6:
    s_cbranch_execz K0RET
    s_nop 0
    v_add_f32_dpp v79, v79, v79 row_ror:4 row_mask:0xf bank_mask:0xf
    v_add_f32_dpp v72, v72, v72 row_ror:8 row_mask:0xf bank_mask:0xf
    v_add_f32_dpp v73, v73, v73 row_ror:8 row_mask:0xf bank_mask:0xf
    v_add_f32_dpp v74, v74, v74 row_ror:8 row_mask:0xf bank_mask:0xf
    v_add_f32_dpp v75, v75, v75 row_ror:8 row_mask:0xf bank_mask:0xf
    v_add_f32_dpp v76, v76, v76 row_ror:8 row_mask:0xf bank_mask:0xf
    v_add_f32_dpp v77, v77, v77 row_ror:8 row_mask:0xf bank_mask:0xf
    v_add_f32_dpp v78, v78, v78 row_ror:8 row_mask:0xf bank_mask:0xf
    v_add_f32_dpp v79, v79, v79 row_ror:8 row_mask:0xf bank_mask:0xf
    v_lshrrev_b32_e64 v8, 4, v1
    v_lshl_add_u32 v8, v2, 2, v8
    v_lshl_add_u32 v8, v8, 2, v4
    v_lshlrev_b32 v8, 5, v8
    v_and_b32 v9, 12, v1
    v_cmp_eq_u32 vcc, 0, v9
    s_and_saveexec_b64 s[42:43], vcc
    ds_write_b128 v8, v[72:75]
    ds_write_b128 v8, v[76:79] offset:16
    s_mov_b64 exec, s[42:43]
    s_waitcnt lgkmcnt(0)
    s_barrier
    v_cmp_gt_u32 vcc, 32, v0
    s_and_saveexec_b64 s[42:43], vcc
    s_nop 3
    s_cbranch_execz K0_END
    v_lshlrev_b32 v8, 2, v0
    ds_read_b32 v20, v8 offset:0
    ds_read_b32 v21, v8 offset:128
    ds_read_b32 v22, v8 offset:256
    ds_read_b32 v23, v8 offset:384
    ds_read_b32 v24, v8 offset:512
    ds_read_b32 v25, v8 offset:640
    ds_read_b32 v26, v8 offset:768
    ds_read_b32 v27, v8 offset:896
    ds_read_b32 v28, v8 offset:1024
    ds_read_b32 v29, v8 offset:1152
    ds_read_b32 v30, v8 offset:1280
    ds_read_b32 v31, v8 offset:1408
    ds_read_b32 v32, v8 offset:1536
    ds_read_b32 v33, v8 offset:1664
    ds_read_b32 v34, v8 offset:1792
    ds_read_b32 v35, v8 offset:1920
    s_waitcnt lgkmcnt(0)
    v_add_f32 v20, v20, v21
    v_add_f32 v20, v20, v22
    v_add_f32 v20, v20, v23
    v_add_f32 v20, v20, v24
    v_add_f32 v20, v20, v25
    v_add_f32 v20, v20, v26
    v_add_f32 v20, v20, v27
    v_add_f32 v20, v20, v28
    v_add_f32 v20, v20, v29
    v_add_f32 v20, v20, v30
    v_add_f32 v20, v20, v31
    v_add_f32 v20, v20, v32
    v_add_f32 v20, v20, v33
    v_add_f32 v20, v20, v34
    v_add_f32 v20, v20, v35
    v_cvt_pk_bf16_f32 v22, v20, v20
    v_lshlrev_b32_e64 v20, 16, v22
    v_and_b32 v21, 0xffff0000, v22
    s_lshl_b32 s17, s15, 7
    s_add_u32 s17, s17, 25231360
    buffer_store_dword v20, v8, s[36:39], s17 offen
    s_endpgm
K0_WD:
    s_load_dwordx2 s[8:9], s[0:1], 112
    s_sub_u32 s10, s2, 352
    s_lshl_b32 s10, s10, 12
    v_lshlrev_b32 v6, 4, v0
    v_mov_b32 v20, 0
    v_mov_b32 v24, -1
    v_mov_b32 v21, 0
    v_mov_b32 v25, -1
    v_mov_b32 v22, 0
    v_mov_b32 v26, -1
    v_mov_b32 v23, 0
    v_mov_b32 v27, -1
    s_waitcnt lgkmcnt(0)
    s_mov_b32 s24, s8
    s_and_b32 s25, s9, 0xffff
    s_mov_b32 s26, 268435456
    s_mov_b32 s27, 0x00020000
    v_lshrrev_b32_e64 v7, 6, v0
    v_mul_u32_u24 v7, 1280, v7
    v_and_b32 v8, 63, v0
    v_mul_u32_u24 v8, 16, v8
    v_add_u32_e64 v7, v7, v8
    s_sub_u32 s11, s2, 352
    s_mul_i32 s12, s11, 5120
    s_add_u32 s17, s12, 29360128
    buffer_store_dword v20, v7, s[24:27], s17 offen
    v_lshrrev_b32_e64 v7, 5, v0
    v_mul_u32_u24 v7, 4224, v7
    v_and_b32_e64 v8, 31, v0
    v_mul_u32_u24 v8, 128, v8
    v_add_u32_e64 v7, v7, v8
    s_mul_i32 s12, s11, 33792
    s_add_u32 s17, s12, 27262976
    buffer_store_dword v20, v7, s[24:27], s17 offen
    s_add_u32 s17, s10, 28311552
    buffer_store_dwordx4 v[24:27], v6, s[24:27], s17 offen
    s_add_u32 s17, s10, 28344320
    buffer_store_dwordx4 v[24:27], v6, s[24:27], s17 offen
    s_add_u32 s17, s10, 28377088
    buffer_store_dwordx4 v[24:27], v6, s[24:27], s17 offen
    s_endpgm
    s_nop 1
K0_END:
    s_endpgm
K0_TWG:
    s_cmp_ge_u32 s2, 872
    s_cbranch_scc1 K0_END
    v_lshrrev_b32 v2, 6, v0
    s_nop 0
    v_readfirstlane_b32 s13, v2
    s_lshr_b32 s10, s2, 1
    s_and_b32 s10, s10, 4
    s_add_u32 s13, s13, s10
    s_waitcnt lgkmcnt(0)
    s_mov_b64 exec, 0
    s_cmp_lg_u32 s13, 0
    s_cbranch_scc1 TCHk0
    s_call_b64 s[68:69], KMPG0
TCHk0:
    s_cmp_lg_u32 s13, 1
    s_cbranch_scc1 TCHk1
    s_call_b64 s[68:69], KMPG1
TCHk1:
    s_cmp_lg_u32 s13, 2
    s_cbranch_scc1 TCHk2
    s_call_b64 s[68:69], KMPG2
TCHk2:
    s_cmp_lg_u32 s13, 3
    s_cbranch_scc1 TCHk3
    s_call_b64 s[68:69], KMPG3
TCHk3:
    s_cmp_lg_u32 s13, 4
    s_cbranch_scc1 TCHk4
    s_call_b64 s[68:69], KMPG4
TCHk4:
    s_cmp_lg_u32 s13, 5
    s_cbranch_scc1 TCHk5
    s_call_b64 s[68:69], KMPG5
TCHk5:
    s_cmp_lg_u32 s13, 6
    s_cbranch_scc1 TCHk6
    s_call_b64 s[68:69], KMPG6
TCHk6:
    s_cmp_lg_u32 s13, 7
    s_cbranch_scc1 TCHk7
    s_call_b64 s[68:69], KMPG7
TCHk7:
    s_mov_b64 exec, -1
    v_readfirstlane_b32 s68, v0
    s_endpgm
.text
K0PG7:
K0PG8:
K0PG9:
K0PG10:
K0PG11:
K0PG12:
K0PG13:
K0PG14:
K0PG15:
K0PG16:
K0PG17:
K0PG18:
K0PG19:
K0PG20:
K0PG21:
K0PG22:
K0RET:
    s_setpc_b64 s[68:69]
.section .rodata,"a"
.p2align 6
.amdhsa_kernel k0_prep_kernel
  .amdhsa_next_free_vgpr 128
  .amdhsa_next_free_sgpr 72
  .amdhsa_accum_offset 128
  .amdhsa_group_segment_fixed_size 0
  .amdhsa_kernarg_size 120
  .amdhsa_user_sgpr_count 2
  .amdhsa_user_sgpr_kernarg_segment_ptr 1
  .amdhsa_system_sgpr_workgroup_id_x 1
  .amdhsa_float_denorm_mode_32 3
.end_amdhsa_kernel
.text
.globl k1_main_kernel
.p2align 12
.p2align 8
.type k1_main_kernel,@function
k1_main_kernel:
    s_cmp_ge_u32 s2, 256
KMPG0:
    s_cbranch_execz KMPG8
    s_cbranch_scc1 KM_END
    s_load_dwordx2 s[8:9], s[0:1], 112
    s_load_dwordx4 s[40:43], s[0:1], 32
    s_load_dwordx4 s[60:63], s[0:1], 56
    s_load_dwordx2 s[6:7], s[0:1], 72
    s_load_dwordx2 s[4:5], s[0:1], 96
    v_lshrrev_b32 v15, 6, v0
    v_and_b32 v1, 63, v0
    v_readfirstlane_b32 s10, v15
    v_lshlrev_b32 v6, 4, v1
    v_and_b32 v31, 255, v0
    v_lshlrev_b32 v29, 4, v31
    v_subrev_u32 v30, 16, v29
    s_and_b32 s15, s10, 3
    s_lshr_b32 s33, s10, 2
    s_lshl_b32 s16, s2, 12
    s_lshl_b32 s17, s15, 10
    s_add_u32 s18, s16, s17
    s_lshl_b32 s20, s33, 20
    s_add_u32 s19, s18, s20
    s_add_u32 s20, s20, s16
    s_mul_i32 s21, s33, 39424
    v_add_u32 v28, s21, v29
    s_add_u32 s21, s21, s17
    s_add_u32 m0, s21, 34816
    s_waitcnt lgkmcnt(0)
    s_add_u32 s40, s40, s20
    s_addc_u32 s41, s41, 0
    s_mov_b32 s56, s40
    s_and_b32 s57, s41, 0xffff
    s_mov_b32 s58, 4096
    s_mov_b32 s59, 0x00020000
    s_mov_b32 s24, s8
    s_and_b32 s25, s9, 0xffff
    s_mov_b32 s26, 268435456
    s_mov_b32 s27, 0x00020000
    buffer_load_dwordx4 v[32:35], v30, s[56:59], 0 offen
    buffer_load_dwordx4 v[36:39], v29, s[56:59], 0 offen
    buffer_load_dwordx4 v6, s[24:27], s19 offen lds
    v_and_b32 v7, 15, v1
    v_lshrrev_b32 v8, 4, v1
    s_cmp_ge_u32 s10, 4
    s_nop 0
    s_cbranch_scc1 KM_AUX
    v_mov_b32 v24, 0
    v_mov_b32 v25, 0
    v_mov_b32 v26, 0
    v_mov_b32 v27, 0
    v_and_b32 v19, 7, v0
    v_lshlrev_b32 v20, 2, v19
    s_mov_b32 s38, 0x8c2ea450
    v_lshrrev_b32 v20, v20, s38
    v_and_b32 v20, 15, v20
    s_movk_i32 s39, 4352
    v_mul_lo_u32 v19, v19, s39
    v_lshl_add_u32 v19, v20, 4, v19
    v_lshrrev_b32_e64 v20, 3, v0
    v_lshl_add_u32 v19, v20, 4, v19
    v_cmp_gt_u32 vcc, 9, v0
    s_and_saveexec_b64 s[36:37], vcc
    ds_write_b128 v19, v[24:27] offset:0
    ds_write_b128 v19, v[24:27] offset:39424
    s_mov_b64 exec, s[36:37]
    v_subrev_u32 v20, 64, v0
    v_add_u32 v21, 39424, v29
    v_cmp_gt_u32 vcc, 30, v20
    s_and_saveexec_b64 s[36:37], vcc
    ds_write_b128 v29, v[24:27] offset:37888
    ds_write_b128 v21, v[24:27] offset:37888
    s_mov_b64 exec, s[36:37]
    v_add_u32 v19, 1, v7
    v_and_b32 v20, 7, v19
    v_lshlrev_b32 v22, 2, v20
    v_lshrrev_b32 v22, v22, s38
    v_and_b32_e64 v22, 15, v22
    v_mul_lo_u32 v20, v20, s39
    v_lshl_add_u32 v20, v22, 4, v20
    v_and_b32_e64 v19, 0x18, v19
    v_lshl_add_u32 v19, v8, 3, v19
    v_lshl_add_u32 v20, v19, 1, v20
    s_lshl_b32 s39, s15, 7
    v_add_u32 v2, s39, v20
    v_lshlrev_b32 v19, 5, v7
    v_lshlrev_b32 v20, 4, v8
    v_sub_u32_e64 v19, v20, v19
    s_add_u32 s38, s39, 35296
    v_add_u32_e64 v3, s38, v19
    v_add_u32 v9, 39424, v2
    v_add_u32 v10, 39424, v3
    v_add_u32_e64 v5, s17, v6
    v_add_u32 v11, 78848, v5
    s_and_b32 s11, s2, 7
    s_lshr_b32 s12, s2, 3
    s_lshr_b32 s13, s11, 1
    s_lshl_b32 s13, s13, 2
    s_and_b32 s14, s12, 3
    s_add_u32 s13, s13, s14
    s_lshr_b32 s14, s12, 2
    s_and_b32 s11, s11, 1
    s_lshl_b32 s34, s11, 2
    s_lshr_b32 s35, s14, 1
    s_add_u32 s34, s34, s35
    s_mul_i32 s33, s35, 1
    s_and_b32 s35, s14, 1
    s_mov_b32 s34, s14
    s_and_b32 s33, s14, 3
    s_and_b32 s36, s12, 3
    s_lshl_b32 s35, s11, 2
    s_sub_u32 s35, s35, s36
    s_mul_i32 s36, s13, 37
    s_lshr_b32 s36, s36, 8
    s_mul_i32 s37, s36, 7
    s_sub_u32 s37, s13, s37
    s_and_b32 s36, s36, 1
    s_cmp_eq_u32 s14, 7
    s_cselect_b32 s12, s37, s14
    s_cselect_b32 s32, s36, 0
    s_mul_i32 s36, s11, 7
    s_add_u32 s12, s12, s36
    s_mov_b32 s44, s60
    s_and_b32 s45, s61, 0xffff
    s_mov_b32 s46, 1835008
    s_mov_b32 s47, 0x00020000
    s_mov_b32 s48, s62
    s_and_b32 s49, s63, 0xffff
    s_mov_b32 s50, 1835008
    s_mov_b32 s51, 0x00020000
    s_mov_b32 s52, s6
    s_and_b32 s53, s7, 0xffff
    s_mov_b32 s54, 1835008
    s_mov_b32 s55, 0x00020000
    s_mov_b32 s28, s4
    s_and_b32 s29, s5, 0xffff
    s_mov_b32 s30, 2097152
    s_mov_b32 s31, 0x00020000
    s_mul_i32 s22, s32, 917504
    s_mul_i32 s36, s15, 3584
    s_add_u32 s22, s22, s36
    s_lshl_b32 s36, s12, 8
    s_add_u32 s22, s22, s36
    s_mul_i32 s23, s15, 1056
    v_lshrrev_b32 v12, 3, v1
    v_and_b32_e64 v13, 7, v1
    v_lshlrev_b32 v13, 4, v13
    s_movk_i32 s36, 14336
    v_mul_lo_u32 v14, v12, s36
    v_lshl_add_u32 v13, v12, 12, v13
    v_and_b32_e64 v12, 7, v1
    v_lshl_add_u32 v12, v12, 4, v14
    s_waitcnt vmcnt(1)
    ds_write_b128 v28, v[36:39] offset:32
    ds_write_b128 v28, v[34:37] offset:17648
    v_mov_b32 v40, v33
    v_mov_b32 v41, v34
    v_mov_b32 v42, v35
    v_mov_b32 v43, v36
    v_mov_b32 v44, v37
    v_mov_b32_e64 v45, v38
    ds_write_b128 v28, v[40:43] offset:8784
    ds_write_b128 v28, v[42:45] offset:26320
    v_alignbit_b32 v46, v33, v32, 16
    v_alignbit_b32 v47, v34, v33, 16
    v_alignbit_b32 v48, v35, v34, 16
    v_alignbit_b32 v49, v36, v35, 16
    v_alignbit_b32 v50, v37, v36, 16
    v_alignbit_b32 v51, v38, v37, 16
    ds_write_b128 v28, v[46:49] offset:4448
    ds_write_b128 v28, v[48:51] offset:21808
    v_alignbit_b32 v52, v34, v33, 16
    v_alignbit_b32 v53, v35, v34, 16
    v_alignbit_b32 v54, v36, v35, 16
    v_alignbit_b32 v55, v37, v36, 16
    v_alignbit_b32 v56, v38, v37, 16
KMPG1:
    s_cbranch_execz KMPG9
    v_alignbit_b32 v57, v39, v38, 16
    ds_write_b128 v28, v[52:55] offset:13232
    ds_write_b128 v28, v[54:57] offset:30608
    s_waitcnt vmcnt(0)
    s_waitcnt lgkmcnt(0)
    s_barrier
    ds_read_b128 v[192:195], v2 offset:0
    ds_read_b128 v[224:227], v3 offset:3584
    ds_read_b128 v[228:231], v3 offset:3072
    ds_read_b128 v[232:235], v3 offset:2560
    ds_read_b128 v[236:239], v3 offset:2048
    ds_read_b128 v[240:243], v3 offset:1536
    ds_read_b128 v[244:247], v3 offset:1024
    ds_read_b128 v[248:251], v3 offset:512
    ds_read_b128 v[252:255], v3 offset:0
    ds_read_b128 v[196:199], v2 offset:512
    ds_read_b128 v[200:203], v2 offset:1024
    ds_read_b128 v[204:207], v2 offset:1536
    ds_read_b128 v[208:211], v2 offset:2048
    ds_read_b128 v[212:215], v2 offset:2560
    ds_read_b128 v[216:219], v2 offset:3072
    ds_read_b128 v[220:223], v2 offset:3584
    s_waitcnt lgkmcnt(15)
    s_waitcnt lgkmcnt(14)
    v_mfma_f32_16x16x32_bf16 v[32:35], v[192:195], v[224:227], 0
    s_waitcnt lgkmcnt(13)
    v_mfma_f32_16x16x32_bf16 v[36:39], v[192:195], v[228:231], 0
    s_waitcnt lgkmcnt(12)
    v_mfma_f32_16x16x32_bf16 v[40:43], v[192:195], v[232:235], 0
    s_waitcnt lgkmcnt(11)
    v_mfma_f32_16x16x32_bf16 v[44:47], v[192:195], v[236:239], 0
    s_waitcnt lgkmcnt(10)
    v_mfma_f32_16x16x32_bf16 v[48:51], v[192:195], v[240:243], 0
    s_waitcnt lgkmcnt(9)
    v_mfma_f32_16x16x32_bf16 v[52:55], v[192:195], v[244:247], 0
    s_waitcnt lgkmcnt(8)
    v_mfma_f32_16x16x32_bf16 v[56:59], v[192:195], v[248:251], 0
    s_waitcnt lgkmcnt(7)
    v_mfma_f32_16x16x32_bf16 v[60:63], v[192:195], v[252:255], 0
    s_waitcnt lgkmcnt(6)
    v_mfma_f32_16x16x32_bf16 v[36:39], v[196:199], v[224:227], v[36:39]
    v_mfma_f32_16x16x32_bf16 v[40:43], v[196:199], v[228:231], v[40:43]
    v_mfma_f32_16x16x32_bf16 v[44:47], v[196:199], v[232:235], v[44:47]
    ds_read_b128 v[128:131], v2 offset:64
    v_mfma_f32_16x16x32_bf16 v[48:51], v[196:199], v[236:239], v[48:51]
    ds_read_b128 v[160:163], v3 offset:3648
    v_mfma_f32_16x16x32_bf16 v[52:55], v[196:199], v[240:243], v[52:55]
    ds_read_b128 v[164:167], v3 offset:3136
    v_mfma_f32_16x16x32_bf16 v[56:59], v[196:199], v[244:247], v[56:59]
    ds_read_b128 v[168:171], v3 offset:2624
    v_mfma_f32_16x16x32_bf16 v[60:63], v[196:199], v[248:251], v[60:63]
    ds_read_b128 v[172:175], v3 offset:2112
    s_waitcnt lgkmcnt(10)
    v_mfma_f32_16x16x32_bf16 v[40:43], v[200:203], v[224:227], v[40:43]
    ds_read_b128 v[176:179], v3 offset:1600
    v_mfma_f32_16x16x32_bf16 v[44:47], v[200:203], v[228:231], v[44:47]
    ds_read_b128 v[180:183], v3 offset:1088
    v_mfma_f32_16x16x32_bf16 v[48:51], v[200:203], v[232:235], v[48:51]
    ds_read_b128 v[184:187], v3 offset:576
    v_mfma_f32_16x16x32_bf16 v[52:55], v[200:203], v[236:239], v[52:55]
    ds_read_b128 v[188:191], v3 offset:64
    v_mfma_f32_16x16x32_bf16 v[56:59], v[200:203], v[240:243], v[56:59]
    ds_read_b128 v[132:135], v2 offset:576
    v_mfma_f32_16x16x32_bf16 v[60:63], v[200:203], v[244:247], v[60:63]
    ds_read_b128 v[136:139], v2 offset:1088
    s_waitcnt lgkmcnt(15)
    v_mfma_f32_16x16x32_bf16 v[44:47], v[204:207], v[224:227], v[44:47]
    ds_read_b128 v[140:143], v2 offset:1600
    v_mfma_f32_16x16x32_bf16 v[48:51], v[204:207], v[228:231], v[48:51]
    ds_read_b128 v[144:147], v2 offset:2112
    v_mfma_f32_16x16x32_bf16 v[52:55], v[204:207], v[232:235], v[52:55]
    ds_read_b128 v[148:151], v2 offset:2624
    v_mfma_f32_16x16x32_bf16 v[56:59], v[204:207], v[236:239], v[56:59]
    ds_read_b128 v[152:155], v2 offset:3136
    v_mfma_f32_16x16x32_bf16 v[60:63], v[204:207], v[240:243], v[60:63]
    ds_read_b128 v[156:159], v2 offset:3648
    s_waitcnt lgkmcnt(15)
    v_mfma_f32_16x16x32_bf16 v[48:51], v[208:211], v[224:227], v[48:51]
    v_mfma_f32_16x16x32_bf16 v[52:55], v[208:211], v[228:231], v[52:55]
    v_mfma_f32_16x16x32_bf16 v[56:59], v[208:211], v[232:235], v[56:59]
    v_mfma_f32_16x16x32_bf16 v[60:63], v[208:211], v[236:239], v[60:63]
    v_mfma_f32_16x16x32_bf16 v[60:63], v[220:223], v[224:227], v[60:63]
    v_mfma_f32_16x16x32_bf16 v[52:55], v[212:215], v[224:227], v[52:55]
    v_mfma_f32_16x16x32_bf16 v[56:59], v[212:215], v[228:231], v[56:59]
    v_mfma_f32_16x16x32_bf16 v[60:63], v[212:215], v[232:235], v[60:63]
    v_mfma_f32_16x16x32_bf16 v[56:59], v[216:219], v[224:227], v[56:59]
    v_mfma_f32_16x16x32_bf16 v[60:63], v[216:219], v[228:231], v[60:63]
    s_waitcnt lgkmcnt(13)
    v_mfma_f32_16x16x32_bf16 v[36:39], v[128:131], v[164:167], v[36:39]
    v_mfma_f32_16x16x32_bf16 v[32:35], v[128:131], v[160:163], v[32:35]
    s_waitcnt lgkmcnt(6)
    v_mfma_f32_16x16x32_bf16 v[36:39], v[132:135], v[160:163], v[36:39]
    v_mfma_f32_16x16x32_bf16 v[44:47], v[128:131], v[172:175], v[44:47]
    v_mfma_f32_16x16x32_bf16 v[40:43], v[128:131], v[168:171], v[40:43]
    s_nop 3
    ds_write_b128 v11, v[32:35] offset:0
    v_mfma_f32_16x16x32_bf16 v[44:47], v[132:135], v[168:171], v[44:47]
    ds_write_b128 v11, v[36:39] offset:4096
    v_mfma_f32_16x16x32_bf16 v[40:43], v[132:135], v[164:167], v[40:43]
    s_waitcnt lgkmcnt(7)
    v_mfma_f32_16x16x32_bf16 v[44:47], v[136:139], v[164:167], v[44:47]
    v_mfma_f32_16x16x32_bf16 v[40:43], v[136:139], v[160:163], v[40:43]
    s_waitcnt lgkmcnt(6)
    v_mfma_f32_16x16x32_bf16 v[44:47], v[140:143], v[160:163], v[44:47]
    v_mfma_f32_16x16x32_bf16 v[52:55], v[128:131], v[180:183], v[52:55]
    v_mfma_f32_16x16x32_bf16 v[48:51], v[128:131], v[176:179], v[48:51]
    s_nop 3
    ds_write_b128 v11, v[40:43] offset:8192
    v_mfma_f32_16x16x32_bf16 v[52:55], v[132:135], v[176:179], v[52:55]
    ds_write_b128 v11, v[44:47] offset:12288
    v_mfma_f32_16x16x32_bf16 v[48:51], v[132:135], v[172:175], v[48:51]
    v_mfma_f32_16x16x32_bf16 v[52:55], v[136:139], v[172:175], v[52:55]
    v_mfma_f32_16x16x32_bf16 v[48:51], v[136:139], v[168:171], v[48:51]
    v_mfma_f32_16x16x32_bf16 v[52:55], v[140:143], v[168:171], v[52:55]
    v_mfma_f32_16x16x32_bf16 v[48:51], v[140:143], v[164:167], v[48:51]
    s_waitcnt lgkmcnt(7)
    v_mfma_f32_16x16x32_bf16 v[52:55], v[144:147], v[164:167], v[52:55]
    v_mfma_f32_16x16x32_bf16 v[48:51], v[144:147], v[160:163], v[48:51]
    s_waitcnt lgkmcnt(6)
    v_mfma_f32_16x16x32_bf16 v[52:55], v[148:151], v[160:163], v[52:55]
    v_mfma_f32_16x16x32_bf16 v[60:63], v[128:131], v[188:191], v[60:63]
    v_mfma_f32_16x16x32_bf16 v[56:59], v[128:131], v[184:187], v[56:59]
    s_nop 3
    ds_write_b128 v11, v[48:51] offset:16384
    v_mfma_f32_16x16x32_bf16 v[60:63], v[132:135], v[184:187], v[60:63]
    ds_write_b128 v11, v[52:55] offset:20480
    v_mfma_f32_16x16x32_bf16 v[56:59], v[132:135], v[180:183], v[56:59]
    v_mfma_f32_16x16x32_bf16 v[60:63], v[136:139], v[180:183], v[60:63]
    v_mfma_f32_16x16x32_bf16 v[56:59], v[136:139], v[176:179], v[56:59]
    v_mfma_f32_16x16x32_bf16 v[60:63], v[140:143], v[176:179], v[60:63]
    v_mfma_f32_16x16x32_bf16 v[56:59], v[140:143], v[172:175], v[56:59]
    v_mfma_f32_16x16x32_bf16 v[60:63], v[144:147], v[172:175], v[60:63]
    v_mfma_f32_16x16x32_bf16 v[56:59], v[144:147], v[168:171], v[56:59]
    v_mfma_f32_16x16x32_bf16 v[60:63], v[148:151], v[168:171], v[60:63]
    v_mfma_f32_16x16x32_bf16 v[56:59], v[148:151], v[164:167], v[56:59]
    s_waitcnt lgkmcnt(7)
    v_mfma_f32_16x16x32_bf16 v[60:63], v[152:155], v[164:167], v[60:63]
    v_mfma_f32_16x16x32_bf16 v[56:59], v[152:155], v[160:163], v[56:59]
    s_waitcnt lgkmcnt(6)
    v_mfma_f32_16x16x32_bf16 v[60:63], v[156:159], v[160:163], v[60:63]
    s_nop 5
    ds_write_b128 v11, v[56:59] offset:24576
KMPG2:
    s_cbranch_execz KMPG10
    s_nop 0
    ds_write_b128 v11, v[60:63] offset:28672
    s_waitcnt lgkmcnt(0)
    s_barrier
    ds_read_b128 v[192:195], v9 offset:0
    ds_read_b128 v[224:227], v10 offset:3584
    ds_read_b128 v[228:231], v10 offset:3072
    ds_read_b128 v[232:235], v10 offset:2560
    ds_read_b128 v[236:239], v10 offset:2048
    ds_read_b128 v[240:243], v10 offset:1536
    ds_read_b128 v[244:247], v10 offset:1024
    ds_read_b128 v[248:251], v10 offset:512
    ds_read_b128 v[252:255], v10 offset:0
    ds_read_b128 v[196:199], v9 offset:512
    ds_read_b128 v[200:203], v9 offset:1024
    ds_read_b128 v[204:207], v9 offset:1536
    ds_read_b128 v[208:211], v9 offset:2048
    ds_read_b128 v[212:215], v9 offset:2560
    ds_read_b128 v[216:219], v9 offset:3072
    ds_read_b128 v[220:223], v9 offset:3584
    s_waitcnt lgkmcnt(15)
    s_waitcnt lgkmcnt(14)
    v_mfma_f32_16x16x32_bf16 v[32:35], v[192:195], v[224:227], 0
    s_waitcnt lgkmcnt(13)
    v_mfma_f32_16x16x32_bf16 v[36:39], v[192:195], v[228:231], 0
    s_waitcnt lgkmcnt(12)
    v_mfma_f32_16x16x32_bf16 v[40:43], v[192:195], v[232:235], 0
    s_waitcnt lgkmcnt(11)
    v_mfma_f32_16x16x32_bf16 v[44:47], v[192:195], v[236:239], 0
    s_waitcnt lgkmcnt(10)
    v_mfma_f32_16x16x32_bf16 v[48:51], v[192:195], v[240:243], 0
    s_waitcnt lgkmcnt(9)
    v_mfma_f32_16x16x32_bf16 v[52:55], v[192:195], v[244:247], 0
    s_waitcnt lgkmcnt(8)
    v_mfma_f32_16x16x32_bf16 v[56:59], v[192:195], v[248:251], 0
    s_waitcnt lgkmcnt(7)
    v_mfma_f32_16x16x32_bf16 v[60:63], v[192:195], v[252:255], 0
    s_waitcnt lgkmcnt(6)
    v_mfma_f32_16x16x32_bf16 v[36:39], v[196:199], v[224:227], v[36:39]
    v_mfma_f32_16x16x32_bf16 v[40:43], v[196:199], v[228:231], v[40:43]
    v_mfma_f32_16x16x32_bf16 v[44:47], v[196:199], v[232:235], v[44:47]
    ds_read_b128 v[128:131], v9 offset:64
    v_mfma_f32_16x16x32_bf16 v[48:51], v[196:199], v[236:239], v[48:51]
    ds_read_b128 v[160:163], v10 offset:3648
    v_mfma_f32_16x16x32_bf16 v[52:55], v[196:199], v[240:243], v[52:55]
    ds_read_b128 v[164:167], v10 offset:3136
    v_mfma_f32_16x16x32_bf16 v[56:59], v[196:199], v[244:247], v[56:59]
    ds_read_b128 v[168:171], v10 offset:2624
    v_mfma_f32_16x16x32_bf16 v[60:63], v[196:199], v[248:251], v[60:63]
    ds_read_b128 v[172:175], v10 offset:2112
    s_waitcnt lgkmcnt(10)
    v_mfma_f32_16x16x32_bf16 v[40:43], v[200:203], v[224:227], v[40:43]
    ds_read_b128 v[176:179], v10 offset:1600
    v_mfma_f32_16x16x32_bf16 v[44:47], v[200:203], v[228:231], v[44:47]
    ds_read_b128 v[180:183], v10 offset:1088
    v_mfma_f32_16x16x32_bf16 v[48:51], v[200:203], v[232:235], v[48:51]
    ds_read_b128 v[184:187], v10 offset:576
    v_mfma_f32_16x16x32_bf16 v[52:55], v[200:203], v[236:239], v[52:55]
    ds_read_b128 v[188:191], v10 offset:64
    v_mfma_f32_16x16x32_bf16 v[56:59], v[200:203], v[240:243], v[56:59]
    ds_read_b128 v[132:135], v9 offset:576
    v_mfma_f32_16x16x32_bf16 v[60:63], v[200:203], v[244:247], v[60:63]
    ds_read_b128 v[136:139], v9 offset:1088
    s_waitcnt lgkmcnt(15)
    v_mfma_f32_16x16x32_bf16 v[44:47], v[204:207], v[224:227], v[44:47]
    ds_read_b128 v[140:143], v9 offset:1600
    v_mfma_f32_16x16x32_bf16 v[48:51], v[204:207], v[228:231], v[48:51]
    ds_read_b128 v[144:147], v9 offset:2112
    v_mfma_f32_16x16x32_bf16 v[52:55], v[204:207], v[232:235], v[52:55]
    ds_read_b128 v[148:151], v9 offset:2624
    v_mfma_f32_16x16x32_bf16 v[56:59], v[204:207], v[236:239], v[56:59]
    ds_read_b128 v[152:155], v9 offset:3136
    v_mfma_f32_16x16x32_bf16 v[60:63], v[204:207], v[240:243], v[60:63]
    ds_read_b128 v[156:159], v9 offset:3648
    s_waitcnt lgkmcnt(15)
    v_mfma_f32_16x16x32_bf16 v[48:51], v[208:211], v[224:227], v[48:51]
    v_mfma_f32_16x16x32_bf16 v[52:55], v[208:211], v[228:231], v[52:55]
    v_mfma_f32_16x16x32_bf16 v[56:59], v[208:211], v[232:235], v[56:59]
    v_mfma_f32_16x16x32_bf16 v[60:63], v[208:211], v[236:239], v[60:63]
    v_mfma_f32_16x16x32_bf16 v[60:63], v[220:223], v[224:227], v[60:63]
    v_mfma_f32_16x16x32_bf16 v[52:55], v[212:215], v[224:227], v[52:55]
    v_mfma_f32_16x16x32_bf16 v[56:59], v[212:215], v[228:231], v[56:59]
    v_mfma_f32_16x16x32_bf16 v[60:63], v[212:215], v[232:235], v[60:63]
    v_mfma_f32_16x16x32_bf16 v[56:59], v[216:219], v[224:227], v[56:59]
    v_mfma_f32_16x16x32_bf16 v[60:63], v[216:219], v[228:231], v[60:63]
    s_waitcnt lgkmcnt(13)
    v_mfma_f32_16x16x32_bf16 v[36:39], v[128:131], v[164:167], v[36:39]
    v_mfma_f32_16x16x32_bf16 v[32:35], v[128:131], v[160:163], v[32:35]
    s_waitcnt lgkmcnt(6)
    v_mfma_f32_16x16x32_bf16 v[36:39], v[132:135], v[160:163], v[36:39]
    v_mfma_f32_16x16x32_bf16 v[44:47], v[128:131], v[172:175], v[44:47]
    v_mfma_f32_16x16x32_bf16 v[40:43], v[128:131], v[168:171], v[40:43]
    s_nop 3
    ds_write_b128 v5, v[32:35] offset:0
    v_mfma_f32_16x16x32_bf16 v[44:47], v[132:135], v[168:171], v[44:47]
    ds_write_b128 v5, v[36:39] offset:4096
    v_mfma_f32_16x16x32_bf16 v[40:43], v[132:135], v[164:167], v[40:43]
    s_waitcnt lgkmcnt(7)
    v_mfma_f32_16x16x32_bf16 v[44:47], v[136:139], v[164:167], v[44:47]
    v_mfma_f32_16x16x32_bf16 v[40:43], v[136:139], v[160:163], v[40:43]
    s_waitcnt lgkmcnt(6)
    v_mfma_f32_16x16x32_bf16 v[44:47], v[140:143], v[160:163], v[44:47]
    v_mfma_f32_16x16x32_bf16 v[52:55], v[128:131], v[180:183], v[52:55]
    v_mfma_f32_16x16x32_bf16 v[48:51], v[128:131], v[176:179], v[48:51]
    s_nop 3
    ds_write_b128 v5, v[40:43] offset:8192
    v_mfma_f32_16x16x32_bf16 v[52:55], v[132:135], v[176:179], v[52:55]
    ds_write_b128 v5, v[44:47] offset:12288
    v_mfma_f32_16x16x32_bf16 v[48:51], v[132:135], v[172:175], v[48:51]
    v_mfma_f32_16x16x32_bf16 v[52:55], v[136:139], v[172:175], v[52:55]
    v_mfma_f32_16x16x32_bf16 v[48:51], v[136:139], v[168:171], v[48:51]
    v_mfma_f32_16x16x32_bf16 v[52:55], v[140:143], v[168:171], v[52:55]
    v_mfma_f32_16x16x32_bf16 v[48:51], v[140:143], v[164:167], v[48:51]
    s_waitcnt lgkmcnt(7)
    v_mfma_f32_16x16x32_bf16 v[52:55], v[144:147], v[164:167], v[52:55]
    v_mfma_f32_16x16x32_bf16 v[48:51], v[144:147], v[160:163], v[48:51]
    s_waitcnt lgkmcnt(6)
    v_mfma_f32_16x16x32_bf16 v[52:55], v[148:151], v[160:163], v[52:55]
    v_mfma_f32_16x16x32_bf16 v[60:63], v[128:131], v[188:191], v[60:63]
    v_mfma_f32_16x16x32_bf16 v[56:59], v[128:131], v[184:187], v[56:59]
    s_nop 3
    ds_write_b128 v5, v[48:51] offset:16384
    v_mfma_f32_16x16x32_bf16 v[60:63], v[132:135], v[184:187], v[60:63]
    ds_write_b128 v5, v[52:55] offset:20480
    v_mfma_f32_16x16x32_bf16 v[56:59], v[132:135], v[180:183], v[56:59]
    v_mfma_f32_16x16x32_bf16 v[60:63], v[136:139], v[180:183], v[60:63]
    v_mfma_f32_16x16x32_bf16 v[56:59], v[136:139], v[176:179], v[56:59]
    v_mfma_f32_16x16x32_bf16 v[60:63], v[140:143], v[176:179], v[60:63]
    v_mfma_f32_16x16x32_bf16 v[56:59], v[140:143], v[172:175], v[56:59]
    v_mfma_f32_16x16x32_bf16 v[60:63], v[144:147], v[172:175], v[60:63]
    v_mfma_f32_16x16x32_bf16 v[56:59], v[144:147], v[168:171], v[56:59]
    v_mfma_f32_16x16x32_bf16 v[60:63], v[148:151], v[168:171], v[60:63]
    v_mfma_f32_16x16x32_bf16 v[56:59], v[148:151], v[164:167], v[56:59]
    s_waitcnt lgkmcnt(7)
    v_mfma_f32_16x16x32_bf16 v[60:63], v[152:155], v[164:167], v[60:63]
    v_mfma_f32_16x16x32_bf16 v[56:59], v[152:155], v[160:163], v[56:59]
    s_waitcnt lgkmcnt(6)
    v_mfma_f32_16x16x32_bf16 v[60:63], v[156:159], v[160:163], v[60:63]
    s_nop 5
    ds_write_b128 v5, v[56:59] offset:24576
    s_nop 0
    ds_write_b128 v5, v[60:63] offset:28672
KMPG3:
    s_cbranch_execz KMPG11
    s_waitcnt lgkmcnt(0)
    v_lshrrev_b32 v20, 4, v1
    v_lshlrev_b32_e64 v20, 15, v20
    v_lshl_add_u32 v20, v7, 4, v20
    v_mul_u32_u24 v21, 16, v1
    s_lshr_b32 s36, s13, 2
    s_lshl_b32 s36, s36, 2
    s_add_u32 s36, s36, s15
    s_mul_i32 s36, s36, 1
    s_and_b32 s37, s13, 3
    s_lshl_b32 s37, s37, 3
    s_add_u32 s37, s37, s14
    s_lshr_b32 s37, s37, 5
    s_add_u32 s36, s36, s37
    s_mul_i32 s36, s36, 1280
    s_add_u32 s64, s36, 29360128
    s_lshl_b32 s65, s15, 12
    s_lshl_b32 s36, s13, 8
    s_add_u32 s65, s65, s36
    s_barrier
    s_barrier
    s_branch KM_COMPUTE
KM_AUX:
    v_lshlrev_b32_e64 v9, 5, v7
    v_lshl_add_u32 v9, v8, 3, v9
    v_lshlrev_b32_e64 v18, 1, v9
    s_add_u32 s36, s18, 2097152
    s_lshl_b32 s37, s15, 11
    s_add_u32 s38, s37, 25165824
    s_add_u32 s39, s37, 25174016
    s_sub_u32 s37, 3576, s17
    v_sub_u32 v5, s37, v9
    buffer_load_dwordx2 v[80:81], v9, s[24:27], s36 offen offset:0
    buffer_load_dwordx4 v[64:67], v18, s[24:27], s38 offen offset:0
    buffer_load_dwordx4 v[72:75], v18, s[24:27], s39 offen offset:0
    buffer_load_dwordx2 v[82:83], v9, s[24:27], s36 offen offset:512
    buffer_load_dwordx4 v[68:71], v18, s[24:27], s38 offen offset:1024
    buffer_load_dwordx4 v[76:79], v18, s[24:27], s39 offen offset:1024
    buffer_load_dwordx2 v[88:89], v5, s[24:27], s16 offen offset:512
    buffer_load_dwordx2 v[90:91], v5, s[24:27], s16 offen offset:0
    s_add_u32 s36, s36, 0x100000
    s_add_u32 s37, s16, 0x100000
    buffer_load_dwordx2 v[84:85], v9, s[24:27], s36 offen offset:0
    buffer_load_dwordx2 v[92:93], v5, s[24:27], s37 offen offset:512
    buffer_load_dwordx2 v[86:87], v9, s[24:27], s36 offen offset:512
    buffer_load_dwordx2 v[94:95], v5, s[24:27], s37 offen offset:0
    s_lshl_b32 s19, s2, 2
    s_add_u32 s19, s19, 25231360
    s_lshl_b32 s20, s2, 1
    s_and_b32 s20, s20, 0xfffffffc
    s_add_u32 s36, s19, 0
    s_load_dword s64, s[8:9], s36
    s_add_u32 s36, s19, 2048
    s_load_dword s65, s[8:9], s36
    s_add_u32 s36, s19, 4096
    s_load_dword s66, s[8:9], s36
    s_add_u32 s36, s19, 8192
    s_load_dword s67, s[8:9], s36
    s_add_u32 s36, s20, 0
    s_load_dword s3, s[42:43], s36
    s_add_u32 s36, s19, 1024
    s_load_dword s0, s[8:9], s36
    s_add_u32 s36, s19, 3072
    s_load_dword s1, s[8:9], s36
    s_add_u32 s36, s19, 5120
    s_load_dword s70, s[8:9], s36
    s_add_u32 s36, s19, 9216
    s_load_dword s71, s[8:9], s36
    s_add_u32 s36, s20, 512
    s_load_dword s21, s[42:43], s36
    s_waitcnt vmcnt(13)
    ds_write_b128 v28, v[36:39] offset:32
    ds_write_b128 v28, v[34:37] offset:17648
    v_mov_b32 v40, v33
    v_mov_b32 v41, v34
    v_mov_b32 v42, v35
    v_mov_b32 v43, v36
    v_mov_b32 v44, v37
    v_mov_b32 v45, v38
    ds_write_b128 v28, v[40:43] offset:8784
    ds_write_b128 v28, v[42:45] offset:26320
    v_alignbit_b32 v46, v33, v32, 16
    v_alignbit_b32 v47, v34, v33, 16
    v_alignbit_b32 v48, v35, v34, 16
    v_alignbit_b32 v49, v36, v35, 16
    v_alignbit_b32 v50, v37, v36, 16
    v_alignbit_b32 v51, v38, v37, 16
    ds_write_b128 v28, v[46:49] offset:4448
    ds_write_b128 v28, v[48:51] offset:21808
    v_alignbit_b32 v52, v34, v33, 16
    v_alignbit_b32 v53, v35, v34, 16
    v_alignbit_b32 v54, v36, v35, 16
    v_alignbit_b32 v55, v37, v36, 16
    v_alignbit_b32 v56, v38, v37, 16
    v_alignbit_b32 v57, v39, v38, 16
    ds_write_b128 v28, v[52:55] offset:13232
    ds_write_b128 v28, v[54:57] offset:30608
    s_barrier
    s_setprio 3
    s_and_b32 s11, s2, 7
    s_lshr_b32 s12, s2, 3
    s_lshr_b32 s13, s11, 1
    s_lshl_b32 s13, s13, 2
    s_and_b32 s14, s12, 3
    s_add_u32 s13, s13, s14
    s_lshr_b32 s14, s12, 2
    s_and_b32 s11, s11, 1
    s_lshl_b32 s34, s11, 2
    s_lshr_b32 s35, s14, 1
    s_add_u32 s34, s34, s35
    s_mul_i32 s33, s35, 1
    s_and_b32 s35, s14, 1
    s_mov_b32 s34, s14
    s_and_b32 s33, s14, 3
    s_and_b32 s36, s12, 3
    s_lshl_b32 s35, s11, 2
    s_sub_u32 s35, s35, s36
    s_mul_i32 s36, s13, 37
    s_lshr_b32 s36, s36, 8
    s_mul_i32 s37, s36, 7
    s_sub_u32 s37, s13, s37
    s_and_b32 s36, s36, 1
    s_cmp_eq_u32 s14, 7
    s_cselect_b32 s12, s37, s14
    s_cselect_b32 s32, s36, 0
    s_mul_i32 s36, s11, 7
    s_add_u32 s12, s12, s36
    s_mov_b32 s44, s60
    s_and_b32 s45, s61, 0xffff
    s_mov_b32 s46, 1835008
    s_mov_b32 s47, 0x00020000
    s_mov_b32 s48, s62
    s_and_b32 s49, s63, 0xffff
    s_mov_b32 s50, 1835008
    s_mov_b32 s51, 0x00020000
    s_mov_b32 s52, s6
    s_and_b32 s53, s7, 0xffff
    s_mov_b32 s54, 1835008
    s_mov_b32 s55, 0x00020000
    s_mov_b32 s28, s4
    s_and_b32 s29, s5, 0xffff
    s_mov_b32 s30, 2097152
    s_mov_b32 s31, 0x00020000
    s_mul_i32 s22, s32, 917504
    s_mul_i32 s36, s15, 3584
    s_add_u32 s22, s22, s36
    s_lshl_b32 s36, s12, 8
    s_add_u32 s22, s22, s36
    s_mul_i32 s23, s15, 1056
    v_lshrrev_b32 v12, 3, v1
    v_and_b32_e64 v13, 7, v1
    v_lshlrev_b32 v13, 4, v13
    s_movk_i32 s36, 14336
    v_mul_lo_u32 v14, v12, s36
    v_lshl_add_u32 v13, v12, 12, v13
    v_and_b32_e64 v12, 7, v1
    v_lshl_add_u32 v12, v12, 4, v14
    s_mul_i32 s19, s15, 7
    s_lshl_b32 s20, s34, 7
    v_and_b32 v23, 7, v7
    v_lshlrev_b32 v23, 4, v23
    v_lshl_add_u32 v23, v8, 12, v23
    v_lshrrev_b32_e64 v19, 3, v7
    v_lshl_add_u32 v23, v19, 14, v23
    s_add_u32 s36, s22, 0
    s_add_u32 m0, s23, 113152
    s_nop 0
KMPG4:
    s_cbranch_execz KMPG12
    buffer_load_dwordx4 v12, s[44:47], s36 offen lds
    s_add_u32 m0, s23, 117376
    s_nop 0
    buffer_load_dwordx4 v12, s[48:51], s36 offen lds
    s_add_u32 s36, s22, 128
    s_add_u32 m0, s23, 121600
    s_nop 0
    buffer_load_dwordx4 v12, s[44:47], s36 offen lds
    s_add_u32 m0, s23, 125824
    s_nop 0
    buffer_load_dwordx4 v12, s[48:51], s36 offen lds
    s_add_u32 s36, s19, 0
    s_and_b32 s37, s36, 1
    s_lshl_b32 s36, s36, 16
    s_lshl_b32 s37, s37, 15
    s_sub_u32 s36, s36, s37
    s_add_u32 s36, s36, s20
    buffer_load_dwordx4 v[144:147], v23, s[52:55], s36 offen offset:0
    buffer_load_dwordx4 v[148:151], v23, s[52:55], s36 offen offset:1024
    buffer_load_dwordx4 v[152:155], v23, s[52:55], s36 offen offset:2048
    buffer_load_dwordx4 v[156:159], v23, s[52:55], s36 offen offset:3072
    s_add_u32 s36, s19, 1
    s_and_b32 s37, s36, 1
    s_lshl_b32 s36, s36, 16
    s_lshl_b32 s37, s37, 15
    s_sub_u32 s36, s36, s37
    s_add_u32 s36, s36, s20
    buffer_load_dwordx4 v[160:163], v23, s[52:55], s36 offen offset:0
    buffer_load_dwordx4 v[164:167], v23, s[52:55], s36 offen offset:1024
    buffer_load_dwordx4 v[168:171], v23, s[52:55], s36 offen offset:2048
    buffer_load_dwordx4 v[172:175], v23, s[52:55], s36 offen offset:3072
    s_lshl_b32 s36, s15, 13
    v_add_u32 v4, s36, v6
    v_add_u32 v10, 78848, v4
    v_and_b32 v11, 1, v8
    v_lshlrev_b32 v11, 9, v11
    v_lshl_add_u32 v11, v7, 5, v11
    v_lshrrev_b32_e64 v15, 1, v8
    v_lshl_add_u32 v11, v15, 4, v11
    s_mov_b32 s40, 0x05040100
    s_mov_b32 s41, 0x07060302
    s_and_b32 s36, s2, 3
    s_lshl_b32 s37, s15, 2
    s_add_u32 s36, s36, s37
    s_mul_i32 s36, s36, 1280
    s_lshr_b32 s37, s2, 2
    s_mul_i32 s37, s37, 16
    s_add_u32 s36, s36, s37
    s_add_u32 s43, s36, 29360128
    v_mul_u32_u24 v16, 1280, v1
    v_mov_b32 v17, 1
    s_waitcnt lgkmcnt(0)
    v_mov_b32 v22, s65
    v_mov_b32 v20, s67
    v_add_f32 v22, 1.0, v22
    v_add_f32 v20, 1.0, v20
    v_cvt_pk_bf16_f32 v22, 0, v22
    v_cvt_pk_bf16_f32 v20, 0, v20
    s_and_b32 s36, s3, 0xffff0000
    s_lshl_b32 s39, s3, 16
    s_bitcmp1_b32 s2, 0
    s_cselect_b32 s3, s36, s39
    v_mov_b32 v24, s1
    v_mov_b32 v21, s71
    v_add_f32 v24, 1.0, v24
    v_add_f32_e64 v21, 1.0, v21
    v_cvt_pk_bf16_f32 v24, 0, v24
    v_cvt_pk_bf16_f32 v21, 0, v21
    s_and_b32 s36, s21, 0xffff0000
    s_lshl_b32 s39, s21, 16
    s_bitcmp1_b32 s2, 0
    s_cselect_b32 s21, s36, s39
    s_waitcnt vmcnt(12)
    v_lshlrev_b32_e64 v96, 16, v80
    s_add_u32 s36, s22, 114688
    s_add_u32 m0, s23, 130048
    s_nop 0
    buffer_load_dwordx4 v12, s[44:47], s36 offen lds
    s_add_u32 m0, s23, 134272
    s_nop 0
    buffer_load_dwordx4 v12, s[48:51], s36 offen lds
    v_and_b32 v97, 0xffff0000, v80
    v_lshlrev_b32_e64 v98, 16, v81
    v_and_b32 v99, 0xffff0000, v81
    v_lshlrev_b32_e64 v100, 16, v82
    v_and_b32 v101, 0xffff0000, v82
    v_lshlrev_b32_e64 v102, 16, v83
    v_and_b32 v103, 0xffff0000, v83
    v_lshlrev_b32_e64 v104, 16, v84
    v_and_b32 v105, 0xffff0000, v84
    v_lshlrev_b32_e64 v106, 16, v85
    v_and_b32 v107, 0xffff0000, v85
    v_lshlrev_b32_e64 v108, 16, v86
    v_and_b32 v109, 0xffff0000, v86
    v_lshlrev_b32_e64 v110, 16, v87
    v_and_b32 v111, 0xffff0000, v87
    v_add_f32 v80, v96, v64
    v_add_f32 v64, v104, v64
    v_add_f32_e64 v81, v97, v65
    s_add_u32 s36, s22, 114816
    s_add_u32 m0, s23, 138496
    s_nop 0
    buffer_load_dwordx4 v12, s[44:47], s36 offen lds
    s_add_u32 m0, s23, 142720
    s_nop 0
    buffer_load_dwordx4 v12, s[48:51], s36 offen lds
    v_add_f32 v65, v105, v65
    v_add_f32 v82, v98, v66
    v_add_f32 v66, v106, v66
    v_add_f32 v83, v99, v67
    v_add_f32 v67, v107, v67
    v_add_f32 v84, v100, v68
    v_add_f32 v68, v108, v68
    v_add_f32 v85, v101, v69
    v_add_f32 v69, v109, v69
    v_add_f32 v86, v102, v70
    v_add_f32 v70, v110, v70
    v_add_f32 v87, v103, v71
    v_add_f32_e64 v71, v111, v71
    v_cvt_pk_bf16_f32 v80, 0, v80
    v_cvt_pk_bf16_f32 v64, 0, v64
    v_cvt_pk_bf16_f32 v81, 0, v81
    v_cvt_pk_bf16_f32 v65, 0, v65
    v_cvt_pk_bf16_f32 v82, 0, v82
    s_add_u32 s36, s22, 229376
    s_add_u32 m0, s23, 146944
    s_nop 0
    buffer_load_dwordx4 v12, s[44:47], s36 offen lds
    s_add_u32 m0, s23, 151168
    s_nop 0
    buffer_load_dwordx4 v12, s[48:51], s36 offen lds
    v_cvt_pk_bf16_f32 v66, 0, v66
    v_cvt_pk_bf16_f32 v83, 0, v83
    v_cvt_pk_bf16_f32 v67, 0, v67
    v_cvt_pk_bf16_f32 v84, 0, v84
    v_cvt_pk_bf16_f32 v68, 0, v68
    v_cvt_pk_bf16_f32 v85, 0, v85
    v_cvt_pk_bf16_f32 v69, 0, v69
    v_cvt_pk_bf16_f32 v86, 0, v86
    v_cvt_pk_bf16_f32 v70, 0, v70
    v_cvt_pk_bf16_f32 v87, 0, v87
    v_cvt_pk_bf16_f32 v71, 0, v71
    v_mul_f32 v80, v80, v72
    v_mul_f32 v64, v64, v72
    v_mul_f32 v81, v81, v73
    v_mul_f32 v65, v65, v73
    v_mul_f32 v82, v82, v74
    v_mul_f32 v66, v66, v74
    v_mul_f32_e64 v83, v83, v75
    s_add_u32 s36, s22, 229504
    s_add_u32 m0, s23, 155392
    s_nop 0
    buffer_load_dwordx4 v12, s[44:47], s36 offen lds
    s_add_u32 m0, s23, 159616
    s_nop 0
    buffer_load_dwordx4 v12, s[48:51], s36 offen lds
    v_mul_f32 v67, v67, v75
    v_mul_f32 v84, v84, v76
    v_mul_f32 v68, v68, v76
    v_mul_f32 v85, v85, v77
    v_mul_f32 v69, v69, v77
    s_waitcnt lgkmcnt(0)
    s_barrier
    v_mul_f32 v86, v86, v78
    v_mul_f32 v70, v70, v78
    v_mul_f32 v87, v87, v79
    v_mul_f32_e64 v71, v71, v79
    v_cvt_pk_bf16_f32 v80, 0, v80
KMPG5:
    s_cbranch_execz KMPG13
    s_nop 0
    v_cvt_pk_bf16_f32 v64, 0, v64
    v_cvt_pk_bf16_f32 v81, 0, v81
    v_cvt_pk_bf16_f32 v65, 0, v65
    v_cvt_pk_bf16_f32 v82, 0, v82
    v_cvt_pk_bf16_f32 v66, 0, v66
    v_cvt_pk_bf16_f32 v83, 0, v83
    v_cvt_pk_bf16_f32 v67, 0, v67
    v_cvt_pk_bf16_f32 v84, 0, v84
    s_add_u32 s36, s19, 2
    s_and_b32 s37, s36, 1
    s_lshl_b32 s36, s36, 16
    s_lshl_b32 s37, s37, 15
    s_sub_u32 s36, s36, s37
    s_add_u32 s36, s36, s20
    buffer_load_dwordx4 v[176:179], v23, s[52:55], s36 offen offset:0
    buffer_load_dwordx4 v[180:183], v23, s[52:55], s36 offen offset:1024
    buffer_load_dwordx4 v[184:187], v23, s[52:55], s36 offen offset:2048
    buffer_load_dwordx4 v[188:191], v23, s[52:55], s36 offen offset:3072
    v_cvt_pk_bf16_f32 v68, 0, v68
    v_cvt_pk_bf16_f32 v85, 0, v85
    v_cvt_pk_bf16_f32 v69, 0, v69
    v_cvt_pk_bf16_f32 v86, 0, v86
    v_cvt_pk_bf16_f32 v70, 0, v70
    v_cvt_pk_bf16_f32 v87, 0, v87
    v_cvt_pk_bf16_f32 v71, 0, v71
    v_mul_f32 v80, v80, v22
    v_mul_f32 v64, v64, v24
    v_mul_f32 v81, v81, v22
    v_mul_f32 v65, v65, v24
    v_mul_f32 v82, v82, v22
    v_mul_f32 v66, v66, v24
    v_mul_f32 v83, v83, v22
    v_mul_f32 v67, v67, v24
    v_mul_f32 v84, v84, v22
    v_mul_f32 v68, v68, v24
    v_mul_f32_e64 v85, v85, v22
    s_add_u32 s36, s19, 3
    s_and_b32 s37, s36, 1
    s_lshl_b32 s36, s36, 16
    s_lshl_b32 s37, s37, 15
    s_sub_u32 s36, s36, s37
    s_add_u32 s36, s36, s20
    buffer_load_dwordx4 v[192:195], v23, s[52:55], s36 offen offset:0
    buffer_load_dwordx4 v[196:199], v23, s[52:55], s36 offen offset:1024
    buffer_load_dwordx4 v[200:203], v23, s[52:55], s36 offen offset:2048
    buffer_load_dwordx4 v[204:207], v23, s[52:55], s36 offen offset:3072
    v_mul_f32 v69, v69, v24
    v_mul_f32 v86, v86, v22
    v_mul_f32 v70, v70, v24
    v_mul_f32 v87, v87, v22
    v_mul_f32_e64 v71, v71, v24
    v_cvt_pk_bf16_f32 v80, 0, v80
    v_cvt_pk_bf16_f32 v64, 0, v64
    v_cvt_pk_bf16_f32 v81, 0, v81
    v_cvt_pk_bf16_f32 v65, 0, v65
    v_cvt_pk_bf16_f32 v82, 0, v82
    v_cvt_pk_bf16_f32 v66, 0, v66
    v_cvt_pk_bf16_f32 v83, 0, v83
    v_cvt_pk_bf16_f32 v67, 0, v67
    v_cvt_pk_bf16_f32 v84, 0, v84
    v_cvt_pk_bf16_f32 v68, 0, v68
    v_cvt_pk_bf16_f32 v85, 0, v85
    v_cvt_pk_bf16_f32 v69, 0, v69
    v_cvt_pk_bf16_f32 v86, 0, v86
    s_add_u32 s36, s19, 4
    s_and_b32 s37, s36, 1
    s_lshl_b32 s36, s36, 16
    s_lshl_b32 s37, s37, 15
    s_sub_u32 s36, s36, s37
    s_add_u32 s36, s36, s20
    buffer_load_dwordx4 v[208:211], v23, s[52:55], s36 offen offset:0
    buffer_load_dwordx4 v[212:215], v23, s[52:55], s36 offen offset:1024
    buffer_load_dwordx4 v[216:219], v23, s[52:55], s36 offen offset:2048
    buffer_load_dwordx4 v[220:223], v23, s[52:55], s36 offen offset:3072
    v_cvt_pk_bf16_f32 v70, 0, v70
    v_cvt_pk_bf16_f32 v87, 0, v87
    v_cvt_pk_bf16_f32 v71, 0, v71
    v_add_f32 v80, s64, v80
    v_add_f32 v64, s0, v64
    v_add_f32 v81, s64, v81
    v_add_f32 v65, s0, v65
    v_add_f32 v82, s64, v82
    v_add_f32 v66, s0, v66
    v_add_f32 v83, s64, v83
    v_add_f32 v67, s0, v67
    v_add_f32 v84, s64, v84
    v_add_f32 v68, s0, v68
    v_add_f32 v85, s64, v85
    v_add_f32 v69, s0, v69
    v_add_f32 v86, s64, v86
    v_add_f32 v70, s0, v70
    v_add_f32_e64 v87, s64, v87
    s_add_u32 s36, s19, 5
    s_and_b32 s37, s36, 1
    s_lshl_b32 s36, s36, 16
    s_lshl_b32 s37, s37, 15
    s_sub_u32 s36, s36, s37
    s_add_u32 s36, s36, s20
    buffer_load_dwordx4 v[224:227], v23, s[52:55], s36 offen offset:0
    buffer_load_dwordx4 v[228:231], v23, s[52:55], s36 offen offset:1024
    buffer_load_dwordx4 v[232:235], v23, s[52:55], s36 offen offset:2048
    buffer_load_dwordx4 v[236:239], v23, s[52:55], s36 offen offset:3072
    v_add_f32_e64 v71, s0, v71
    v_cvt_pk_bf16_f32 v80, 0, v80
    v_cvt_pk_bf16_f32 v64, 0, v64
    v_cvt_pk_bf16_f32 v81, 0, v81
    v_cvt_pk_bf16_f32 v65, 0, v65
    v_cvt_pk_bf16_f32 v82, 0, v82
    v_cvt_pk_bf16_f32 v66, 0, v66
    v_cvt_pk_bf16_f32 v83, 0, v83
    v_cvt_pk_bf16_f32 v67, 0, v67
    v_cvt_pk_bf16_f32 v84, 0, v84
    v_cvt_pk_bf16_f32 v68, 0, v68
    v_cvt_pk_bf16_f32 v85, 0, v85
    v_cvt_pk_bf16_f32 v69, 0, v69
    v_cvt_pk_bf16_f32 v86, 0, v86
    v_cvt_pk_bf16_f32 v70, 0, v70
    v_cvt_pk_bf16_f32 v87, 0, v87
    v_cvt_pk_bf16_f32 v71, 0, v71
    v_lshlrev_b32_e64 v113, 16, v89
    v_and_b32 v112, 0xffff0000, v89
    v_lshlrev_b32_e64 v115, 16, v88
    v_and_b32 v114, 0xffff0000, v88
    v_lshlrev_b32_e64 v117, 16, v91
    v_and_b32 v116, 0xffff0000, v91
    v_lshlrev_b32_e64 v119, 16, v90
    v_and_b32 v118, 0xffff0000, v90
    v_lshlrev_b32_e64 v121, 16, v93
    v_and_b32 v120, 0xffff0000, v93
    v_lshlrev_b32_e64 v123, 16, v92
    v_and_b32 v122, 0xffff0000, v92
    v_lshlrev_b32_e64 v125, 16, v95
    v_and_b32 v124, 0xffff0000, v95
    v_lshlrev_b32_e64 v127, 16, v94
    v_and_b32 v126, 0xffff0000, v94
    v_mul_f32 v112, s3, v112
    v_mul_f32 v120, s21, v120
    v_mul_f32 v113, s3, v113
    v_mul_f32 v121, s21, v121
    v_mul_f32 v114, s3, v114
    v_mul_f32 v122, s21, v122
    v_mul_f32 v115, s3, v115
    v_mul_f32 v123, s21, v123
    v_mul_f32 v116, s3, v116
    v_mul_f32 v124, s21, v124
    v_mul_f32 v117, s3, v117
    v_mul_f32 v125, s21, v125
    v_mul_f32 v118, s3, v118
    v_mul_f32 v126, s21, v126
    v_mul_f32 v119, s3, v119
    v_mul_f32 v127, s21, v127
    v_cvt_pk_bf16_f32 v112, 0, v112
    v_cvt_pk_bf16_f32 v120, 0, v120
    v_cvt_pk_bf16_f32 v113, 0, v113
    v_cvt_pk_bf16_f32 v121, 0, v121
    v_cvt_pk_bf16_f32 v114, 0, v114
    v_cvt_pk_bf16_f32 v122, 0, v122
    v_cvt_pk_bf16_f32 v115, 0, v115
    v_cvt_pk_bf16_f32 v123, 0, v123
    v_cvt_pk_bf16_f32 v116, 0, v116
KMPG6:
    s_cbranch_execz KMPG14
    s_nop 0
    v_cvt_pk_bf16_f32 v124, 0, v124
    v_cvt_pk_bf16_f32 v117, 0, v117
    v_cvt_pk_bf16_f32 v125, 0, v125
    v_cvt_pk_bf16_f32 v118, 0, v118
    v_cvt_pk_bf16_f32 v126, 0, v126
    v_cvt_pk_bf16_f32 v119, 0, v119
    v_cvt_pk_bf16_f32 v127, 0, v127
    ds_read_b128 v[32:35], v10 offset:0
    ds_read_b128 v[48:51], v10 offset:4096
    ds_read_b128 v[36:39], v10 offset:1024
    ds_read_b128 v[52:55], v10 offset:5120
    ds_read_b128 v[40:43], v10 offset:2048
    ds_read_b128 v[56:59], v10 offset:6144
    ds_read_b128 v[44:47], v10 offset:3072
    ds_read_b128 v[60:63], v10 offset:7168
    s_waitcnt lgkmcnt(4)
    v_add_f32 v32, v32, v36
    v_add_f32 v33, v33, v37
    v_add_f32 v34, v34, v38
    v_add_f32 v35, v35, v39
    v_add_f32 v48, v48, v52
    v_add_f32 v49, v49, v53
    v_add_f32 v50, v50, v54
    v_add_f32 v51, v51, v55
    s_waitcnt lgkmcnt(0)
    v_add_f32 v40, v40, v44
    v_add_f32 v41, v41, v45
    v_add_f32 v42, v42, v46
    v_add_f32 v43, v43, v47
    v_add_f32 v56, v56, v60
    v_add_f32 v57, v57, v61
    v_add_f32 v58, v58, v62
    v_add_f32 v59, v59, v63
    v_add_f32 v32, v32, v40
    v_add_f32 v33, v33, v41
    v_add_f32 v34, v34, v42
    v_add_f32 v35, v35, v43
    v_add_f32 v48, v48, v56
    v_add_f32 v49, v49, v57
    v_add_f32 v50, v50, v58
    v_add_f32 v51, v51, v59
    v_cvt_pk_bf16_f32 v32, 0, v32
    v_cvt_pk_bf16_f32 v33, 0, v33
    v_cvt_pk_bf16_f32 v34, 0, v34
    v_cvt_pk_bf16_f32 v35, 0, v35
    v_cvt_pk_bf16_f32 v48, 0, v48
    v_cvt_pk_bf16_f32 v49, 0, v49
    v_cvt_pk_bf16_f32 v50, 0, v50
    v_cvt_pk_bf16_f32 v51, 0, v51
    v_add_f32 v32, v32, v112
    v_add_f32 v33, v33, v113
    v_add_f32 v34, v34, v114
    v_add_f32 v35, v35, v115
    v_add_f32 v48, v48, v116
    v_add_f32 v49, v49, v117
    v_add_f32 v50, v50, v118
    v_add_f32 v51, v51, v119
    v_cvt_pk_bf16_f32 v32, 0, v32
    v_cvt_pk_bf16_f32 v33, 0, v33
    v_cvt_pk_bf16_f32 v34, 0, v34
    v_cvt_pk_bf16_f32 v35, 0, v35
    v_cvt_pk_bf16_f32 v48, 0, v48
    v_cvt_pk_bf16_f32 v49, 0, v49
    v_cvt_pk_bf16_f32 v50, 0, v50
    v_cvt_pk_bf16_f32 v51, 0, v51
    v_mul_f32 v32, v32, v80
    v_mul_f32 v33, v33, v81
    v_mul_f32 v34, v34, v82
    v_mul_f32 v35, v35, v83
    v_mul_f32 v48, v48, v84
    v_mul_f32 v49, v49, v85
    v_mul_f32 v50, v50, v86
    v_mul_f32 v51, v51, v87
    v_cvt_pk_bf16_f32 v32, 0, v32
    v_cvt_pk_bf16_f32 v33, 0, v33
    v_cvt_pk_bf16_f32 v34, 0, v34
    v_cvt_pk_bf16_f32 v35, 0, v35
    v_cvt_pk_bf16_f32 v48, 0, v48
    v_cvt_pk_bf16_f32 v49, 0, v49
    v_cvt_pk_bf16_f32 v50, 0, v50
    v_cvt_pk_bf16_f32 v51, 0, v51
    v_mul_f32 v32, s66, v32
    v_mul_f32 v33, s66, v33
    v_mul_f32 v34, s66, v34
    v_mul_f32 v35, s66, v35
    v_mul_f32 v48, s66, v48
    v_mul_f32 v49, s66, v49
    v_mul_f32 v50, s66, v50
    v_mul_f32 v51, s66, v51
    v_cvt_pk_bf16_f32 v32, 0, v32
    v_cvt_pk_bf16_f32 v33, 0, v33
    v_cvt_pk_bf16_f32 v34, 0, v34
    v_cvt_pk_bf16_f32 v35, 0, v35
    v_cvt_pk_bf16_f32 v48, 0, v48
    v_cvt_pk_bf16_f32 v49, 0, v49
    v_cvt_pk_bf16_f32 v50, 0, v50
    v_cvt_pk_bf16_f32 v51, 0, v51
    v_add_f32 v32, v32, v96
    v_add_f32 v33, v33, v97
    v_add_f32 v34, v34, v98
    v_add_f32 v35, v35, v99
    v_add_f32 v48, v48, v100
    v_add_f32 v49, v49, v101
    v_add_f32 v50, v50, v102
    v_add_f32 v51, v51, v103
    v_cvt_pk_bf16_f32 v40, v32, v33
    v_cvt_pk_bf16_f32 v41, v34, v35
    v_cvt_pk_bf16_f32 v42, v48, v49
    v_cvt_pk_bf16_f32 v43, v50, v51
    v_cvt_pk_bf16_f32 v32, 0, v32
    v_cvt_pk_bf16_f32 v33, 0, v33
    v_cvt_pk_bf16_f32 v34, 0, v34
    v_cvt_pk_bf16_f32 v35, 0, v35
    v_cvt_pk_bf16_f32 v48, 0, v48
    v_cvt_pk_bf16_f32 v49, 0, v49
    v_cvt_pk_bf16_f32 v50, 0, v50
    v_cvt_pk_bf16_f32 v51, 0, v51
    v_permlane16_swap_b32 v40, v42
    v_permlane16_swap_b32 v41, v43
    v_mul_f32 v32, v32, v20
    v_mul_f32 v33, v33, v20
    v_mul_f32 v34, v34, v20
    v_mul_f32 v35, v35, v20
    v_mul_f32 v48, v48, v20
    v_mul_f32 v49, v49, v20
    v_mul_f32 v50, v50, v20
    v_mul_f32 v51, v51, v20
    s_add_u32 s36, s18, 4194304
    s_add_u32 s37, s18, 6291456
    buffer_store_dwordx4 v[40:43], v11, s[24:27], s36 offen sc1
    v_cvt_pk_bf16_f32 v44, v32, v33
    v_cvt_pk_bf16_f32 v45, v34, v35
    v_cvt_pk_bf16_f32 v46, v48, v49
    v_cvt_pk_bf16_f32 v47, v50, v51
    s_nop 0
    v_permlane16_swap_b32 v44, v46
    v_permlane16_swap_b32 v45, v47
    buffer_store_dwordx4 v[44:47], v11, s[24:27], s37 offen sc1
    s_barrier
    ds_read_b128 v[32:35], v4 offset:0
    ds_read_b128 v[48:51], v4 offset:4096
    ds_read_b128 v[36:39], v4 offset:1024
    ds_read_b128 v[52:55], v4 offset:5120
    ds_read_b128 v[40:43], v4 offset:2048
    ds_read_b128 v[56:59], v4 offset:6144
    ds_read_b128 v[44:47], v4 offset:3072
    ds_read_b128 v[60:63], v4 offset:7168
    s_waitcnt lgkmcnt(4)
    v_add_f32 v32, v32, v36
    v_add_f32 v33, v33, v37
    v_add_f32 v34, v34, v38
    v_add_f32 v35, v35, v39
    v_add_f32 v48, v48, v52
    v_add_f32 v49, v49, v53
    v_add_f32 v50, v50, v54
    v_add_f32 v51, v51, v55
    s_waitcnt lgkmcnt(0)
    s_waitcnt vmcnt(18)
    s_barrier
    v_add_f32 v40, v40, v44
    v_add_f32 v41, v41, v45
    v_add_f32 v42, v42, v46
    v_add_f32 v43, v43, v47
    v_add_f32 v56, v56, v60
    v_add_f32 v57, v57, v61
    v_add_f32 v58, v58, v62
    v_add_f32 v59, v59, v63
    v_add_f32 v32, v32, v40
    v_add_f32 v33, v33, v41
    v_add_f32 v34, v34, v42
    v_add_f32 v35, v35, v43
    v_add_f32 v48, v48, v56
    v_add_f32 v49, v49, v57
    v_add_f32 v50, v50, v58
    v_add_f32 v51, v51, v59
    v_cvt_pk_bf16_f32 v32, 0, v32
    v_cvt_pk_bf16_f32 v33, 0, v33
KMPG7:
    s_cbranch_execz KMPG15
    s_nop 0
    v_cvt_pk_bf16_f32 v34, 0, v34
    v_cvt_pk_bf16_f32 v35, 0, v35
    v_cvt_pk_bf16_f32 v48, 0, v48
    v_cvt_pk_bf16_f32 v49, 0, v49
    v_cvt_pk_bf16_f32 v50, 0, v50
    v_cvt_pk_bf16_f32 v51, 0, v51
    v_add_f32 v32, v32, v120
    v_add_f32 v33, v33, v121
    v_add_f32 v34, v34, v122
    v_add_f32 v35, v35, v123
    v_add_f32 v48, v48, v124
    v_add_f32 v49, v49, v125
    v_add_f32 v50, v50, v126
    v_add_f32 v51, v51, v127
    v_cvt_pk_bf16_f32 v32, 0, v32
    v_cvt_pk_bf16_f32 v33, 0, v33
    v_cvt_pk_bf16_f32 v34, 0, v34
    v_cvt_pk_bf16_f32 v35, 0, v35
    v_cvt_pk_bf16_f32 v48, 0, v48
    v_cvt_pk_bf16_f32 v49, 0, v49
    v_cvt_pk_bf16_f32 v50, 0, v50
    v_cvt_pk_bf16_f32 v51, 0, v51
    v_mul_f32 v32, v32, v64
    v_mul_f32 v33, v33, v65
    v_mul_f32 v34, v34, v66
    v_mul_f32 v35, v35, v67
    v_mul_f32 v48, v48, v68
    v_mul_f32 v49, v49, v69
    v_mul_f32 v50, v50, v70
    v_mul_f32 v51, v51, v71
    v_cvt_pk_bf16_f32 v32, 0, v32
    v_cvt_pk_bf16_f32 v33, 0, v33
    v_cvt_pk_bf16_f32 v34, 0, v34
    v_cvt_pk_bf16_f32 v35, 0, v35
    v_cvt_pk_bf16_f32 v48, 0, v48
    v_cvt_pk_bf16_f32 v49, 0, v49
    v_cvt_pk_bf16_f32 v50, 0, v50
    v_cvt_pk_bf16_f32 v51, 0, v51
    s_waitcnt vmcnt(0)
    s_mov_b64 exec, 0x1
    buffer_store_dword v17, v16, s[24:27], s43 offen offset:0 sc1
    s_mov_b64 exec, -1
    v_mul_f32 v32, s70, v32
    v_mul_f32 v33, s70, v33
    v_mul_f32 v34, s70, v34
    v_mul_f32 v35, s70, v35
    v_mul_f32 v48, s70, v48
    v_mul_f32 v49, s70, v49
    v_mul_f32 v50, s70, v50
    v_mul_f32_e64 v51, s70, v51
    v_cvt_pk_bf16_f32 v32, 0, v32
    v_cvt_pk_bf16_f32 v33, 0, v33
    v_cvt_pk_bf16_f32 v34, 0, v34
    v_cvt_pk_bf16_f32 v35, 0, v35
    v_cvt_pk_bf16_f32 v48, 0, v48
    v_cvt_pk_bf16_f32 v49, 0, v49
    v_cvt_pk_bf16_f32 v50, 0, v50
    v_cvt_pk_bf16_f32 v51, 0, v51
    v_add_f32 v32, v32, v104
    v_add_f32 v33, v33, v105
    v_add_f32 v34, v34, v106
    v_add_f32 v35, v35, v107
    v_add_f32 v48, v48, v108
    v_add_f32 v49, v49, v109
    v_add_f32 v50, v50, v110
    v_add_f32 v51, v51, v111
    v_cvt_pk_bf16_f32 v40, v32, v33
    v_cvt_pk_bf16_f32 v41, v34, v35
    v_cvt_pk_bf16_f32 v42, v48, v49
    v_cvt_pk_bf16_f32 v43, v50, v51
    v_cvt_pk_bf16_f32 v32, 0, v32
    v_cvt_pk_bf16_f32 v33, 0, v33
    v_cvt_pk_bf16_f32 v34, 0, v34
    v_cvt_pk_bf16_f32 v35, 0, v35
    v_cvt_pk_bf16_f32 v48, 0, v48
    v_cvt_pk_bf16_f32 v49, 0, v49
    v_cvt_pk_bf16_f32 v50, 0, v50
    v_cvt_pk_bf16_f32 v51, 0, v51
    v_permlane16_swap_b32 v40, v42
    v_permlane16_swap_b32 v41, v43
    v_mul_f32 v32, v32, v21
    v_mul_f32 v33, v33, v21
    v_mul_f32 v34, v34, v21
    v_mul_f32 v35, v35, v21
    v_mul_f32 v48, v48, v21
    v_mul_f32 v49, v49, v21
    v_mul_f32 v50, v50, v21
    v_mul_f32 v51, v51, v21
    s_add_u32 s36, s18, 5242880
    s_add_u32 s37, s18, 7340032
    buffer_store_dwordx4 v[40:43], v11, s[24:27], s36 offen sc1
    v_cvt_pk_bf16_f32 v44, v32, v33
    v_cvt_pk_bf16_f32 v45, v34, v35
    v_cvt_pk_bf16_f32 v46, v48, v49
    v_cvt_pk_bf16_f32 v47, v50, v51
    s_nop 0
    v_permlane16_swap_b32 v44, v46
    v_permlane16_swap_b32 v45, v47
    buffer_store_dwordx4 v[44:47], v11, s[24:27], s37 offen sc1
    s_setprio 0
    v_lshrrev_b32 v14, 4, v1
    v_lshlrev_b32 v14, 15, v14
    v_lshl_add_u32 v14, v7, 4, v14
    v_mul_u32_u24 v15, 16, v1
    s_lshr_b32 s36, s13, 2
    s_lshl_b32 s36, s36, 2
    s_add_u32 s36, s36, s15
    s_mul_i32 s36, s36, 1
    s_and_b32 s37, s13, 3
    s_lshl_b32 s37, s37, 3
    s_add_u32 s37, s37, s14
    s_lshr_b32 s37, s37, 5
    s_add_u32 s36, s36, s37
    s_mul_i32 s36, s36, 1280
    s_add_u32 s64, s36, 29360128
    s_lshl_b32 s16, s15, 12
    s_lshl_b32 s36, s13, 8
    s_add_u32 s16, s16, s36
    s_add_u32 s65, s64, 20480
    s_mul_i32 s17, s15, 4224
    v_mov_b32 v40, v144
    v_mov_b32 v41, v145
    v_mov_b32 v42, v148
    v_mov_b32 v43, v149
    v_mov_b32 v44, v152
    v_mov_b32 v45, v153
    v_mov_b32 v46, v156
    v_mov_b32_e64 v47, v157
    v_mov_b32_dpp v144, v146 row_ror:8 row_mask:0xf bank_mask:0xc
    v_mov_b32_dpp v145, v147 row_ror:8 row_mask:0xf bank_mask:0xc
    v_mov_b32_dpp v148, v150 row_ror:8 row_mask:0xf bank_mask:0xc
    v_mov_b32_dpp v149, v151 row_ror:8 row_mask:0xf bank_mask:0xc
    v_mov_b32_dpp v152, v154 row_ror:8 row_mask:0xf bank_mask:0xc
    v_mov_b32_dpp v153, v155 row_ror:8 row_mask:0xf bank_mask:0xc
    v_mov_b32_dpp v156, v158 row_ror:8 row_mask:0xf bank_mask:0xc
    v_mov_b32_dpp v157, v159 row_ror:8 row_mask:0xf bank_mask:0xc
    v_mov_b32_dpp v146, v40 row_ror:8 row_mask:0xf bank_mask:0x3
    v_mov_b32_dpp v147, v41 row_ror:8 row_mask:0xf bank_mask:0x3
    v_mov_b32_dpp v150, v42 row_ror:8 row_mask:0xf bank_mask:0x3
    v_mov_b32_dpp v151, v43 row_ror:8 row_mask:0xf bank_mask:0x3
    v_mov_b32_dpp v154, v44 row_ror:8 row_mask:0xf bank_mask:0x3
    v_mov_b32_dpp v155, v45 row_ror:8 row_mask:0xf bank_mask:0x3
    v_mov_b32_dpp v158, v46 row_ror:8 row_mask:0xf bank_mask:0x3
    v_mov_b32_dpp v159, v47 row_ror:8 row_mask:0xf bank_mask:0x3
    v_perm_b32 v128, v148, v144, s40
    v_perm_b32 v129, v156, v152, s40
    v_perm_b32 v130, v150, v146, s40
    v_perm_b32 v131, v158, v154, s40
    v_perm_b32 v132, v148, v144, s41
    v_perm_b32 v133, v156, v152, s41
    v_perm_b32 v134, v150, v146, s41
    v_perm_b32 v135, v158, v154, s41
    v_perm_b32 v136, v149, v145, s40
    v_perm_b32 v137, v157, v153, s40
    v_perm_b32 v138, v151, v147, s40
    v_perm_b32 v139, v159, v155, s40
    v_perm_b32 v140, v149, v145, s41
    v_perm_b32 v141, v157, v153, s41
    v_perm_b32 v142, v151, v147, s41
    v_perm_b32 v143, v159, v155, s41
    v_mov_b32 v40, v160
    v_mov_b32 v41, v161
    v_mov_b32 v42, v164
    v_mov_b32 v43, v165
KMPG8:
    s_cbranch_execz KMPG16
    v_mov_b32 v44, v168
    v_mov_b32 v45, v169
    v_mov_b32 v46, v172
    v_mov_b32_e64 v47, v173
    v_mov_b32_dpp v160, v162 row_ror:8 row_mask:0xf bank_mask:0xc
    v_mov_b32_dpp v161, v163 row_ror:8 row_mask:0xf bank_mask:0xc
    v_mov_b32_dpp v164, v166 row_ror:8 row_mask:0xf bank_mask:0xc
    v_mov_b32_dpp v165, v167 row_ror:8 row_mask:0xf bank_mask:0xc
    v_mov_b32_dpp v168, v170 row_ror:8 row_mask:0xf bank_mask:0xc
    v_mov_b32_dpp v169, v171 row_ror:8 row_mask:0xf bank_mask:0xc
    v_mov_b32_dpp v172, v174 row_ror:8 row_mask:0xf bank_mask:0xc
    v_mov_b32_dpp v173, v175 row_ror:8 row_mask:0xf bank_mask:0xc
    v_mov_b32_dpp v162, v40 row_ror:8 row_mask:0xf bank_mask:0x3
    v_mov_b32_dpp v163, v41 row_ror:8 row_mask:0xf bank_mask:0x3
    v_mov_b32_dpp v166, v42 row_ror:8 row_mask:0xf bank_mask:0x3
    v_mov_b32_dpp v167, v43 row_ror:8 row_mask:0xf bank_mask:0x3
    v_mov_b32_dpp v170, v44 row_ror:8 row_mask:0xf bank_mask:0x3
    v_mov_b32_dpp v171, v45 row_ror:8 row_mask:0xf bank_mask:0x3
    v_mov_b32_dpp v174, v46 row_ror:8 row_mask:0xf bank_mask:0x3
    v_mov_b32_dpp v175, v47 row_ror:8 row_mask:0xf bank_mask:0x3
    v_perm_b32 v144, v164, v160, s40
    v_perm_b32 v145, v172, v168, s40
    v_perm_b32 v146, v166, v162, s40
    v_perm_b32 v147, v174, v170, s40
    v_perm_b32 v148, v164, v160, s41
    v_perm_b32 v149, v172, v168, s41
    v_perm_b32 v150, v166, v162, s41
    v_perm_b32 v151, v174, v170, s41
    v_perm_b32 v152, v165, v161, s40
    v_perm_b32 v153, v173, v169, s40
    v_perm_b32 v154, v167, v163, s40
    v_perm_b32 v155, v175, v171, s40
    v_perm_b32 v156, v165, v161, s41
    v_perm_b32 v157, v173, v169, s41
    v_perm_b32 v158, v167, v163, s41
    v_perm_b32 v159, v175, v171, s41
    v_mov_b32 v40, v176
    v_mov_b32 v41, v177
    v_mov_b32 v42, v180
    v_mov_b32 v43, v181
    v_mov_b32 v44, v184
    v_mov_b32 v45, v185
    v_mov_b32 v46, v188
    v_mov_b32 v47, v189
    v_mov_b32_dpp v176, v178 row_ror:8 row_mask:0xf bank_mask:0xc
    v_mov_b32_dpp v177, v179 row_ror:8 row_mask:0xf bank_mask:0xc
    v_mov_b32_dpp v180, v182 row_ror:8 row_mask:0xf bank_mask:0xc
    v_mov_b32_dpp v181, v183 row_ror:8 row_mask:0xf bank_mask:0xc
    v_mov_b32_dpp v184, v186 row_ror:8 row_mask:0xf bank_mask:0xc
    v_mov_b32_dpp v185, v187 row_ror:8 row_mask:0xf bank_mask:0xc
    v_mov_b32_dpp v188, v190 row_ror:8 row_mask:0xf bank_mask:0xc
    v_mov_b32_dpp v189, v191 row_ror:8 row_mask:0xf bank_mask:0xc
    v_mov_b32_dpp v178, v40 row_ror:8 row_mask:0xf bank_mask:0x3
    v_mov_b32_dpp v179, v41 row_ror:8 row_mask:0xf bank_mask:0x3
    v_mov_b32_dpp v182, v42 row_ror:8 row_mask:0xf bank_mask:0x3
    v_mov_b32_dpp v183, v43 row_ror:8 row_mask:0xf bank_mask:0x3
    v_mov_b32_dpp v186, v44 row_ror:8 row_mask:0xf bank_mask:0x3
    v_mov_b32_dpp v187, v45 row_ror:8 row_mask:0xf bank_mask:0x3
    v_mov_b32_dpp v190, v46 row_ror:8 row_mask:0xf bank_mask:0x3
    v_mov_b32_dpp v191, v47 row_ror:8 row_mask:0xf bank_mask:0x3
    v_perm_b32 v160, v180, v176, s40
    v_perm_b32 v161, v188, v184, s40
    v_perm_b32 v162, v182, v178, s40
    v_perm_b32 v163, v190, v186, s40
    v_perm_b32 v164, v180, v176, s41
    v_perm_b32 v165, v188, v184, s41
    v_perm_b32 v166, v182, v178, s41
    v_perm_b32 v167, v190, v186, s41
    v_perm_b32 v168, v181, v177, s40
    v_perm_b32 v169, v189, v185, s40
    v_perm_b32 v170, v183, v179, s40
    v_perm_b32 v171, v191, v187, s40
    v_perm_b32 v172, v181, v177, s41
    v_perm_b32 v173, v189, v185, s41
    v_perm_b32 v174, v183, v179, s41
    v_perm_b32 v175, v191, v187, s41
    v_mov_b32 v40, v192
    v_mov_b32 v41, v193
    v_mov_b32 v42, v196
    v_mov_b32 v43, v197
    v_mov_b32 v44, v200
    v_mov_b32 v45, v201
    v_mov_b32 v46, v204
    v_mov_b32 v47, v205
    v_mov_b32_dpp v192, v194 row_ror:8 row_mask:0xf bank_mask:0xc
    v_mov_b32_dpp v193, v195 row_ror:8 row_mask:0xf bank_mask:0xc
    v_mov_b32_dpp v196, v198 row_ror:8 row_mask:0xf bank_mask:0xc
    v_mov_b32_dpp v197, v199 row_ror:8 row_mask:0xf bank_mask:0xc
    v_mov_b32_dpp v200, v202 row_ror:8 row_mask:0xf bank_mask:0xc
    v_mov_b32_dpp v201, v203 row_ror:8 row_mask:0xf bank_mask:0xc
    v_mov_b32_dpp v204, v206 row_ror:8 row_mask:0xf bank_mask:0xc
    v_mov_b32_dpp v205, v207 row_ror:8 row_mask:0xf bank_mask:0xc
    v_mov_b32_dpp v194, v40 row_ror:8 row_mask:0xf bank_mask:0x3
    v_mov_b32_dpp v195, v41 row_ror:8 row_mask:0xf bank_mask:0x3
    v_mov_b32_dpp v198, v42 row_ror:8 row_mask:0xf bank_mask:0x3
    v_mov_b32_dpp v199, v43 row_ror:8 row_mask:0xf bank_mask:0x3
    v_mov_b32_dpp v202, v44 row_ror:8 row_mask:0xf bank_mask:0x3
    v_mov_b32_dpp v203, v45 row_ror:8 row_mask:0xf bank_mask:0x3
    v_mov_b32_dpp v206, v46 row_ror:8 row_mask:0xf bank_mask:0x3
    v_mov_b32_dpp v207, v47 row_ror:8 row_mask:0xf bank_mask:0x3
    v_perm_b32 v176, v196, v192, s40
    v_perm_b32 v177, v204, v200, s40
    v_perm_b32 v178, v198, v194, s40
    v_perm_b32 v179, v206, v202, s40
    v_perm_b32 v180, v196, v192, s41
    v_perm_b32 v181, v204, v200, s41
    v_perm_b32 v182, v198, v194, s41
    v_perm_b32 v183, v206, v202, s41
    v_perm_b32 v184, v197, v193, s40
    v_perm_b32 v185, v205, v201, s40
    v_perm_b32 v186, v199, v195, s40
    v_perm_b32 v187, v207, v203, s40
    v_perm_b32 v188, v197, v193, s41
    v_perm_b32 v189, v205, v201, s41
    v_perm_b32 v190, v199, v195, s41
    v_perm_b32 v191, v207, v203, s41
    v_mov_b32 v40, v208
    v_mov_b32 v41, v209
    v_mov_b32 v42, v212
    v_mov_b32 v43, v213
    v_mov_b32 v44, v216
    v_mov_b32 v45, v217
    v_mov_b32 v46, v220
    v_mov_b32 v47, v221
    v_mov_b32_dpp v208, v210 row_ror:8 row_mask:0xf bank_mask:0xc
    v_mov_b32_dpp v209, v211 row_ror:8 row_mask:0xf bank_mask:0xc
    v_mov_b32_dpp v212, v214 row_ror:8 row_mask:0xf bank_mask:0xc
    v_mov_b32_dpp v213, v215 row_ror:8 row_mask:0xf bank_mask:0xc
    v_mov_b32_dpp v216, v218 row_ror:8 row_mask:0xf bank_mask:0xc
    v_mov_b32_dpp v217, v219 row_ror:8 row_mask:0xf bank_mask:0xc
    v_mov_b32_dpp v220, v222 row_ror:8 row_mask:0xf bank_mask:0xc
    v_mov_b32_dpp v221, v223 row_ror:8 row_mask:0xf bank_mask:0xc
    v_mov_b32_dpp v210, v40 row_ror:8 row_mask:0xf bank_mask:0x3
    v_mov_b32_dpp v211, v41 row_ror:8 row_mask:0xf bank_mask:0x3
    v_mov_b32_dpp v214, v42 row_ror:8 row_mask:0xf bank_mask:0x3
    v_mov_b32_dpp v215, v43 row_ror:8 row_mask:0xf bank_mask:0x3
    v_mov_b32_dpp v218, v44 row_ror:8 row_mask:0xf bank_mask:0x3
    v_mov_b32_dpp v219, v45 row_ror:8 row_mask:0xf bank_mask:0x3
    v_mov_b32_dpp v222, v46 row_ror:8 row_mask:0xf bank_mask:0x3
    v_mov_b32_dpp v223, v47 row_ror:8 row_mask:0xf bank_mask:0x3
    v_perm_b32 v192, v212, v208, s40
KMPG9:
    s_cbranch_execz KMPG17
    s_nop 0
    v_perm_b32 v193, v220, v216, s40
    v_perm_b32 v194, v214, v210, s40
    v_perm_b32 v195, v222, v218, s40
    v_perm_b32 v196, v212, v208, s41
    v_perm_b32 v197, v220, v216, s41
    v_perm_b32 v198, v214, v210, s41
    v_perm_b32 v199, v222, v218, s41
    v_perm_b32 v200, v213, v209, s40
    v_perm_b32 v201, v221, v217, s40
    v_perm_b32 v202, v215, v211, s40
    v_perm_b32 v203, v223, v219, s40
    v_perm_b32 v204, v213, v209, s41
    v_perm_b32 v205, v221, v217, s41
    v_perm_b32 v206, v215, v211, s41
    v_perm_b32 v207, v223, v219, s41
    v_mov_b32 v40, v224
    v_mov_b32 v41, v225
    v_mov_b32 v42, v228
    v_mov_b32 v43, v229
    v_mov_b32 v44, v232
    v_mov_b32 v45, v233
    v_mov_b32 v46, v236
    v_mov_b32 v47, v237
    v_mov_b32_dpp v224, v226 row_ror:8 row_mask:0xf bank_mask:0xc
    v_mov_b32_dpp v225, v227 row_ror:8 row_mask:0xf bank_mask:0xc
    v_mov_b32_dpp v228, v230 row_ror:8 row_mask:0xf bank_mask:0xc
    v_mov_b32_dpp v229, v231 row_ror:8 row_mask:0xf bank_mask:0xc
    v_mov_b32_dpp v232, v234 row_ror:8 row_mask:0xf bank_mask:0xc
    v_mov_b32_dpp v233, v235 row_ror:8 row_mask:0xf bank_mask:0xc
    v_mov_b32_dpp v236, v238 row_ror:8 row_mask:0xf bank_mask:0xc
    v_mov_b32_dpp v237, v239 row_ror:8 row_mask:0xf bank_mask:0xc
    v_mov_b32_dpp v226, v40 row_ror:8 row_mask:0xf bank_mask:0x3
    v_mov_b32_dpp v227, v41 row_ror:8 row_mask:0xf bank_mask:0x3
    v_mov_b32_dpp v230, v42 row_ror:8 row_mask:0xf bank_mask:0x3
    v_mov_b32_dpp v231, v43 row_ror:8 row_mask:0xf bank_mask:0x3
    v_mov_b32_dpp v234, v44 row_ror:8 row_mask:0xf bank_mask:0x3
    v_mov_b32_dpp v235, v45 row_ror:8 row_mask:0xf bank_mask:0x3
    v_mov_b32_dpp v238, v46 row_ror:8 row_mask:0xf bank_mask:0x3
    v_mov_b32_dpp v239, v47 row_ror:8 row_mask:0xf bank_mask:0x3
    v_perm_b32 v208, v228, v224, s40
    v_perm_b32 v209, v236, v232, s40
    v_perm_b32 v210, v230, v226, s40
    v_perm_b32 v211, v238, v234, s40
    v_perm_b32 v212, v228, v224, s41
    v_perm_b32 v213, v236, v232, s41
    v_perm_b32 v214, v230, v226, s41
    v_perm_b32 v215, v238, v234, s41
    v_perm_b32 v216, v229, v225, s40
    v_perm_b32 v217, v237, v233, s40
    v_perm_b32 v218, v231, v227, s40
    v_perm_b32 v219, v239, v235, s40
    v_perm_b32 v220, v229, v225, s41
    v_perm_b32 v221, v237, v233, s41
    v_perm_b32 v222, v231, v227, s41
    v_perm_b32 v223, v239, v235, s41
    s_cmp_eq_u32 s14, 7
    s_nop 0
    s_cbranch_scc1 SV_L
    s_lshl_b32 s36, s13, 10
    s_add_u32 s36, s36, 28311552
    s_lshl_b32 s37, s12, 12
    s_lshl_b32 s39, s15, 10
    s_add_u32 s37, s37, s39
    s_add_u32 s37, s37, 28326912
    s_add_u32 s39, s39, 7168
    s_add_u32 s1, s37, 2048
    s_add_u32 s38, s15, 1
    s_bitcmp1_b32 s38, 1
    s_cselect_b32 s0, s37, s36
    s_cselect_b32 s1, s1, s36
    s_cselect_b32 s70, 1.0, 0
    s_cselect_b32 s71, s39, 10240
    v_add_u32 v4, s71, v6
    s_waitcnt vmcnt(0)
    s_add_u32 s36, s43, 20480
    s_mov_b64 exec, 0x1
    buffer_store_dword v17, v16, s[24:27], s36 offen offset:0 sc1
    s_mov_b64 exec, -1
    s_barrier
    s_add_u32 s36, s19, 6
    s_and_b32 s37, s36, 1
    s_lshl_b32 s36, s36, 16
    s_lshl_b32 s37, s37, 15
    s_sub_u32 s36, s36, s37
    s_add_u32 s36, s36, s20
    buffer_load_dwordx4 v[240:243], v23, s[52:55], s36 offen offset:0
    buffer_load_dwordx4 v[244:247], v23, s[52:55], s36 offen offset:1024
    buffer_load_dwordx4 v[248:251], v23, s[52:55], s36 offen offset:2048
    buffer_load_dwordx4 v[252:255], v23, s[52:55], s36 offen offset:3072
    s_barrier
    s_add_u32 s36, s22, 688128
    s_add_u32 m0, s23, 113152
    s_nop 0
    buffer_load_dwordx4 v12, s[44:47], s36 offen lds
    s_add_u32 m0, s23, 117376
    s_nop 0
    buffer_load_dwordx4 v12, s[48:51], s36 offen lds
    s_add_u32 s36, s22, 688256
    s_add_u32 m0, s23, 121600
    s_nop 0
    buffer_load_dwordx4 v12, s[44:47], s36 offen lds
    s_add_u32 m0, s23, 125824
    s_nop 0
    buffer_load_dwordx4 v12, s[48:51], s36 offen lds
    s_barrier
    buffer_load_dword v18, v15, s[24:27], s65 offen sc1
    s_add_u32 s36, s22, 802816
    s_add_u32 m0, s23, 130048
    s_nop 0
    buffer_load_dwordx4 v12, s[44:47], s36 offen lds
    s_add_u32 m0, s23, 134272
    s_nop 0
    buffer_load_dwordx4 v12, s[48:51], s36 offen lds
    s_add_u32 s36, s22, 802944
    s_add_u32 m0, s23, 138496
    s_nop 0
    buffer_load_dwordx4 v12, s[44:47], s36 offen lds
    s_add_u32 m0, s23, 142720
    s_nop 0
    buffer_load_dwordx4 v12, s[48:51], s36 offen lds
    s_add_u32 m0, s23, 79360
    s_add_u32 s36, s16, 7077888
    buffer_load_dwordx4 v14, s[24:27], s36 offen sc1 lds
    s_add_u32 m0, s23, 83584
    s_add_u32 s36, s16, 7094272
    buffer_load_dwordx4 v14, s[24:27], s36 offen sc1 lds
    s_add_u32 m0, s23, 87808
    s_add_u32 s36, s16, 7208960
    buffer_load_dwordx4 v14, s[24:27], s36 offen sc1 lds
    s_add_u32 m0, s23, 92032
    s_add_u32 s36, s16, 7225344
    buffer_load_dwordx4 v14, s[24:27], s36 offen sc1 lds
    s_barrier
    s_waitcnt vmcnt(8)
    s_mov_b32 s38, 400000
KM_P2:
    v_cmp_ne_u32 vcc, 0, v18
    s_cmp_eq_u64 vcc, -1
    s_nop 3
    s_cbranch_scc1 KM_P2R
    s_sleep 4
KM_P2L:
    buffer_load_dword v18, v15, s[24:27], s65 offen sc1
    s_waitcnt vmcnt(0)
    s_sub_u32 s38, s38, 1
    s_cmp_lg_u32 s38, 0
    s_cbranch_scc1 KM_P2
KM_P2R:
    s_add_u32 m0, s23, 146944
    s_add_u32 s36, s16, 7340032
    buffer_load_dwordx4 v14, s[24:27], s36 offen sc1 lds
    s_add_u32 m0, s23, 151168
    s_add_u32 s36, s16, 7356416
    buffer_load_dwordx4 v14, s[24:27], s36 offen sc1 lds
    s_add_u32 s36, s22, 917504
    s_add_u32 m0, s23, 155392
KMPG10:
    s_cbranch_execz KMPG18
    s_nop 0
    buffer_load_dwordx4 v12, s[44:47], s36 offen lds
    s_add_u32 m0, s23, 159616
    s_nop 0
    buffer_load_dwordx4 v12, s[48:51], s36 offen lds
    s_barrier
    s_add_u32 m0, s23, 45568
    s_add_u32 s36, s16, 7471104
    buffer_load_dwordx4 v14, s[24:27], s36 offen sc1 lds
    s_add_u32 m0, s23, 49792
    s_add_u32 s36, s16, 7487488
    buffer_load_dwordx4 v14, s[24:27], s36 offen sc1 lds
    s_add_u32 s36, s22, 1032192
    s_add_u32 m0, s23, 54016
    s_nop 0
    buffer_load_dwordx4 v12, s[44:47], s36 offen lds
    s_add_u32 m0, s23, 58240
    s_nop 0
    buffer_load_dwordx4 v12, s[48:51], s36 offen lds
    s_add_u32 m0, s23, 96256
    s_add_u32 s36, s16, 7602176
    buffer_load_dwordx4 v14, s[24:27], s36 offen sc1 lds
    s_add_u32 m0, s23, 100480
    s_add_u32 s36, s16, 7618560
    buffer_load_dwordx4 v14, s[24:27], s36 offen sc1 lds
    s_add_u32 s36, s22, 1146880
    s_add_u32 m0, s23, 104704
    s_nop 0
    buffer_load_dwordx4 v12, s[44:47], s36 offen lds
    s_add_u32 m0, s23, 108928
    s_nop 0
    buffer_load_dwordx4 v12, s[48:51], s36 offen lds
    s_waitcnt vmcnt(14)
    s_barrier
    s_add_u32 m0, s23, 62464
    s_add_u32 s36, s16, 7733248
    buffer_load_dwordx4 v14, s[24:27], s36 offen sc1 lds
    s_add_u32 m0, s23, 66688
    s_add_u32 s36, s16, 7749632
    buffer_load_dwordx4 v14, s[24:27], s36 offen sc1 lds
    s_add_u32 s36, s22, 1261568
    s_add_u32 m0, s23, 70912
    s_nop 0
    buffer_load_dwordx4 v12, s[44:47], s36 offen lds
    s_add_u32 m0, s23, 75136
    s_nop 0
    buffer_load_dwordx4 v12, s[48:51], s36 offen lds
    v_mov_b32 v40, v240
    v_mov_b32 v41, v241
    v_mov_b32 v42, v244
    v_mov_b32 v43, v245
    v_mov_b32 v44, v248
    v_mov_b32 v45, v249
    v_mov_b32 v46, v252
    v_mov_b32 v47, v253
    v_mov_b32_dpp v240, v242 row_ror:8 row_mask:0xf bank_mask:0xc
    v_mov_b32_dpp v241, v243 row_ror:8 row_mask:0xf bank_mask:0xc
    v_mov_b32_dpp v244, v246 row_ror:8 row_mask:0xf bank_mask:0xc
    v_mov_b32_dpp v245, v247 row_ror:8 row_mask:0xf bank_mask:0xc
    v_mov_b32_dpp v248, v250 row_ror:8 row_mask:0xf bank_mask:0xc
    v_mov_b32_dpp v249, v251 row_ror:8 row_mask:0xf bank_mask:0xc
    v_mov_b32_dpp v252, v254 row_ror:8 row_mask:0xf bank_mask:0xc
    v_mov_b32_dpp v253, v255 row_ror:8 row_mask:0xf bank_mask:0xc
    v_mov_b32_dpp v242, v40 row_ror:8 row_mask:0xf bank_mask:0x3
    v_mov_b32_dpp v243, v41 row_ror:8 row_mask:0xf bank_mask:0x3
    v_mov_b32_dpp v246, v42 row_ror:8 row_mask:0xf bank_mask:0x3
    v_mov_b32_dpp v247, v43 row_ror:8 row_mask:0xf bank_mask:0x3
    v_mov_b32_dpp v250, v44 row_ror:8 row_mask:0xf bank_mask:0x3
    v_mov_b32_dpp v251, v45 row_ror:8 row_mask:0xf bank_mask:0x3
    v_mov_b32_dpp v254, v46 row_ror:8 row_mask:0xf bank_mask:0x3
    v_mov_b32_dpp v255, v47 row_ror:8 row_mask:0xf bank_mask:0x3
    v_perm_b32 v224, v244, v240, s40
    v_perm_b32 v225, v252, v248, s40
    v_perm_b32 v226, v246, v242, s40
    v_perm_b32 v227, v254, v250, s40
    v_perm_b32 v228, v244, v240, s41
    v_perm_b32 v229, v252, v248, s41
    v_perm_b32 v230, v246, v242, s41
    v_perm_b32 v231, v254, v250, s41
    v_perm_b32 v232, v245, v241, s40
    v_perm_b32 v233, v253, v249, s40
    v_perm_b32 v234, v247, v243, s40
    v_perm_b32 v235, v255, v251, s40
    v_perm_b32 v236, v245, v241, s41
    v_perm_b32 v237, v253, v249, s41
    v_perm_b32 v238, v247, v243, s41
    v_perm_b32 v239, v255, v251, s41
    s_waitcnt vmcnt(16)
    s_barrier
    s_add_u32 m0, s23, 11776
    s_add_u32 s36, s16, 7864320
    buffer_load_dwordx4 v14, s[24:27], s36 offen sc1 lds
    s_add_u32 m0, s23, 16000
    s_add_u32 s36, s16, 7880704
    buffer_load_dwordx4 v14, s[24:27], s36 offen sc1 lds
    s_add_u32 s36, s22, 1376256
    s_add_u32 m0, s23, 20224
    s_nop 0
    buffer_load_dwordx4 v12, s[44:47], s36 offen lds
    s_add_u32 m0, s23, 24448
    s_nop 0
    buffer_load_dwordx4 v12, s[48:51], s36 offen lds
    s_add_u32 m0, s23, 28672
    s_add_u32 s36, s16, 7995392
    buffer_load_dwordx4 v14, s[24:27], s36 offen sc1 lds
    s_add_u32 m0, s23, 32896
    s_add_u32 s36, s16, 8011776
    buffer_load_dwordx4 v14, s[24:27], s36 offen sc1 lds
    s_add_u32 s36, s22, 1490944
    s_add_u32 m0, s23, 37120
    s_nop 0
    buffer_load_dwordx4 v12, s[44:47], s36 offen lds
    s_add_u32 m0, s23, 41344
    s_nop 0
    buffer_load_dwordx4 v12, s[48:51], s36 offen lds
    s_waitcnt vmcnt(20)
    s_barrier
    s_add_u32 m0, s23, 113152
    s_add_u32 s36, s16, 8126464
    buffer_load_dwordx4 v14, s[24:27], s36 offen sc1 lds
    s_add_u32 m0, s23, 117376
    s_add_u32 s36, s16, 8142848
    buffer_load_dwordx4 v14, s[24:27], s36 offen sc1 lds
    s_add_u32 s36, s22, 1605632
    s_add_u32 m0, s23, 121600
    s_nop 0
    buffer_load_dwordx4 v12, s[44:47], s36 offen lds
    s_add_u32 m0, s23, 125824
    s_nop 0
    buffer_load_dwordx4 v12, s[48:51], s36 offen lds
    s_waitcnt vmcnt(16)
    s_barrier
    s_add_u32 m0, s23, 130048
    s_add_u32 s36, s16, 8257536
    buffer_load_dwordx4 v14, s[24:27], s36 offen sc1 lds
    s_add_u32 m0, s23, 134272
    s_add_u32 s36, s16, 8273920
    buffer_load_dwordx4 v14, s[24:27], s36 offen sc1 lds
    s_add_u32 s36, s22, 1720320
    s_add_u32 m0, s23, 138496
    s_nop 0
    buffer_load_dwordx4 v12, s[44:47], s36 offen lds
    s_add_u32 m0, s23, 142720
    s_nop 0
KMPG11:
    s_cbranch_execz KMPG19
    buffer_load_dwordx4 v12, s[48:51], s36 offen lds
    s_add_u32 s36, s19, 0
    s_and_b32 s37, s36, 1
    s_lshl_b32 s36, s36, 16
    s_lshl_b32 s37, s37, 15
    s_sub_u32 s36, s36, s37
    s_add_u32 s36, s36, s20
    s_add_u32 s36, s36, 65536
    s_add_u32 m0, s17, 79360
    s_nop 0
    buffer_load_dwordx4 v13, s[52:55], s36 offen offset:0 lds
    s_add_u32 m0, s17, 79392
    s_nop 0
    buffer_load_dwordx4 v13, s[52:55], s36 offen offset:1024 lds
    s_add_u32 m0, s17, 79424
    s_nop 0
    buffer_load_dwordx4 v13, s[52:55], s36 offen offset:2048 lds
    s_add_u32 m0, s17, 79456
    s_nop 0
    buffer_load_dwordx4 v13, s[52:55], s36 offen offset:3072 lds
    s_waitcnt vmcnt(16)
    s_barrier
    s_add_u32 s36, s22, 917632
    s_add_u32 m0, s23, 155392
    s_nop 0
    buffer_load_dwordx4 v12, s[44:47], s36 offen lds
    s_add_u32 m0, s23, 159616
    s_nop 0
    buffer_load_dwordx4 v12, s[48:51], s36 offen lds
    s_add_u32 s36, s22, 1032320
    s_add_u32 m0, s23, 54016
    s_nop 0
    buffer_load_dwordx4 v12, s[44:47], s36 offen lds
    s_add_u32 m0, s23, 58240
    s_nop 0
    buffer_load_dwordx4 v12, s[48:51], s36 offen lds
    buffer_load_dwordx4 v[32:35], v6, s[24:27], s0 offen sc1
    buffer_load_dwordx4 v[36:39], v6, s[24:27], s1 offen sc1
    s_lshl_b32 s36, s34, 2
    s_add_u32 s36, s36, s15
    s_lshl_b32 s36, s36, 16
    s_lshl_b32 s37, s13, 8
    s_add_u32 s36, s36, s37
    s_lshl_b32 s37, s35, 7
    s_add_u32 s36, s36, s37
    s_add_u32 s36, s36, 4194304
    s_lshl_b32 s37, s15, 11
    s_add_u32 m0, s37, 0
    s_nop 0
    buffer_load_dwordx4 v13, s[24:27], s36 offen sc1 lds
    s_add_u32 s36, s36, 31744
    buffer_load_dwordx4 v13, s[24:27], s36 offen offset:1024 sc1 lds
    s_waitcnt vmcnt(16)
    s_barrier
    s_add_u32 s36, s22, 1147008
    s_add_u32 m0, s23, 104704
    s_nop 0
    buffer_load_dwordx4 v12, s[44:47], s36 offen lds
    s_add_u32 m0, s23, 108928
    s_nop 0
    buffer_load_dwordx4 v12, s[48:51], s36 offen lds
    s_add_u32 s36, s22, 1261696
    s_add_u32 m0, s23, 70912
    s_nop 0
    buffer_load_dwordx4 v12, s[44:47], s36 offen lds
    s_add_u32 m0, s23, 75136
    s_nop 0
    buffer_load_dwordx4 v12, s[48:51], s36 offen lds
    s_waitcnt vmcnt(6)
    s_mov_b32 s38, 400000
KM_P3:
    v_max3_u32 v18, v32, v33, v34
    v_max3_u32 v19, v35, v36, v37
    v_max3_u32 v18, v18, v38, v39
    v_max_u32 v18, v18, v19
    v_cmp_eq_u32 vcc, -1, v18
    s_nop 4
    s_cbranch_vccz KM_P3R
    s_sleep 4
    buffer_load_dwordx4 v[32:35], v6, s[24:27], s0 offen sc1
    buffer_load_dwordx4 v[36:39], v6, s[24:27], s1 offen sc1
    s_waitcnt vmcnt(0)
    s_sub_u32 s38, s38, 1
    s_cmp_lg_u32 s38, 0
    s_cbranch_scc1 KM_P3
KM_P3R:
    v_fmac_f32 v32, s70, v36
    v_fmac_f32 v33, s70, v37
    v_fmac_f32 v34, s70, v38
    v_fmac_f32_e64 v35, s70, v39
    ds_write_b128 v4, v[32:35]
    s_waitcnt lgkmcnt(0)
    s_barrier
    s_add_u32 s36, s22, 1376384
    s_add_u32 m0, s23, 20224
    s_nop 0
    buffer_load_dwordx4 v12, s[44:47], s36 offen lds
    s_add_u32 m0, s23, 24448
    s_nop 0
    buffer_load_dwordx4 v12, s[48:51], s36 offen lds
    s_add_u32 s36, s22, 1491072
    s_add_u32 m0, s23, 37120
    s_nop 0
    buffer_load_dwordx4 v12, s[44:47], s36 offen lds
    s_add_u32 m0, s23, 41344
    s_nop 0
    buffer_load_dwordx4 v12, s[48:51], s36 offen lds
    s_waitcnt vmcnt(6)
    s_barrier
    s_add_u32 s36, s22, 1605760
    s_add_u32 m0, s23, 121600
    s_nop 0
    buffer_load_dwordx4 v12, s[44:47], s36 offen lds
    s_add_u32 m0, s23, 125824
    s_nop 0
    buffer_load_dwordx4 v12, s[48:51], s36 offen lds
    s_add_u32 s36, s22, 1720448
    s_add_u32 m0, s23, 138496
    s_nop 0
    buffer_load_dwordx4 v12, s[44:47], s36 offen lds
    s_add_u32 m0, s23, 142720
    s_nop 0
    buffer_load_dwordx4 v12, s[48:51], s36 offen lds
    s_waitcnt vmcnt(6)
    s_barrier
    s_add_u32 s36, s19, 1
    s_and_b32 s37, s36, 1
    s_lshl_b32 s36, s36, 16
    s_lshl_b32 s37, s37, 15
    s_sub_u32 s36, s36, s37
    s_add_u32 s36, s36, s20
    s_add_u32 s36, s36, 65536
    s_add_u32 m0, s17, 146944
    s_nop 0
    buffer_load_dwordx4 v13, s[52:55], s36 offen offset:0 lds
    s_add_u32 m0, s17, 146976
    s_nop 0
    buffer_load_dwordx4 v13, s[52:55], s36 offen offset:1024 lds
    s_add_u32 m0, s17, 147008
    s_nop 0
    buffer_load_dwordx4 v13, s[52:55], s36 offen offset:2048 lds
    s_add_u32 m0, s17, 147040
    s_nop 0
    buffer_load_dwordx4 v13, s[52:55], s36 offen offset:3072 lds
    s_waitcnt vmcnt(6)
    s_barrier
    s_add_u32 s36, s19, 2
    s_and_b32 s37, s36, 1
    s_lshl_b32 s36, s36, 16
    s_lshl_b32 s37, s37, 15
    s_sub_u32 s36, s36, s37
    s_add_u32 s36, s36, s20
    s_add_u32 s36, s36, 65536
    s_add_u32 m0, s17, 45568
    s_nop 0
    buffer_load_dwordx4 v13, s[52:55], s36 offen offset:0 lds
    s_add_u32 m0, s17, 45600
    s_nop 0
    buffer_load_dwordx4 v13, s[52:55], s36 offen offset:1024 lds
    s_add_u32 m0, s17, 45632
    s_nop 0
    buffer_load_dwordx4 v13, s[52:55], s36 offen offset:2048 lds
    s_add_u32 m0, s17, 45664
    s_nop 0
    buffer_load_dwordx4 v13, s[52:55], s36 offen offset:3072 lds
    s_add_u32 s36, s19, 3
    s_and_b32 s37, s36, 1
    s_lshl_b32 s36, s36, 16
    s_lshl_b32 s37, s37, 15
    s_sub_u32 s36, s36, s37
    s_add_u32 s36, s36, s20
    s_add_u32 s36, s36, 65536
    s_add_u32 m0, s17, 96256
KMPG12:
    s_cbranch_execz KMPG20
    s_nop 0
    buffer_load_dwordx4 v13, s[52:55], s36 offen offset:0 lds
    s_add_u32 m0, s17, 96288
    s_nop 0
    buffer_load_dwordx4 v13, s[52:55], s36 offen offset:1024 lds
    s_add_u32 m0, s17, 96320
    s_nop 0
    buffer_load_dwordx4 v13, s[52:55], s36 offen offset:2048 lds
    s_add_u32 m0, s17, 96352
    s_nop 0
    buffer_load_dwordx4 v13, s[52:55], s36 offen offset:3072 lds
    s_lshl_b32 s36, s13, 1
    s_add_u32 s36, s36, s35
    s_lshl_b32 s36, s36, 1
    s_mul_i32 s37, s15, 7
    s_mul_i32 s61, s36, 4224
    s_mul_i32 s39, s37, 128
    s_add_u32 s61, s61, s39
    s_add_u32 s61, s61, 27262976
    s_mul_i32 s36, s36, 28
    s_add_u32 s36, s36, s37
    s_lshl_b32 s36, s36, 12
    s_add_u32 s60, s36, 16777216
    v_mul_u32_u24 v15, 128, v1
    s_add_u32 s4, s60, 0
    s_add_u32 s5, s60, 4096
    s_add_u32 s6, s60, 8192
    s_add_u32 s7, s60, 12288
    s_add_u32 s0, s60, 16384
    s_add_u32 s1, s60, 20480
    s_add_u32 s3, s60, 24576
    s_add_u32 s36, s33, 0
    s_and_b32 s36, s36, 3
    s_lshl_b32 s36, s36, 10
    v_add_u32 v9, s36, v6
    s_add_u32 s36, s33, 1
    s_and_b32 s36, s36, 3
    s_lshl_b32 s36, s36, 10
    v_add_u32 v10, s36, v6
    s_add_u32 s36, s33, 2
    s_and_b32 s36, s36, 3
    s_lshl_b32 s36, s36, 10
    v_add_u32 v11, s36, v6
    s_add_u32 s36, s33, 3
    s_and_b32 s36, s36, 3
    s_lshl_b32 s36, s36, 10
    v_add_u32 v12, s36, v6
    s_mov_b64 exec, 0x7f
    buffer_load_dword v14, v15, s[24:27], s61 offen sc1
    s_mov_b64 exec, -1
    s_waitcnt vmcnt(13)
    s_barrier
    s_add_u32 s36, s19, 4
    s_and_b32 s37, s36, 1
    s_lshl_b32 s36, s36, 16
    s_lshl_b32 s37, s37, 15
    s_sub_u32 s36, s36, s37
    s_add_u32 s36, s36, s20
    s_add_u32 s36, s36, 65536
    s_add_u32 m0, s17, 62464
    s_nop 0
    buffer_load_dwordx4 v13, s[52:55], s36 offen offset:0 lds
    s_add_u32 m0, s17, 62496
    s_nop 0
    buffer_load_dwordx4 v13, s[52:55], s36 offen offset:1024 lds
    s_add_u32 m0, s17, 62528
    s_nop 0
    buffer_load_dwordx4 v13, s[52:55], s36 offen offset:2048 lds
    s_add_u32 m0, s17, 62560
    s_nop 0
    buffer_load_dwordx4 v13, s[52:55], s36 offen offset:3072 lds
    s_add_u32 s36, s19, 5
    s_and_b32 s37, s36, 1
    s_lshl_b32 s36, s36, 16
    s_lshl_b32 s37, s37, 15
    s_sub_u32 s36, s36, s37
    s_add_u32 s36, s36, s20
    s_add_u32 s36, s36, 65536
    s_add_u32 m0, s17, 11776
    s_nop 0
    buffer_load_dwordx4 v13, s[52:55], s36 offen offset:0 lds
    s_add_u32 m0, s17, 11808
    s_nop 0
    buffer_load_dwordx4 v13, s[52:55], s36 offen offset:1024 lds
    s_add_u32 m0, s17, 11840
    s_nop 0
    buffer_load_dwordx4 v13, s[52:55], s36 offen offset:2048 lds
    s_add_u32 m0, s17, 11872
    s_nop 0
    buffer_load_dwordx4 v13, s[52:55], s36 offen offset:3072 lds
    s_add_u32 s36, s19, 6
    s_and_b32 s37, s36, 1
    s_lshl_b32 s36, s36, 16
    s_lshl_b32 s37, s37, 15
    s_sub_u32 s36, s36, s37
    s_add_u32 s36, s36, s20
    s_add_u32 s36, s36, 65536
    s_add_u32 m0, s17, 28672
    s_nop 0
    buffer_load_dwordx4 v13, s[52:55], s36 offen offset:0 lds
    s_add_u32 m0, s17, 28704
    s_nop 0
    buffer_load_dwordx4 v13, s[52:55], s36 offen offset:1024 lds
    s_add_u32 m0, s17, 28736
    s_nop 0
    buffer_load_dwordx4 v13, s[52:55], s36 offen offset:2048 lds
    s_add_u32 m0, s17, 28768
    s_nop 0
    buffer_load_dwordx4 v13, s[52:55], s36 offen offset:3072 lds
    s_waitcnt vmcnt(12)
    v_cmp_ne_u32 vcc, 0, v14
    s_and_b32 s36, vcc_lo, 0x7f
    s_cmp_eq_u32 s36, 0x7f
    s_nop 2
    s_cbranch_scc1 KM_LT
    s_mov_b64 exec, 0x7f
    s_mov_b32 s38, 400000
    s_branch KM_P4L
KM_P4:
    v_cmp_ne_u32 vcc, 0, v14
    s_cmp_eq_u64 vcc, 0x7f
    s_nop 3
    s_cbranch_scc1 KM_P4R
    s_sleep 4
KM_P4L:
    buffer_load_dword v14, v15, s[24:27], s61 offen sc1
    s_waitcnt vmcnt(0)
    s_sub_u32 s38, s38, 1
    s_cmp_lg_u32 s38, 0
    s_cbranch_scc1 KM_P4
KM_P4R:
    s_mov_b64 exec, -1
    s_branch KM_LT
SV_L:
    s_waitcnt vmcnt(0)
    s_add_u32 s36, s43, 20480
    s_mov_b64 exec, 0x1
    buffer_store_dword v17, v16, s[24:27], s36 offen offset:0 sc1
    s_mov_b64 exec, -1
    v_lshrrev_b32 v14, 3, v1
    v_lshlrev_b32 v14, 14, v14
    v_and_b32 v18, 7, v1
    v_lshl_add_u32 v14, v18, 4, v14
    s_lshl_b32 s36, s11, 7
    s_add_u32 s16, s16, s36
    s_barrier
    s_mov_b32 s38, 400000
    s_branch SV_P1L
SV_P1:
    v_cmp_ne_u32 vcc, 0, v18
    s_cmp_eq_u64 vcc, -1
    s_nop 3
    s_cbranch_scc1 SV_P1R
    s_sleep 8
SV_P1L:
    buffer_load_dword v18, v15, s[24:27], s64 offen sc1
    s_waitcnt vmcnt(0)
    s_sub_u32 s38, s38, 1
    s_cmp_lg_u32 s38, 0
    s_cbranch_scc1 SV_P1
SV_P1R:
    s_add_u32 m0, s23, 11776
    s_add_u32 s36, s16, 4194304
    buffer_load_dwordx4 v14, s[24:27], s36 offen sc1 lds
    s_add_u32 m0, s23, 16000
    s_add_u32 s36, s16, 4325376
    buffer_load_dwordx4 v14, s[24:27], s36 offen sc1 lds
    s_add_u32 m0, s23, 20224
    s_add_u32 s36, s16, 4456448
    buffer_load_dwordx4 v14, s[24:27], s36 offen sc1 lds
    s_add_u32 m0, s23, 24448
    s_add_u32 s36, s16, 4587520
    buffer_load_dwordx4 v14, s[24:27], s36 offen sc1 lds
    s_add_u32 m0, s23, 28672
    s_add_u32 s36, s16, 4718592
    buffer_load_dwordx4 v14, s[24:27], s36 offen sc1 lds
    s_add_u32 m0, s23, 32896
    s_add_u32 s36, s16, 4849664
    buffer_load_dwordx4 v14, s[24:27], s36 offen sc1 lds
    s_add_u32 m0, s23, 37120
    s_add_u32 s36, s16, 4980736
    buffer_load_dwordx4 v14, s[24:27], s36 offen sc1 lds
    s_add_u32 m0, s23, 41344
KMPG13:
    s_cbranch_execz KMPG21
    s_add_u32 s36, s16, 5111808
    buffer_load_dwordx4 v14, s[24:27], s36 offen sc1 lds
    s_mov_b32 s38, 400000
    s_branch SV_P2L
SV_P2:
    v_cmp_ne_u32 vcc, 0, v18
    s_cmp_eq_u64 vcc, -1
    s_nop 3
    s_cbranch_scc1 SV_P2R
    s_sleep 8
SV_P2L:
    buffer_load_dword v18, v15, s[24:27], s65 offen sc1
    s_waitcnt vmcnt(0)
    s_sub_u32 s38, s38, 1
    s_cmp_lg_u32 s38, 0
    s_cbranch_scc1 SV_P2
SV_P2R:
    s_add_u32 m0, s23, 45568
    s_add_u32 s36, s16, 5242880
    buffer_load_dwordx4 v14, s[24:27], s36 offen sc1 lds
    s_add_u32 m0, s23, 49792
    s_add_u32 s36, s16, 5373952
    buffer_load_dwordx4 v14, s[24:27], s36 offen sc1 lds
    s_add_u32 m0, s23, 54016
    s_add_u32 s36, s16, 5505024
    buffer_load_dwordx4 v14, s[24:27], s36 offen sc1 lds
    s_add_u32 m0, s23, 58240
    s_add_u32 s36, s16, 5636096
    buffer_load_dwordx4 v14, s[24:27], s36 offen sc1 lds
    s_add_u32 m0, s23, 62464
    s_add_u32 s36, s16, 5767168
    buffer_load_dwordx4 v14, s[24:27], s36 offen sc1 lds
    s_add_u32 m0, s23, 66688
    s_add_u32 s36, s16, 5898240
    buffer_load_dwordx4 v14, s[24:27], s36 offen sc1 lds
    s_add_u32 m0, s23, 70912
    s_add_u32 s36, s16, 6029312
    buffer_load_dwordx4 v14, s[24:27], s36 offen sc1 lds
    s_add_u32 m0, s23, 75136
    s_add_u32 s36, s16, 6160384
    buffer_load_dwordx4 v14, s[24:27], s36 offen sc1 lds
    s_barrier
    s_waitcnt vmcnt(0)
    s_barrier
    s_barrier
    s_add_u32 s36, s19, 6
    s_and_b32 s37, s36, 1
    s_lshl_b32 s36, s36, 16
    s_lshl_b32 s37, s37, 15
    s_sub_u32 s36, s36, s37
    s_add_u32 s36, s36, s20
    buffer_load_dwordx4 v[240:243], v23, s[52:55], s36 offen offset:0
    buffer_load_dwordx4 v[244:247], v23, s[52:55], s36 offen offset:1024
    buffer_load_dwordx4 v[248:251], v23, s[52:55], s36 offen offset:2048
    buffer_load_dwordx4 v[252:255], v23, s[52:55], s36 offen offset:3072
    s_lshl_b32 s36, s34, 2
    s_add_u32 s36, s36, s15
    s_lshl_b32 s36, s36, 16
    s_lshl_b32 s37, s13, 8
    s_add_u32 s36, s36, s37
    s_lshl_b32 s37, s35, 7
    s_add_u32 s36, s36, s37
    s_add_u32 s36, s36, 4194304
    s_lshl_b32 s37, s15, 11
    s_add_u32 m0, s37, 0
    s_nop 0
    buffer_load_dwordx4 v13, s[24:27], s36 offen sc1 lds
    s_add_u32 s36, s36, 31744
    buffer_load_dwordx4 v13, s[24:27], s36 offen offset:1024 sc1 lds
    s_add_u32 s36, s19, 0
    s_and_b32 s37, s36, 1
    s_lshl_b32 s36, s36, 16
    s_lshl_b32 s37, s37, 15
    s_sub_u32 s36, s36, s37
    s_add_u32 s36, s36, s20
    s_add_u32 s36, s36, 65536
    s_add_u32 m0, s17, 79360
    s_nop 0
    buffer_load_dwordx4 v13, s[52:55], s36 offen offset:0 lds
    s_add_u32 m0, s17, 79392
    s_nop 0
    buffer_load_dwordx4 v13, s[52:55], s36 offen offset:1024 lds
    s_add_u32 m0, s17, 79424
    s_nop 0
    buffer_load_dwordx4 v13, s[52:55], s36 offen offset:2048 lds
    s_add_u32 m0, s17, 79456
    s_nop 0
    buffer_load_dwordx4 v13, s[52:55], s36 offen offset:3072 lds
    s_add_u32 s36, s19, 1
    s_and_b32 s37, s36, 1
    s_lshl_b32 s36, s36, 16
    s_lshl_b32 s37, s37, 15
    s_sub_u32 s36, s36, s37
    s_add_u32 s36, s36, s20
    s_add_u32 s36, s36, 65536
    s_add_u32 m0, s17, 146944
    s_nop 0
    buffer_load_dwordx4 v13, s[52:55], s36 offen offset:0 lds
    s_add_u32 m0, s17, 146976
    s_nop 0
    buffer_load_dwordx4 v13, s[52:55], s36 offen offset:1024 lds
    s_add_u32 m0, s17, 147008
    s_nop 0
    buffer_load_dwordx4 v13, s[52:55], s36 offen offset:2048 lds
    s_add_u32 m0, s17, 147040
    s_nop 0
    buffer_load_dwordx4 v13, s[52:55], s36 offen offset:3072 lds
    s_add_u32 s36, s19, 2
    s_and_b32 s37, s36, 1
    s_lshl_b32 s36, s36, 16
    s_lshl_b32 s37, s37, 15
    s_sub_u32 s36, s36, s37
    s_add_u32 s36, s36, s20
    s_add_u32 s36, s36, 65536
    s_add_u32 m0, s17, 45568
    s_nop 0
    buffer_load_dwordx4 v13, s[52:55], s36 offen offset:0 lds
    s_add_u32 m0, s17, 45600
    s_nop 0
    buffer_load_dwordx4 v13, s[52:55], s36 offen offset:1024 lds
    s_add_u32 m0, s17, 45632
    s_nop 0
    buffer_load_dwordx4 v13, s[52:55], s36 offen offset:2048 lds
    s_add_u32 m0, s17, 45664
    s_nop 0
    buffer_load_dwordx4 v13, s[52:55], s36 offen offset:3072 lds
    s_add_u32 s36, s19, 3
    s_and_b32 s37, s36, 1
    s_lshl_b32 s36, s36, 16
    s_lshl_b32 s37, s37, 15
    s_sub_u32 s36, s36, s37
    s_add_u32 s36, s36, s20
    s_add_u32 s36, s36, 65536
    s_add_u32 m0, s17, 96256
    s_nop 0
    buffer_load_dwordx4 v13, s[52:55], s36 offen offset:0 lds
    s_add_u32 m0, s17, 96288
    s_nop 0
    buffer_load_dwordx4 v13, s[52:55], s36 offen offset:1024 lds
    s_add_u32 m0, s17, 96320
    s_nop 0
    buffer_load_dwordx4 v13, s[52:55], s36 offen offset:2048 lds
    s_add_u32 m0, s17, 96352
    s_nop 0
    buffer_load_dwordx4 v13, s[52:55], s36 offen offset:3072 lds
    s_add_u32 s36, s19, 4
    s_and_b32 s37, s36, 1
    s_lshl_b32 s36, s36, 16
    s_lshl_b32 s37, s37, 15
    s_sub_u32 s36, s36, s37
    s_add_u32 s36, s36, s20
    s_add_u32 s36, s36, 65536
    s_add_u32 m0, s17, 62464
    s_nop 0
    buffer_load_dwordx4 v13, s[52:55], s36 offen offset:0 lds
    s_add_u32 m0, s17, 62496
    s_nop 0
    buffer_load_dwordx4 v13, s[52:55], s36 offen offset:1024 lds
    s_add_u32 m0, s17, 62528
    s_nop 0
    buffer_load_dwordx4 v13, s[52:55], s36 offen offset:2048 lds
    s_add_u32 m0, s17, 62560
    s_nop 0
    buffer_load_dwordx4 v13, s[52:55], s36 offen offset:3072 lds
    s_add_u32 s36, s19, 5
    s_and_b32 s37, s36, 1
    s_lshl_b32 s36, s36, 16
    s_lshl_b32 s37, s37, 15
    s_sub_u32 s36, s36, s37
    s_add_u32 s36, s36, s20
    s_add_u32 s36, s36, 65536
    s_add_u32 m0, s17, 11776
    s_nop 0
    buffer_load_dwordx4 v13, s[52:55], s36 offen offset:0 lds
KMPG14:
    s_cbranch_execz KMPG22
    s_add_u32 m0, s17, 11808
    s_nop 0
    buffer_load_dwordx4 v13, s[52:55], s36 offen offset:1024 lds
    s_add_u32 m0, s17, 11840
    s_nop 0
    buffer_load_dwordx4 v13, s[52:55], s36 offen offset:2048 lds
    s_add_u32 m0, s17, 11872
    s_nop 0
    buffer_load_dwordx4 v13, s[52:55], s36 offen offset:3072 lds
    s_add_u32 s36, s19, 6
    s_and_b32 s37, s36, 1
    s_lshl_b32 s36, s36, 16
    s_lshl_b32 s37, s37, 15
    s_sub_u32 s36, s36, s37
    s_add_u32 s36, s36, s20
    s_add_u32 s36, s36, 65536
    s_add_u32 m0, s17, 28672
    s_nop 0
    buffer_load_dwordx4 v13, s[52:55], s36 offen offset:0 lds
    s_add_u32 m0, s17, 28704
    s_nop 0
    buffer_load_dwordx4 v13, s[52:55], s36 offen offset:1024 lds
    s_add_u32 m0, s17, 28736
    s_nop 0
    buffer_load_dwordx4 v13, s[52:55], s36 offen offset:2048 lds
    s_add_u32 m0, s17, 28768
    s_nop 0
    buffer_load_dwordx4 v13, s[52:55], s36 offen offset:3072 lds
    s_waitcnt vmcnt(30)
    v_mov_b32 v40, v240
    v_mov_b32 v41, v241
    v_mov_b32 v42, v244
    v_mov_b32 v43, v245
    v_mov_b32 v44, v248
    v_mov_b32 v45, v249
    v_mov_b32 v46, v252
    v_mov_b32 v47, v253
    v_mov_b32_dpp v240, v242 row_ror:8 row_mask:0xf bank_mask:0xc
    v_mov_b32_dpp v241, v243 row_ror:8 row_mask:0xf bank_mask:0xc
    v_mov_b32_dpp v244, v246 row_ror:8 row_mask:0xf bank_mask:0xc
    v_mov_b32_dpp v245, v247 row_ror:8 row_mask:0xf bank_mask:0xc
    v_mov_b32_dpp v248, v250 row_ror:8 row_mask:0xf bank_mask:0xc
    v_mov_b32_dpp v249, v251 row_ror:8 row_mask:0xf bank_mask:0xc
    v_mov_b32_dpp v252, v254 row_ror:8 row_mask:0xf bank_mask:0xc
    v_mov_b32_dpp v253, v255 row_ror:8 row_mask:0xf bank_mask:0xc
    v_mov_b32_dpp v242, v40 row_ror:8 row_mask:0xf bank_mask:0x3
    v_mov_b32_dpp v243, v41 row_ror:8 row_mask:0xf bank_mask:0x3
    v_mov_b32_dpp v246, v42 row_ror:8 row_mask:0xf bank_mask:0x3
    v_mov_b32_dpp v247, v43 row_ror:8 row_mask:0xf bank_mask:0x3
    v_mov_b32_dpp v250, v44 row_ror:8 row_mask:0xf bank_mask:0x3
    v_mov_b32_dpp v251, v45 row_ror:8 row_mask:0xf bank_mask:0x3
    v_mov_b32_dpp v254, v46 row_ror:8 row_mask:0xf bank_mask:0x3
    v_mov_b32_dpp v255, v47 row_ror:8 row_mask:0xf bank_mask:0x3
    v_perm_b32 v224, v244, v240, s40
    v_perm_b32 v225, v252, v248, s40
    v_perm_b32 v226, v246, v242, s40
    v_perm_b32 v227, v254, v250, s40
    v_perm_b32 v228, v244, v240, s41
    v_perm_b32 v229, v252, v248, s41
    v_perm_b32 v230, v246, v242, s41
    v_perm_b32 v231, v254, v250, s41
    v_perm_b32 v232, v245, v241, s40
    v_perm_b32 v233, v253, v249, s40
    v_perm_b32 v234, v247, v243, s40
    v_perm_b32 v235, v255, v251, s40
    v_perm_b32 v236, v245, v241, s41
    v_perm_b32 v237, v253, v249, s41
    v_perm_b32 v238, v247, v243, s41
    v_perm_b32 v239, v255, v251, s41
    s_barrier
    s_lshl_b32 s36, s13, 1
    s_add_u32 s36, s36, s35
    s_lshl_b32 s36, s36, 1
    s_mul_i32 s37, s15, 7
    s_mul_i32 s61, s36, 4224
    s_mul_i32 s39, s37, 128
    s_add_u32 s61, s61, s39
    s_add_u32 s61, s61, 27262976
    s_mul_i32 s36, s36, 28
    s_add_u32 s36, s36, s37
    s_lshl_b32 s36, s36, 12
    s_add_u32 s60, s36, 16777216
    v_mul_u32_u24 v15, 128, v1
    s_add_u32 s4, s60, 0
    s_add_u32 s5, s60, 4096
    s_add_u32 s6, s60, 8192
    s_add_u32 s7, s60, 12288
    s_add_u32 s0, s60, 16384
    s_add_u32 s1, s60, 20480
    s_add_u32 s3, s60, 24576
    s_add_u32 s36, s33, 0
    s_and_b32 s36, s36, 3
    s_lshl_b32 s36, s36, 10
    v_add_u32 v9, s36, v6
    s_add_u32 s36, s33, 1
    s_and_b32 s36, s36, 3
    s_lshl_b32 s36, s36, 10
    v_add_u32 v10, s36, v6
    s_add_u32 s36, s33, 2
    s_and_b32 s36, s36, 3
    s_lshl_b32 s36, s36, 10
    v_add_u32 v11, s36, v6
    s_add_u32 s36, s33, 3
    s_and_b32 s36, s36, 3
    s_lshl_b32 s36, s36, 10
    v_add_u32 v12, s36, v6
    s_mov_b64 exec, 0x7f
    s_mov_b32 s38, 400000
    s_branch SV_P4L
SV_P4:
    v_cmp_ne_u32 vcc, 0, v14
    s_cmp_eq_u64 vcc, 0x7f
    s_nop 3
    s_cbranch_scc1 SV_P4R
    s_sleep 16
SV_P4L:
    buffer_load_dword v14, v15, s[24:27], s61 offen sc1
    s_waitcnt vmcnt(0)
    s_sub_u32 s38, s38, 1
    s_cmp_lg_u32 s38, 0
    s_cbranch_scc1 SV_P4
SV_P4R:
    s_mov_b64 exec, -1
KM_LT:
    buffer_load_dwordx4 v[80:83], v9, s[24:27], s4 offen sc1
    buffer_load_dwordx4 v[84:87], v9, s[24:27], s5 offen sc1
    buffer_load_dwordx4 v[88:91], v9, s[24:27], s6 offen sc1
    buffer_load_dwordx4 v[92:95], v9, s[24:27], s7 offen sc1
    buffer_load_dwordx4 v[96:99], v9, s[24:27], s0 offen sc1
    buffer_load_dwordx4 v[100:103], v9, s[24:27], s1 offen sc1
    buffer_load_dwordx4 v[104:107], v9, s[24:27], s3 offen sc1
    s_waitcnt vmcnt(7)
    s_barrier
    buffer_load_dwordx4 v[108:111], v10, s[24:27], s4 offen sc1
    buffer_load_dwordx4 v[112:115], v10, s[24:27], s5 offen sc1
    buffer_load_dwordx4 v[116:119], v10, s[24:27], s6 offen sc1
    buffer_load_dwordx4 v[120:123], v10, s[24:27], s7 offen sc1
    buffer_load_dwordx4 v[124:127], v10, s[24:27], s0 offen sc1
    buffer_load_dwordx4 v[16:19], v10, s[24:27], s1 offen sc1
    buffer_load_dwordx4 v[20:23], v10, s[24:27], s3 offen sc1
    s_barrier
    s_waitcnt vmcnt(13)
    v_mfma_f32_16x16x32_bf16 v[64:67], v[128:131], v[80:83], 0
    buffer_load_dwordx4 v[24:27], v11, s[24:27], s4 offen sc1
    v_mfma_f32_16x16x32_bf16 v[68:71], v[132:135], v[80:83], 0
    v_mfma_f32_16x16x32_bf16 v[72:75], v[136:139], v[80:83], 0
    v_mfma_f32_16x16x32_bf16 v[76:79], v[140:143], v[80:83], 0
    s_waitcnt vmcnt(13)
    v_mfma_f32_16x16x32_bf16 v[64:67], v[144:147], v[84:87], v[64:67]
    buffer_load_dwordx4 v[28:31], v11, s[24:27], s5 offen sc1
    v_mfma_f32_16x16x32_bf16 v[68:71], v[148:151], v[84:87], v[68:71]
    v_mfma_f32_16x16x32_bf16 v[72:75], v[152:155], v[84:87], v[72:75]
    v_mfma_f32_16x16x32_bf16 v[76:79], v[156:159], v[84:87], v[76:79]
    s_waitcnt vmcnt(13)
    v_mfma_f32_16x16x32_bf16 v[64:67], v[160:163], v[88:91], v[64:67]
    buffer_load_dwordx4 v[32:35], v11, s[24:27], s6 offen sc1
    v_mfma_f32_16x16x32_bf16 v[68:71], v[164:167], v[88:91], v[68:71]
    v_mfma_f32_16x16x32_bf16 v[72:75], v[168:171], v[88:91], v[72:75]
    v_mfma_f32_16x16x32_bf16 v[76:79], v[172:175], v[88:91], v[76:79]
    s_waitcnt vmcnt(13)
    v_mfma_f32_16x16x32_bf16 v[64:67], v[176:179], v[92:95], v[64:67]
    buffer_load_dwordx4 v[36:39], v11, s[24:27], s7 offen sc1
    v_mfma_f32_16x16x32_bf16 v[68:71], v[180:183], v[92:95], v[68:71]
    v_mfma_f32_16x16x32_bf16 v[72:75], v[184:187], v[92:95], v[72:75]
KMPG15:
    s_cbranch_execz KMPG23
    v_mfma_f32_16x16x32_bf16 v[76:79], v[188:191], v[92:95], v[76:79]
    s_waitcnt vmcnt(13)
    v_mfma_f32_16x16x32_bf16 v[64:67], v[192:195], v[96:99], v[64:67]
    buffer_load_dwordx4 v[40:43], v11, s[24:27], s0 offen sc1
    v_mfma_f32_16x16x32_bf16 v[68:71], v[196:199], v[96:99], v[68:71]
    v_mfma_f32_16x16x32_bf16 v[72:75], v[200:203], v[96:99], v[72:75]
    v_mfma_f32_16x16x32_bf16 v[76:79], v[204:207], v[96:99], v[76:79]
    s_waitcnt vmcnt(13)
    v_mfma_f32_16x16x32_bf16 v[64:67], v[208:211], v[100:103], v[64:67]
    buffer_load_dwordx4 v[44:47], v11, s[24:27], s1 offen sc1
    v_mfma_f32_16x16x32_bf16 v[68:71], v[212:215], v[100:103], v[68:71]
    v_mfma_f32_16x16x32_bf16 v[72:75], v[216:219], v[100:103], v[72:75]
    v_mfma_f32_16x16x32_bf16 v[76:79], v[220:223], v[100:103], v[76:79]
    s_waitcnt vmcnt(13)
    v_mfma_f32_16x16x32_bf16 v[64:67], v[224:227], v[104:107], v[64:67]
    buffer_load_dwordx4 v[48:51], v11, s[24:27], s3 offen sc1
    v_mfma_f32_16x16x32_bf16 v[68:71], v[228:231], v[104:107], v[68:71]
    v_mfma_f32_16x16x32_bf16 v[72:75], v[232:235], v[104:107], v[72:75]
    v_mfma_f32_16x16x32_bf16 v[76:79], v[236:239], v[104:107], v[76:79]
    s_waitcnt vmcnt(13)
    v_mfma_f32_16x16x32_bf16 v[80:83], v[128:131], v[108:111], 0
    buffer_load_dwordx4 v[52:55], v12, s[24:27], s4 offen sc1
    v_mfma_f32_16x16x32_bf16 v[84:87], v[132:135], v[108:111], 0
    v_mfma_f32_16x16x32_bf16 v[88:91], v[136:139], v[108:111], 0
    v_mfma_f32_16x16x32_bf16 v[92:95], v[140:143], v[108:111], 0
    s_waitcnt vmcnt(13)
    v_mfma_f32_16x16x32_bf16 v[80:83], v[144:147], v[112:115], v[80:83]
    buffer_load_dwordx4 v[56:59], v12, s[24:27], s5 offen sc1
    v_mfma_f32_16x16x32_bf16 v[84:87], v[148:151], v[112:115], v[84:87]
    v_mfma_f32_16x16x32_bf16 v[88:91], v[152:155], v[112:115], v[88:91]
    v_mfma_f32_16x16x32_bf16 v[92:95], v[156:159], v[112:115], v[92:95]
    s_waitcnt vmcnt(13)
    v_mfma_f32_16x16x32_bf16 v[80:83], v[160:163], v[116:119], v[80:83]
    buffer_load_dwordx4 v[60:63], v12, s[24:27], s6 offen sc1
    v_mfma_f32_16x16x32_bf16 v[84:87], v[164:167], v[116:119], v[84:87]
    v_mfma_f32_16x16x32_bf16 v[88:91], v[168:171], v[116:119], v[88:91]
    v_mfma_f32_16x16x32_bf16 v[92:95], v[172:175], v[116:119], v[92:95]
    s_waitcnt vmcnt(13)
    v_mfma_f32_16x16x32_bf16 v[80:83], v[176:179], v[120:123], v[80:83]
    buffer_load_dwordx4 v[240:243], v12, s[24:27], s7 offen sc1
    v_mfma_f32_16x16x32_bf16 v[84:87], v[180:183], v[120:123], v[84:87]
    v_mfma_f32_16x16x32_bf16 v[88:91], v[184:187], v[120:123], v[88:91]
    v_mfma_f32_16x16x32_bf16 v[92:95], v[188:191], v[120:123], v[92:95]
    s_waitcnt vmcnt(13)
    v_mfma_f32_16x16x32_bf16 v[80:83], v[192:195], v[124:127], v[80:83]
    buffer_load_dwordx4 v[244:247], v12, s[24:27], s0 offen sc1
    v_mfma_f32_16x16x32_bf16 v[84:87], v[196:199], v[124:127], v[84:87]
    v_mfma_f32_16x16x32_bf16 v[88:91], v[200:203], v[124:127], v[88:91]
    v_mfma_f32_16x16x32_bf16 v[92:95], v[204:207], v[124:127], v[92:95]
    s_waitcnt vmcnt(13)
    v_mfma_f32_16x16x32_bf16 v[80:83], v[208:211], v[16:19], v[80:83]
    buffer_load_dwordx4 v[248:251], v12, s[24:27], s1 offen sc1
    v_mfma_f32_16x16x32_bf16 v[84:87], v[212:215], v[16:19], v[84:87]
    v_mfma_f32_16x16x32_bf16 v[88:91], v[216:219], v[16:19], v[88:91]
    v_mfma_f32_16x16x32_bf16 v[92:95], v[220:223], v[16:19], v[92:95]
    s_waitcnt vmcnt(13)
    v_mfma_f32_16x16x32_bf16 v[80:83], v[224:227], v[20:23], v[80:83]
    buffer_load_dwordx4 v[252:255], v12, s[24:27], s3 offen sc1
    v_mfma_f32_16x16x32_bf16 v[84:87], v[228:231], v[20:23], v[84:87]
    v_mfma_f32_16x16x32_bf16 v[88:91], v[232:235], v[20:23], v[88:91]
    v_mfma_f32_16x16x32_bf16 v[92:95], v[236:239], v[20:23], v[92:95]
    s_waitcnt vmcnt(13)
    v_mfma_f32_16x16x32_bf16 v[96:99], v[128:131], v[24:27], 0
    v_mfma_f32_16x16x32_bf16 v[100:103], v[132:135], v[24:27], 0
    v_mfma_f32_16x16x32_bf16 v[104:107], v[136:139], v[24:27], 0
    v_mfma_f32_16x16x32_bf16 v[108:111], v[140:143], v[24:27], 0
    s_waitcnt vmcnt(12)
    v_mfma_f32_16x16x32_bf16 v[96:99], v[144:147], v[28:31], v[96:99]
    v_mfma_f32_16x16x32_bf16 v[100:103], v[148:151], v[28:31], v[100:103]
    v_mfma_f32_16x16x32_bf16 v[104:107], v[152:155], v[28:31], v[104:107]
    v_mfma_f32_16x16x32_bf16 v[108:111], v[156:159], v[28:31], v[108:111]
    s_waitcnt vmcnt(11)
    v_mfma_f32_16x16x32_bf16 v[96:99], v[160:163], v[32:35], v[96:99]
    v_mfma_f32_16x16x32_bf16 v[100:103], v[164:167], v[32:35], v[100:103]
    v_mfma_f32_16x16x32_bf16 v[104:107], v[168:171], v[32:35], v[104:107]
    v_mfma_f32_16x16x32_bf16 v[108:111], v[172:175], v[32:35], v[108:111]
    s_waitcnt vmcnt(10)
    v_mfma_f32_16x16x32_bf16 v[96:99], v[176:179], v[36:39], v[96:99]
    v_mfma_f32_16x16x32_bf16 v[100:103], v[180:183], v[36:39], v[100:103]
    v_mfma_f32_16x16x32_bf16 v[104:107], v[184:187], v[36:39], v[104:107]
    v_mfma_f32_16x16x32_bf16 v[108:111], v[188:191], v[36:39], v[108:111]
    s_waitcnt vmcnt(9)
    v_mfma_f32_16x16x32_bf16 v[96:99], v[192:195], v[40:43], v[96:99]
    v_mfma_f32_16x16x32_bf16 v[100:103], v[196:199], v[40:43], v[100:103]
    v_mfma_f32_16x16x32_bf16 v[104:107], v[200:203], v[40:43], v[104:107]
    v_mfma_f32_16x16x32_bf16 v[108:111], v[204:207], v[40:43], v[108:111]
    s_waitcnt vmcnt(8)
    v_mfma_f32_16x16x32_bf16 v[96:99], v[208:211], v[44:47], v[96:99]
    v_mfma_f32_16x16x32_bf16 v[100:103], v[212:215], v[44:47], v[100:103]
    v_mfma_f32_16x16x32_bf16 v[104:107], v[216:219], v[44:47], v[104:107]
    v_mfma_f32_16x16x32_bf16 v[108:111], v[220:223], v[44:47], v[108:111]
    s_waitcnt vmcnt(7)
    v_mfma_f32_16x16x32_bf16 v[96:99], v[224:227], v[48:51], v[96:99]
    v_mfma_f32_16x16x32_bf16 v[100:103], v[228:231], v[48:51], v[100:103]
    v_mfma_f32_16x16x32_bf16 v[104:107], v[232:235], v[48:51], v[104:107]
    v_mfma_f32_16x16x32_bf16 v[108:111], v[236:239], v[48:51], v[108:111]
    s_waitcnt vmcnt(6)
    v_mfma_f32_16x16x32_bf16 v[112:115], v[128:131], v[52:55], 0
    v_mfma_f32_16x16x32_bf16 v[116:119], v[132:135], v[52:55], 0
    v_mfma_f32_16x16x32_bf16 v[120:123], v[136:139], v[52:55], 0
    v_mfma_f32_16x16x32_bf16 v[124:127], v[140:143], v[52:55], 0
    s_waitcnt vmcnt(5)
    v_mfma_f32_16x16x32_bf16 v[112:115], v[144:147], v[56:59], v[112:115]
    v_mfma_f32_16x16x32_bf16 v[116:119], v[148:151], v[56:59], v[116:119]
    v_mfma_f32_16x16x32_bf16 v[120:123], v[152:155], v[56:59], v[120:123]
    v_mfma_f32_16x16x32_bf16 v[124:127], v[156:159], v[56:59], v[124:127]
    s_waitcnt vmcnt(4)
    v_mfma_f32_16x16x32_bf16 v[112:115], v[160:163], v[60:63], v[112:115]
    v_mfma_f32_16x16x32_bf16 v[116:119], v[164:167], v[60:63], v[116:119]
    v_mfma_f32_16x16x32_bf16 v[120:123], v[168:171], v[60:63], v[120:123]
    v_mfma_f32_16x16x32_bf16 v[124:127], v[172:175], v[60:63], v[124:127]
    s_waitcnt vmcnt(3)
    v_mfma_f32_16x16x32_bf16 v[112:115], v[176:179], v[240:243], v[112:115]
    v_mfma_f32_16x16x32_bf16 v[116:119], v[180:183], v[240:243], v[116:119]
    v_mfma_f32_16x16x32_bf16 v[120:123], v[184:187], v[240:243], v[120:123]
    v_mfma_f32_16x16x32_bf16 v[124:127], v[188:191], v[240:243], v[124:127]
    s_waitcnt vmcnt(2)
    v_mfma_f32_16x16x32_bf16 v[112:115], v[192:195], v[244:247], v[112:115]
    v_mfma_f32_16x16x32_bf16 v[116:119], v[196:199], v[244:247], v[116:119]
    v_mfma_f32_16x16x32_bf16 v[120:123], v[200:203], v[244:247], v[120:123]
    v_mfma_f32_16x16x32_bf16 v[124:127], v[204:207], v[244:247], v[124:127]
    s_waitcnt vmcnt(1)
    v_mfma_f32_16x16x32_bf16 v[112:115], v[208:211], v[248:251], v[112:115]
    v_mfma_f32_16x16x32_bf16 v[116:119], v[212:215], v[248:251], v[116:119]
    v_mfma_f32_16x16x32_bf16 v[120:123], v[216:219], v[248:251], v[120:123]
    v_mfma_f32_16x16x32_bf16 v[124:127], v[220:223], v[248:251], v[124:127]
    s_waitcnt vmcnt(0)
    v_mfma_f32_16x16x32_bf16 v[112:115], v[224:227], v[252:255], v[112:115]
    v_mfma_f32_16x16x32_bf16 v[116:119], v[228:231], v[252:255], v[116:119]
    v_mfma_f32_16x16x32_bf16 v[120:123], v[232:235], v[252:255], v[120:123]
    v_mfma_f32_16x16x32_bf16 v[124:127], v[236:239], v[252:255], v[124:127]
    v_lshlrev_b32 v5, 4, v7
    v_and_b32 v4, 1, v8
    v_lshl_add_u32 v5, v4, 11, v5
    v_lshrrev_b32_e64 v4, 1, v8
    v_lshl_add_u32 v5, v4, 8, v5
    s_mul_i32 s17, s15, 4224
    v_add_u32_e64 v5, s17, v5
    v_add_u32 v16, 113152, v5
    v_mov_b32 v128, v64
    v_mov_b32 v129, v68
KMPG16:
    s_cbranch_execz KMPG24
    v_mov_b32 v130, v72
    v_mov_b32 v131, v76
    v_mov_b32 v132, v65
    v_mov_b32 v133, v69
    v_mov_b32 v134, v73
    v_mov_b32 v135, v77
    v_mov_b32 v136, v66
    v_mov_b32 v137, v70
    v_mov_b32 v138, v74
    v_mov_b32 v139, v78
    v_mov_b32 v140, v67
    v_mov_b32 v141, v71
    v_mov_b32 v142, v75
    v_mov_b32_e64 v143, v79
    v_add_u32 v17, 130048, v5
    v_mov_b32 v144, v80
    v_mov_b32 v145, v84
    v_mov_b32 v146, v88
    v_mov_b32 v147, v92
    v_mov_b32 v148, v81
    v_mov_b32 v149, v85
    v_mov_b32 v150, v89
    v_mov_b32 v151, v93
    v_mov_b32 v152, v82
    v_mov_b32 v153, v86
    v_mov_b32 v154, v90
    v_mov_b32 v155, v94
    v_mov_b32 v156, v83
    v_mov_b32 v157, v87
    v_mov_b32 v158, v91
    v_mov_b32 v159, v95
    v_add_u32 v18, 79360, v5
    v_mov_b32 v160, v96
    v_mov_b32 v161, v100
    v_mov_b32 v162, v104
    v_mov_b32 v163, v108
    v_mov_b32 v164, v97
    v_mov_b32 v165, v101
    v_mov_b32 v166, v105
    v_mov_b32 v167, v109
    v_mov_b32 v168, v98
    v_mov_b32 v169, v102
    v_mov_b32 v170, v106
    v_mov_b32 v171, v110
    v_mov_b32 v172, v99
    v_mov_b32 v173, v103
    v_mov_b32 v174, v107
    v_mov_b32 v175, v111
    v_add_u32 v19, 146944, v5
    v_mov_b32 v176, v112
    v_mov_b32 v177, v116
    v_mov_b32 v178, v120
    v_mov_b32 v179, v124
    v_mov_b32 v180, v113
    v_mov_b32 v181, v117
    v_mov_b32 v182, v121
    v_mov_b32 v183, v125
    v_mov_b32 v184, v114
    v_mov_b32 v185, v118
    v_mov_b32 v186, v122
    v_mov_b32 v187, v126
    v_mov_b32 v188, v115
    v_mov_b32 v189, v119
    v_mov_b32 v190, v123
    v_mov_b32 v191, v127
    ds_write_b128 v16, v[128:131] offset:0
    ds_write_b128 v16, v[132:135] offset:512
    ds_write_b128 v16, v[136:139] offset:1024
    ds_write_b128 v16, v[140:143] offset:1536
    ds_write_b128 v17, v[144:147] offset:0
    ds_write_b128 v17, v[148:151] offset:512
    ds_write_b128 v17, v[152:155] offset:1024
    ds_write_b128 v17, v[156:159] offset:1536
    ds_write_b128 v18, v[160:163] offset:0
    ds_write_b128 v18, v[164:167] offset:512
    ds_write_b128 v18, v[168:171] offset:1024
    ds_write_b128 v18, v[172:175] offset:1536
    ds_write_b128 v19, v[176:179] offset:0
    ds_write_b128 v19, v[180:183] offset:512
    ds_write_b128 v19, v[184:187] offset:1024
    ds_write_b128 v19, v[188:191] offset:1536
    s_branch KM_FIN
KM_COMPUTE:
    v_bfe_u32 v16, v1, 2, 2
    v_and_b32 v17, 3, v1
    v_mul_u32_u24 v18, 1056, v16
    v_lshl_add_u32 v18, v17, 3, v18
    v_lshl_add_u32 v5, v8, 7, v18
    v_and_b32_e64 v19, 1, v8
    v_mul_u32_u24 v19, 4224, v19
    v_add_u32 v18, v18, v19
    v_lshrrev_b32 v19, 1, v8
    v_lshl_add_u32 v18, v19, 8, v18
    s_cmp_eq_u32 s14, 7
    s_nop 0
    s_cbranch_scc1 SV_C
    s_add_u32 s36, s22, 344064
    s_add_u32 m0, s23, 45568
    s_nop 0
    buffer_load_dwordx4 v12, s[44:47], s36 offen lds
    s_add_u32 m0, s23, 49792
    s_nop 0
    buffer_load_dwordx4 v12, s[48:51], s36 offen lds
    s_add_u32 s36, s22, 344192
    s_add_u32 m0, s23, 54016
    s_nop 0
    buffer_load_dwordx4 v12, s[44:47], s36 offen lds
    s_add_u32 m0, s23, 58240
    s_nop 0
    buffer_load_dwordx4 v12, s[48:51], s36 offen lds
    s_add_u32 s36, s22, 458752
    s_add_u32 m0, s23, 62464
    s_nop 0
    buffer_load_dwordx4 v12, s[44:47], s36 offen lds
    s_add_u32 m0, s23, 66688
    s_nop 0
    buffer_load_dwordx4 v12, s[48:51], s36 offen lds
    s_add_u32 s36, s22, 458880
    s_add_u32 m0, s23, 70912
    s_nop 0
    buffer_load_dwordx4 v12, s[44:47], s36 offen lds
    s_add_u32 m0, s23, 75136
    s_nop 0
    buffer_load_dwordx4 v12, s[48:51], s36 offen lds
    s_add_u32 s36, s22, 573440
    s_add_u32 m0, s23, 11776
    s_nop 0
    buffer_load_dwordx4 v12, s[44:47], s36 offen lds
    s_add_u32 m0, s23, 16000
    s_nop 0
    buffer_load_dwordx4 v12, s[48:51], s36 offen lds
    s_add_u32 s36, s22, 573568
    s_add_u32 m0, s23, 20224
    s_nop 0
    buffer_load_dwordx4 v12, s[44:47], s36 offen lds
    s_add_u32 m0, s23, 24448
    s_nop 0
    buffer_load_dwordx4 v12, s[48:51], s36 offen lds
    s_waitcnt lgkmcnt(0)
    s_mov_b64 exec, 0
    s_cmp_lg_u32 s15, 0
    s_cbranch_scc1 TCHcm0
    s_call_b64 s[68:69], KMPG1
TCHcm0:
    s_cmp_lg_u32 s15, 1
    s_cbranch_scc1 TCHcm1
    s_call_b64 s[68:69], KMPG2
TCHcm1:
    s_cmp_lg_u32 s15, 2
    s_cbranch_scc1 TCHcm2
    s_call_b64 s[68:69], KMPG3
TCHcm2:
    s_cmp_lg_u32 s15, 3
    s_cbranch_scc1 TCHcm3
    s_call_b64 s[68:69], KMPG4
TCHcm3:
    s_mov_b64 exec, -1
    v_readfirstlane_b32 s68, v0
    s_waitcnt lgkmcnt(0)
    s_mov_b64 exec, 0
    s_cmp_lg_u32 s15, 0
    s_nop 1
    s_cbranch_scc1 TCHam0
    s_call_b64 s[68:69], KMPG5
TCHam0:
    s_cmp_lg_u32 s15, 1
    s_cbranch_scc1 TCHam1
    s_call_b64 s[68:69], KMPG6
TCHam1:
    s_cmp_lg_u32 s15, 2
    s_cbranch_scc1 TCHam2
    s_call_b64 s[68:69], KMPG7
TCHam2:
    s_cmp_lg_u32 s15, 3
    s_cbranch_scc1 TCHam3
    s_call_b64 s[68:69], KMPG8
TCHam3:
    s_mov_b64 exec, -1
    v_readfirstlane_b32 s68, v0
    s_sleep 4
    buffer_load_dword v22, v21, s[24:27], s64 offen sc1
    s_mov_b32 s38, 400000
    s_nop 1
KM_P1:
    s_waitcnt vmcnt(0)
    v_cmp_ne_u32 vcc, 0, v22
    s_cmp_eq_u64 vcc, -1
    s_nop 3
    s_cbranch_scc1 KM_P1R
    s_sleep 4
    buffer_load_dword v22, v21, s[24:27], s64 offen sc1
    s_sub_u32 s38, s38, 1
    s_cmp_lg_u32 s38, 0
    s_cbranch_scc1 KM_P1
KM_P1R:
    s_add_u32 m0, s23, 79360
    s_add_u32 s36, s65, 6291456
    buffer_load_dwordx4 v20, s[24:27], s36 offen sc1 lds
    s_add_u32 m0, s23, 83584
    s_add_u32 s36, s65, 6307840
    buffer_load_dwordx4 v20, s[24:27], s36 offen sc1 lds
KMPG17:
    s_cbranch_execz KMPG25
    s_add_u32 m0, s23, 87808
    s_add_u32 s36, s65, 6422528
    buffer_load_dwordx4 v20, s[24:27], s36 offen sc1 lds
    s_add_u32 m0, s23, 92032
    s_add_u32 s36, s65, 6438912
    buffer_load_dwordx4 v20, s[24:27], s36 offen sc1 lds
    s_add_u32 m0, s23, 96256
    s_add_u32 s36, s65, 6553600
    buffer_load_dwordx4 v20, s[24:27], s36 offen sc1 lds
    s_add_u32 m0, s23, 100480
    s_add_u32 s36, s65, 6569984
    buffer_load_dwordx4 v20, s[24:27], s36 offen sc1 lds
    s_add_u32 m0, s23, 104704
    s_add_u32 s36, s65, 6684672
    buffer_load_dwordx4 v20, s[24:27], s36 offen sc1 lds
    s_add_u32 m0, s23, 108928
    s_add_u32 s36, s65, 6701056
    buffer_load_dwordx4 v20, s[24:27], s36 offen sc1 lds
    s_add_u32 m0, s23, 28672
    s_add_u32 s36, s65, 6815744
    buffer_load_dwordx4 v20, s[24:27], s36 offen sc1 lds
    s_add_u32 m0, s23, 32896
    s_add_u32 s36, s65, 6832128
    buffer_load_dwordx4 v20, s[24:27], s36 offen sc1 lds
    s_add_u32 m0, s23, 37120
    s_add_u32 s36, s65, 6946816
    buffer_load_dwordx4 v20, s[24:27], s36 offen sc1 lds
    s_add_u32 m0, s23, 41344
    s_add_u32 s36, s65, 6963200
    buffer_load_dwordx4 v20, s[24:27], s36 offen sc1 lds
    s_lshr_b32 s16, s15, 1
    s_and_b32 s17, s15, 1
    s_lshl_b32 s36, s17, 6
    v_add_u32 v2, s36, v5
    s_lshl_b32 s36, s16, 7
    v_add_u32 v9, s36, v18
    v_add_u32 v3, 50688, v2
    v_add_u32 v10, 50688, v9
    v_add_u32 v4, 101376, v2
    v_add_u32 v11, 101376, v9
    s_lshl_b32 s36, s17, 7
    v_lshlrev_b32 v12, 4, v8
    v_add_u32 v12, s36, v12
    s_lshl_b32 s36, s16, 9
    v_lshlrev_b32_e64 v13, 3, v7
    v_add_u32 v13, s36, v13
    s_lshl_b32 s36, s13, 1
    s_add_u32 s36, s36, s16
    s_lshl_b32 s36, s36, 1
    s_lshl_b32 s37, s12, 1
    s_add_u32 s37, s37, s17
    s_mul_i32 s63, s36, 4224
    s_mul_i32 s38, s37, 128
    s_add_u32 s63, s63, s38
    s_add_u32 s63, s63, 27262976
    s_add_u32 s66, s63, 4224
    s_mul_i32 s36, s36, 28
    s_add_u32 s36, s36, s37
    s_lshl_b32 s36, s36, 12
    s_add_u32 s62, s36, 16777216
    s_add_u32 s21, s62, 114688
    v_mov_b32 v14, 0
    v_mov_b32 v15, 1
    s_waitcnt vmcnt(8)
    s_barrier
    ds_read_b64_tr_b16 v[192:193], v4 offset:11776
    ds_read_b64_tr_b16 v[194:195], v4 offset:12288
    ds_read_b64_tr_b16 v[224:225], v10 offset:28672
    ds_read_b64_tr_b16 v[226:227], v10 offset:29184
    ds_read_b64_tr_b16 v[228:229], v10 offset:28704
    ds_read_b64_tr_b16 v[230:231], v10 offset:29216
    ds_read_b64_tr_b16 v[196:197], v4 offset:11808
    ds_read_b64_tr_b16 v[198:199], v4 offset:12320
    ds_read_b64_tr_b16 v[232:233], v10 offset:28736
    ds_read_b64_tr_b16 v[234:235], v10 offset:29248
    ds_read_b64_tr_b16 v[200:201], v4 offset:16000
    ds_read_b64_tr_b16 v[202:203], v4 offset:16512
    ds_read_b64_tr_b16 v[236:237], v10 offset:28768
    ds_read_b64_tr_b16 v[238:239], v10 offset:29280
    ds_read_b64_tr_b16 v[204:205], v4 offset:16032
    ds_read_b64_tr_b16 v[206:207], v4 offset:16544
    s_waitcnt lgkmcnt(14)
    s_waitcnt lgkmcnt(12)
    v_mfma_f32_16x16x32_bf16 v[64:67], v[192:195], v[224:227], 0
    ds_read_b64_tr_b16 v[208:209], v4 offset:20224
    s_waitcnt lgkmcnt(11)
    v_mfma_f32_16x16x32_bf16 v[68:71], v[192:195], v[228:231], 0
    ds_read_b64_tr_b16 v[210:211], v4 offset:20736
    s_waitcnt lgkmcnt(10)
    v_mfma_f32_16x16x32_bf16 v[80:83], v[196:199], v[224:227], 0
    ds_read_b64_tr_b16 v[212:213], v4 offset:20256
    v_mfma_f32_16x16x32_bf16 v[84:87], v[196:199], v[228:231], 0
    ds_read_b64_tr_b16 v[214:215], v4 offset:20768
    s_waitcnt lgkmcnt(10)
    v_mfma_f32_16x16x32_bf16 v[72:75], v[192:195], v[232:235], 0
    ds_read_b64_tr_b16 v[216:217], v4 offset:24448
    v_mfma_f32_16x16x32_bf16 v[88:91], v[196:199], v[232:235], 0
    ds_read_b64_tr_b16 v[218:219], v4 offset:24960
    s_waitcnt lgkmcnt(10)
    v_mfma_f32_16x16x32_bf16 v[96:99], v[200:203], v[224:227], 0
    ds_read_b64_tr_b16 v[220:221], v4 offset:24480
    v_mfma_f32_16x16x32_bf16 v[100:103], v[200:203], v[228:231], 0
    ds_read_b64_tr_b16 v[222:223], v4 offset:24992
    v_mfma_f32_16x16x32_bf16 v[104:107], v[200:203], v[232:235], 0
    s_waitcnt lgkmcnt(10)
    v_mfma_f32_16x16x32_bf16 v[76:79], v[192:195], v[236:239], 0
    v_mfma_f32_16x16x32_bf16 v[92:95], v[196:199], v[236:239], 0
    v_mfma_f32_16x16x32_bf16 v[108:111], v[200:203], v[236:239], 0
    s_waitcnt lgkmcnt(8)
    v_mfma_f32_16x16x32_bf16 v[112:115], v[204:207], v[224:227], 0
    v_mfma_f32_16x16x32_bf16 v[116:119], v[204:207], v[228:231], 0
    v_mfma_f32_16x16x32_bf16 v[120:123], v[204:207], v[232:235], 0
    v_mfma_f32_16x16x32_bf16 v[124:127], v[204:207], v[236:239], 0
    s_waitcnt lgkmcnt(6)
    v_mfma_f32_16x16x32_bf16 v[128:131], v[208:211], v[224:227], 0
    ds_read_b64_tr_b16 v[192:193], v4 offset:28672
    v_mfma_f32_16x16x32_bf16 v[132:135], v[208:211], v[228:231], 0
    ds_read_b64_tr_b16 v[194:195], v4 offset:29184
    v_mfma_f32_16x16x32_bf16 v[136:139], v[208:211], v[232:235], 0
    ds_read_b64_tr_b16 v[240:241], v10 offset:37120
    v_mfma_f32_16x16x32_bf16 v[140:143], v[208:211], v[236:239], 0
    ds_read_b64_tr_b16 v[242:243], v10 offset:37632
    s_waitcnt lgkmcnt(8)
    v_mfma_f32_16x16x32_bf16 v[144:147], v[212:215], v[224:227], 0
    ds_read_b64_tr_b16 v[244:245], v10 offset:37152
    v_mfma_f32_16x16x32_bf16 v[148:151], v[212:215], v[228:231], 0
    ds_read_b64_tr_b16 v[246:247], v10 offset:37664
    v_mfma_f32_16x16x32_bf16 v[152:155], v[212:215], v[232:235], 0
    ds_read_b64_tr_b16 v[196:197], v4 offset:28704
    v_mfma_f32_16x16x32_bf16 v[156:159], v[212:215], v[236:239], 0
    ds_read_b64_tr_b16 v[198:199], v4 offset:29216
    s_waitcnt lgkmcnt(10)
    v_mfma_f32_16x16x32_bf16 v[160:163], v[216:219], v[224:227], 0
    ds_read_b64_tr_b16 v[248:249], v10 offset:37184
    v_mfma_f32_16x16x32_bf16 v[164:167], v[216:219], v[228:231], 0
    ds_read_b64_tr_b16 v[250:251], v10 offset:37696
    v_mfma_f32_16x16x32_bf16 v[168:171], v[216:219], v[232:235], 0
    ds_read_b64_tr_b16 v[200:201], v4 offset:32896
    v_mfma_f32_16x16x32_bf16 v[172:175], v[216:219], v[236:239], 0
    ds_read_b64_tr_b16 v[202:203], v4 offset:33408
    s_waitcnt lgkmcnt(12)
    v_mfma_f32_16x16x32_bf16 v[176:179], v[220:223], v[224:227], 0
    ds_read_b64_tr_b16 v[252:253], v10 offset:37216
    v_mfma_f32_16x16x32_bf16 v[180:183], v[220:223], v[228:231], 0
    ds_read_b64_tr_b16 v[254:255], v10 offset:37728
KMPG18:
    s_cbranch_execz KMPG26
    v_mfma_f32_16x16x32_bf16 v[184:187], v[220:223], v[232:235], 0
    ds_read_b64_tr_b16 v[204:205], v4 offset:32928
    v_mfma_f32_16x16x32_bf16 v[188:191], v[220:223], v[236:239], 0
    ds_read_b64_tr_b16 v[206:207], v4 offset:33440
    s_waitcnt vmcnt(6)
    s_barrier
    s_waitcnt lgkmcnt(14)
    s_waitcnt lgkmcnt(12)
    v_mfma_f32_16x16x32_bf16 v[64:67], v[192:195], v[240:243], v[64:67]
    ds_read_b64_tr_b16 v[208:209], v4 offset:37120
    s_waitcnt lgkmcnt(11)
    v_mfma_f32_16x16x32_bf16 v[68:71], v[192:195], v[244:247], v[68:71]
    ds_read_b64_tr_b16 v[210:211], v4 offset:37632
    s_waitcnt lgkmcnt(10)
    v_mfma_f32_16x16x32_bf16 v[80:83], v[196:199], v[240:243], v[80:83]
    ds_read_b64_tr_b16 v[212:213], v4 offset:37152
    v_mfma_f32_16x16x32_bf16 v[84:87], v[196:199], v[244:247], v[84:87]
    ds_read_b64_tr_b16 v[214:215], v4 offset:37664
    s_waitcnt lgkmcnt(10)
    v_mfma_f32_16x16x32_bf16 v[72:75], v[192:195], v[248:251], v[72:75]
    ds_read_b64_tr_b16 v[216:217], v4 offset:41344
    v_mfma_f32_16x16x32_bf16 v[88:91], v[196:199], v[248:251], v[88:91]
    ds_read_b64_tr_b16 v[218:219], v4 offset:41856
    s_waitcnt lgkmcnt(10)
    v_mfma_f32_16x16x32_bf16 v[96:99], v[200:203], v[240:243], v[96:99]
    ds_read_b64_tr_b16 v[220:221], v4 offset:41376
    v_mfma_f32_16x16x32_bf16 v[100:103], v[200:203], v[244:247], v[100:103]
    ds_read_b64_tr_b16 v[222:223], v4 offset:41888
    v_mfma_f32_16x16x32_bf16 v[104:107], v[200:203], v[248:251], v[104:107]
    s_waitcnt lgkmcnt(10)
    v_mfma_f32_16x16x32_bf16 v[76:79], v[192:195], v[252:255], v[76:79]
    v_mfma_f32_16x16x32_bf16 v[92:95], v[196:199], v[252:255], v[92:95]
    v_mfma_f32_16x16x32_bf16 v[108:111], v[200:203], v[252:255], v[108:111]
    s_waitcnt lgkmcnt(8)
    v_mfma_f32_16x16x32_bf16 v[112:115], v[204:207], v[240:243], v[112:115]
    v_mfma_f32_16x16x32_bf16 v[116:119], v[204:207], v[244:247], v[116:119]
    v_mfma_f32_16x16x32_bf16 v[120:123], v[204:207], v[248:251], v[120:123]
    v_mfma_f32_16x16x32_bf16 v[124:127], v[204:207], v[252:255], v[124:127]
    s_waitcnt lgkmcnt(6)
    v_mfma_f32_16x16x32_bf16 v[128:131], v[208:211], v[240:243], v[128:131]
    ds_read_b64_tr_b16 v[192:193], v4 offset:45568
    v_mfma_f32_16x16x32_bf16 v[132:135], v[208:211], v[244:247], v[132:135]
    ds_read_b64_tr_b16 v[194:195], v4 offset:46080
    v_mfma_f32_16x16x32_bf16 v[136:139], v[208:211], v[248:251], v[136:139]
    ds_read_b64_tr_b16 v[224:225], v10 offset:45568
    v_mfma_f32_16x16x32_bf16 v[140:143], v[208:211], v[252:255], v[140:143]
    ds_read_b64_tr_b16 v[226:227], v10 offset:46080
    s_waitcnt lgkmcnt(8)
    v_mfma_f32_16x16x32_bf16 v[144:147], v[212:215], v[240:243], v[144:147]
    ds_read_b64_tr_b16 v[228:229], v10 offset:45600
    v_mfma_f32_16x16x32_bf16 v[148:151], v[212:215], v[244:247], v[148:151]
    ds_read_b64_tr_b16 v[230:231], v10 offset:46112
    v_mfma_f32_16x16x32_bf16 v[152:155], v[212:215], v[248:251], v[152:155]
    ds_read_b64_tr_b16 v[196:197], v4 offset:45600
    v_mfma_f32_16x16x32_bf16 v[156:159], v[212:215], v[252:255], v[156:159]
    ds_read_b64_tr_b16 v[198:199], v4 offset:46112
    s_waitcnt lgkmcnt(10)
    v_mfma_f32_16x16x32_bf16 v[160:163], v[216:219], v[240:243], v[160:163]
    ds_read_b64_tr_b16 v[232:233], v10 offset:45632
    v_mfma_f32_16x16x32_bf16 v[164:167], v[216:219], v[244:247], v[164:167]
    ds_read_b64_tr_b16 v[234:235], v10 offset:46144
    v_mfma_f32_16x16x32_bf16 v[168:171], v[216:219], v[248:251], v[168:171]
    ds_read_b64_tr_b16 v[200:201], v4 offset:49792
    v_mfma_f32_16x16x32_bf16 v[172:175], v[216:219], v[252:255], v[172:175]
    ds_read_b64_tr_b16 v[202:203], v4 offset:50304
    s_waitcnt lgkmcnt(12)
    v_mfma_f32_16x16x32_bf16 v[176:179], v[220:223], v[240:243], v[176:179]
    ds_read_b64_tr_b16 v[236:237], v10 offset:45664
    v_mfma_f32_16x16x32_bf16 v[180:183], v[220:223], v[244:247], v[180:183]
    ds_read_b64_tr_b16 v[238:239], v10 offset:46176
    v_mfma_f32_16x16x32_bf16 v[184:187], v[220:223], v[248:251], v[184:187]
    ds_read_b64_tr_b16 v[204:205], v4 offset:49824
    v_mfma_f32_16x16x32_bf16 v[188:191], v[220:223], v[252:255], v[188:191]
    ds_read_b64_tr_b16 v[206:207], v4 offset:50336
    s_waitcnt vmcnt(4)
    s_barrier
    s_waitcnt lgkmcnt(14)
    s_waitcnt lgkmcnt(12)
    v_mfma_f32_16x16x32_bf16 v[64:67], v[192:195], v[224:227], v[64:67]
    ds_read_b64_tr_b16 v[208:209], v4 offset:54016
    s_waitcnt lgkmcnt(11)
    v_mfma_f32_16x16x32_bf16 v[68:71], v[192:195], v[228:231], v[68:71]
    ds_read_b64_tr_b16 v[210:211], v4 offset:54528
    s_waitcnt lgkmcnt(10)
    v_mfma_f32_16x16x32_bf16 v[80:83], v[196:199], v[224:227], v[80:83]
    ds_read_b64_tr_b16 v[212:213], v4 offset:54048
    v_mfma_f32_16x16x32_bf16 v[84:87], v[196:199], v[228:231], v[84:87]
    ds_read_b64_tr_b16 v[214:215], v4 offset:54560
    s_waitcnt lgkmcnt(10)
    v_mfma_f32_16x16x32_bf16 v[72:75], v[192:195], v[232:235], v[72:75]
    ds_read_b64_tr_b16 v[216:217], v4 offset:58240
    v_mfma_f32_16x16x32_bf16 v[88:91], v[196:199], v[232:235], v[88:91]
    ds_read_b64_tr_b16 v[218:219], v4 offset:58752
    s_waitcnt lgkmcnt(10)
    v_mfma_f32_16x16x32_bf16 v[96:99], v[200:203], v[224:227], v[96:99]
    ds_read_b64_tr_b16 v[220:221], v4 offset:58272
    v_mfma_f32_16x16x32_bf16 v[100:103], v[200:203], v[228:231], v[100:103]
    ds_read_b64_tr_b16 v[222:223], v4 offset:58784
    v_mfma_f32_16x16x32_bf16 v[104:107], v[200:203], v[232:235], v[104:107]
    s_waitcnt lgkmcnt(10)
    v_mfma_f32_16x16x32_bf16 v[76:79], v[192:195], v[236:239], v[76:79]
    v_mfma_f32_16x16x32_bf16 v[92:95], v[196:199], v[236:239], v[92:95]
    v_mfma_f32_16x16x32_bf16 v[108:111], v[200:203], v[236:239], v[108:111]
    s_waitcnt lgkmcnt(8)
    v_mfma_f32_16x16x32_bf16 v[112:115], v[204:207], v[224:227], v[112:115]
    v_mfma_f32_16x16x32_bf16 v[116:119], v[204:207], v[228:231], v[116:119]
    v_mfma_f32_16x16x32_bf16 v[120:123], v[204:207], v[232:235], v[120:123]
    v_mfma_f32_16x16x32_bf16 v[124:127], v[204:207], v[236:239], v[124:127]
    s_waitcnt lgkmcnt(6)
    v_mfma_f32_16x16x32_bf16 v[128:131], v[208:211], v[224:227], v[128:131]
    ds_read_b64_tr_b16 v[192:193], v2 offset:45568
    v_mfma_f32_16x16x32_bf16 v[132:135], v[208:211], v[228:231], v[132:135]
    ds_read_b64_tr_b16 v[194:195], v2 offset:46080
    v_mfma_f32_16x16x32_bf16 v[136:139], v[208:211], v[232:235], v[136:139]
    ds_read_b64_tr_b16 v[240:241], v10 offset:54016
    v_mfma_f32_16x16x32_bf16 v[140:143], v[208:211], v[236:239], v[140:143]
    ds_read_b64_tr_b16 v[242:243], v10 offset:54528
    s_waitcnt lgkmcnt(8)
    v_mfma_f32_16x16x32_bf16 v[144:147], v[212:215], v[224:227], v[144:147]
    ds_read_b64_tr_b16 v[244:245], v10 offset:54048
    v_mfma_f32_16x16x32_bf16 v[148:151], v[212:215], v[228:231], v[148:151]
    ds_read_b64_tr_b16 v[246:247], v10 offset:54560
    v_mfma_f32_16x16x32_bf16 v[152:155], v[212:215], v[232:235], v[152:155]
    ds_read_b64_tr_b16 v[196:197], v2 offset:45600
    v_mfma_f32_16x16x32_bf16 v[156:159], v[212:215], v[236:239], v[156:159]
    ds_read_b64_tr_b16 v[198:199], v2 offset:46112
    s_waitcnt lgkmcnt(10)
    v_mfma_f32_16x16x32_bf16 v[160:163], v[216:219], v[224:227], v[160:163]
    ds_read_b64_tr_b16 v[248:249], v10 offset:54080
    v_mfma_f32_16x16x32_bf16 v[164:167], v[216:219], v[228:231], v[164:167]
    ds_read_b64_tr_b16 v[250:251], v10 offset:54592
    v_mfma_f32_16x16x32_bf16 v[168:171], v[216:219], v[232:235], v[168:171]
    ds_read_b64_tr_b16 v[200:201], v2 offset:49792
    v_mfma_f32_16x16x32_bf16 v[172:175], v[216:219], v[236:239], v[172:175]
    ds_read_b64_tr_b16 v[202:203], v2 offset:50304
    s_waitcnt lgkmcnt(12)
    v_mfma_f32_16x16x32_bf16 v[176:179], v[220:223], v[224:227], v[176:179]
    ds_read_b64_tr_b16 v[252:253], v10 offset:54112
    v_mfma_f32_16x16x32_bf16 v[180:183], v[220:223], v[228:231], v[180:183]
    ds_read_b64_tr_b16 v[254:255], v10 offset:54624
    v_mfma_f32_16x16x32_bf16 v[184:187], v[220:223], v[232:235], v[184:187]
    ds_read_b64_tr_b16 v[204:205], v2 offset:49824
KMPG19:
    s_cbranch_execz KMPG27
    v_mfma_f32_16x16x32_bf16 v[188:191], v[220:223], v[236:239], v[188:191]
    ds_read_b64_tr_b16 v[206:207], v2 offset:50336
    s_waitcnt vmcnt(2)
    s_barrier
    s_waitcnt lgkmcnt(14)
    s_waitcnt lgkmcnt(12)
    v_mfma_f32_16x16x32_bf16 v[64:67], v[192:195], v[240:243], v[64:67]
    ds_read_b64_tr_b16 v[208:209], v2 offset:54016
    s_waitcnt lgkmcnt(11)
    v_mfma_f32_16x16x32_bf16 v[68:71], v[192:195], v[244:247], v[68:71]
    ds_read_b64_tr_b16 v[210:211], v2 offset:54528
    s_waitcnt lgkmcnt(10)
    v_mfma_f32_16x16x32_bf16 v[80:83], v[196:199], v[240:243], v[80:83]
    ds_read_b64_tr_b16 v[212:213], v2 offset:54048
    v_mfma_f32_16x16x32_bf16 v[84:87], v[196:199], v[244:247], v[84:87]
    ds_read_b64_tr_b16 v[214:215], v2 offset:54560
    s_waitcnt lgkmcnt(10)
    v_mfma_f32_16x16x32_bf16 v[72:75], v[192:195], v[248:251], v[72:75]
    ds_read_b64_tr_b16 v[216:217], v2 offset:58240
    v_mfma_f32_16x16x32_bf16 v[88:91], v[196:199], v[248:251], v[88:91]
    ds_read_b64_tr_b16 v[218:219], v2 offset:58752
    s_waitcnt lgkmcnt(10)
    v_mfma_f32_16x16x32_bf16 v[96:99], v[200:203], v[240:243], v[96:99]
    ds_read_b64_tr_b16 v[220:221], v2 offset:58272
    v_mfma_f32_16x16x32_bf16 v[100:103], v[200:203], v[244:247], v[100:103]
    ds_read_b64_tr_b16 v[222:223], v2 offset:58784
    v_mfma_f32_16x16x32_bf16 v[104:107], v[200:203], v[248:251], v[104:107]
    s_waitcnt lgkmcnt(10)
    v_mfma_f32_16x16x32_bf16 v[76:79], v[192:195], v[252:255], v[76:79]
    v_mfma_f32_16x16x32_bf16 v[92:95], v[196:199], v[252:255], v[92:95]
    v_mfma_f32_16x16x32_bf16 v[108:111], v[200:203], v[252:255], v[108:111]
    s_waitcnt lgkmcnt(8)
    v_mfma_f32_16x16x32_bf16 v[112:115], v[204:207], v[240:243], v[112:115]
    v_mfma_f32_16x16x32_bf16 v[116:119], v[204:207], v[244:247], v[116:119]
    v_mfma_f32_16x16x32_bf16 v[120:123], v[204:207], v[248:251], v[120:123]
    v_mfma_f32_16x16x32_bf16 v[124:127], v[204:207], v[252:255], v[124:127]
    s_waitcnt lgkmcnt(6)
    v_mfma_f32_16x16x32_bf16 v[128:131], v[208:211], v[240:243], v[128:131]
    ds_read_b64_tr_b16 v[192:193], v3 offset:11776
    v_mfma_f32_16x16x32_bf16 v[132:135], v[208:211], v[244:247], v[132:135]
    ds_read_b64_tr_b16 v[194:195], v3 offset:12288
    v_mfma_f32_16x16x32_bf16 v[136:139], v[208:211], v[248:251], v[136:139]
    ds_read_b64_tr_b16 v[224:225], v9 offset:28672
    v_mfma_f32_16x16x32_bf16 v[140:143], v[208:211], v[252:255], v[140:143]
    ds_read_b64_tr_b16 v[226:227], v9 offset:29184
    s_waitcnt lgkmcnt(8)
    v_mfma_f32_16x16x32_bf16 v[144:147], v[212:215], v[240:243], v[144:147]
    ds_read_b64_tr_b16 v[228:229], v9 offset:28704
    v_mfma_f32_16x16x32_bf16 v[148:151], v[212:215], v[244:247], v[148:151]
    ds_read_b64_tr_b16 v[230:231], v9 offset:29216
    v_mfma_f32_16x16x32_bf16 v[152:155], v[212:215], v[248:251], v[152:155]
    ds_read_b64_tr_b16 v[196:197], v3 offset:11808
    v_mfma_f32_16x16x32_bf16 v[156:159], v[212:215], v[252:255], v[156:159]
    ds_read_b64_tr_b16 v[198:199], v3 offset:12320
    s_waitcnt lgkmcnt(10)
    v_mfma_f32_16x16x32_bf16 v[160:163], v[216:219], v[240:243], v[160:163]
    ds_read_b64_tr_b16 v[232:233], v9 offset:28736
    v_mfma_f32_16x16x32_bf16 v[164:167], v[216:219], v[244:247], v[164:167]
    ds_read_b64_tr_b16 v[234:235], v9 offset:29248
    v_mfma_f32_16x16x32_bf16 v[168:171], v[216:219], v[248:251], v[168:171]
    ds_read_b64_tr_b16 v[200:201], v3 offset:16000
    v_mfma_f32_16x16x32_bf16 v[172:175], v[216:219], v[252:255], v[172:175]
    ds_read_b64_tr_b16 v[202:203], v3 offset:16512
    s_waitcnt lgkmcnt(12)
    v_mfma_f32_16x16x32_bf16 v[176:179], v[220:223], v[240:243], v[176:179]
    ds_read_b64_tr_b16 v[236:237], v9 offset:28768
    v_mfma_f32_16x16x32_bf16 v[180:183], v[220:223], v[244:247], v[180:183]
    ds_read_b64_tr_b16 v[238:239], v9 offset:29280
    v_mfma_f32_16x16x32_bf16 v[184:187], v[220:223], v[248:251], v[184:187]
    ds_read_b64_tr_b16 v[204:205], v3 offset:16032
    v_mfma_f32_16x16x32_bf16 v[188:191], v[220:223], v[252:255], v[188:191]
    ds_read_b64_tr_b16 v[206:207], v3 offset:16544
    s_waitcnt vmcnt(0)
    s_barrier
    s_waitcnt lgkmcnt(14)
    s_waitcnt lgkmcnt(12)
    v_mfma_f32_16x16x32_bf16 v[64:67], v[192:195], v[224:227], v[64:67]
    ds_read_b64_tr_b16 v[208:209], v3 offset:20224
    s_waitcnt lgkmcnt(11)
    v_mfma_f32_16x16x32_bf16 v[68:71], v[192:195], v[228:231], v[68:71]
    ds_read_b64_tr_b16 v[210:211], v3 offset:20736
    s_waitcnt lgkmcnt(10)
    v_mfma_f32_16x16x32_bf16 v[80:83], v[196:199], v[224:227], v[80:83]
    ds_read_b64_tr_b16 v[212:213], v3 offset:20256
    v_mfma_f32_16x16x32_bf16 v[84:87], v[196:199], v[228:231], v[84:87]
    ds_read_b64_tr_b16 v[214:215], v3 offset:20768
    s_waitcnt lgkmcnt(10)
    v_mfma_f32_16x16x32_bf16 v[72:75], v[192:195], v[232:235], v[72:75]
    ds_read_b64_tr_b16 v[216:217], v3 offset:24448
    v_mfma_f32_16x16x32_bf16 v[88:91], v[196:199], v[232:235], v[88:91]
    ds_read_b64_tr_b16 v[218:219], v3 offset:24960
    s_waitcnt lgkmcnt(10)
    v_mfma_f32_16x16x32_bf16 v[96:99], v[200:203], v[224:227], v[96:99]
    ds_read_b64_tr_b16 v[220:221], v3 offset:24480
    v_mfma_f32_16x16x32_bf16 v[100:103], v[200:203], v[228:231], v[100:103]
    ds_read_b64_tr_b16 v[222:223], v3 offset:24992
    v_mfma_f32_16x16x32_bf16 v[104:107], v[200:203], v[232:235], v[104:107]
    s_waitcnt lgkmcnt(10)
    v_mfma_f32_16x16x32_bf16 v[76:79], v[192:195], v[236:239], v[76:79]
    v_mfma_f32_16x16x32_bf16 v[92:95], v[196:199], v[236:239], v[92:95]
    v_mfma_f32_16x16x32_bf16 v[108:111], v[200:203], v[236:239], v[108:111]
    s_waitcnt lgkmcnt(8)
    v_mfma_f32_16x16x32_bf16 v[112:115], v[204:207], v[224:227], v[112:115]
    v_mfma_f32_16x16x32_bf16 v[116:119], v[204:207], v[228:231], v[116:119]
    v_mfma_f32_16x16x32_bf16 v[120:123], v[204:207], v[232:235], v[120:123]
    v_mfma_f32_16x16x32_bf16 v[124:127], v[204:207], v[236:239], v[124:127]
    s_waitcnt lgkmcnt(6)
    v_mfma_f32_16x16x32_bf16 v[128:131], v[208:211], v[224:227], v[128:131]
    ds_read_b64_tr_b16 v[192:193], v2 offset:11776
    v_mfma_f32_16x16x32_bf16 v[132:135], v[208:211], v[228:231], v[132:135]
    ds_read_b64_tr_b16 v[194:195], v2 offset:12288
    v_mfma_f32_16x16x32_bf16 v[136:139], v[208:211], v[232:235], v[136:139]
    ds_read_b64_tr_b16 v[240:241], v9 offset:37120
    v_mfma_f32_16x16x32_bf16 v[140:143], v[208:211], v[236:239], v[140:143]
    ds_read_b64_tr_b16 v[242:243], v9 offset:37632
    s_waitcnt lgkmcnt(8)
    v_mfma_f32_16x16x32_bf16 v[144:147], v[212:215], v[224:227], v[144:147]
    ds_read_b64_tr_b16 v[244:245], v9 offset:37152
    v_mfma_f32_16x16x32_bf16 v[148:151], v[212:215], v[228:231], v[148:151]
    ds_read_b64_tr_b16 v[246:247], v9 offset:37664
    v_mfma_f32_16x16x32_bf16 v[152:155], v[212:215], v[232:235], v[152:155]
    ds_read_b64_tr_b16 v[196:197], v2 offset:11808
    v_mfma_f32_16x16x32_bf16 v[156:159], v[212:215], v[236:239], v[156:159]
    ds_read_b64_tr_b16 v[198:199], v2 offset:12320
    s_waitcnt lgkmcnt(10)
    v_mfma_f32_16x16x32_bf16 v[160:163], v[216:219], v[224:227], v[160:163]
    ds_read_b64_tr_b16 v[248:249], v9 offset:37184
    v_mfma_f32_16x16x32_bf16 v[164:167], v[216:219], v[228:231], v[164:167]
    ds_read_b64_tr_b16 v[250:251], v9 offset:37696
    v_mfma_f32_16x16x32_bf16 v[168:171], v[216:219], v[232:235], v[168:171]
    ds_read_b64_tr_b16 v[200:201], v2 offset:16000
    v_mfma_f32_16x16x32_bf16 v[172:175], v[216:219], v[236:239], v[172:175]
    ds_read_b64_tr_b16 v[202:203], v2 offset:16512
    s_waitcnt lgkmcnt(12)
    v_mfma_f32_16x16x32_bf16 v[176:179], v[220:223], v[224:227], v[176:179]
    ds_read_b64_tr_b16 v[252:253], v9 offset:37216
    v_mfma_f32_16x16x32_bf16 v[180:183], v[220:223], v[228:231], v[180:183]
    ds_read_b64_tr_b16 v[254:255], v9 offset:37728
    v_mfma_f32_16x16x32_bf16 v[184:187], v[220:223], v[232:235], v[184:187]
    ds_read_b64_tr_b16 v[204:205], v2 offset:16032
    v_mfma_f32_16x16x32_bf16 v[188:191], v[220:223], v[236:239], v[188:191]
KMPG20:
    s_cbranch_execz KMPG28
    ds_read_b64_tr_b16 v[206:207], v2 offset:16544
    s_barrier
    s_waitcnt lgkmcnt(14)
    s_waitcnt lgkmcnt(12)
    v_mfma_f32_16x16x32_bf16 v[64:67], v[192:195], v[240:243], v[64:67]
    ds_read_b64_tr_b16 v[208:209], v2 offset:20224
    s_waitcnt lgkmcnt(11)
    v_mfma_f32_16x16x32_bf16 v[68:71], v[192:195], v[244:247], v[68:71]
    ds_read_b64_tr_b16 v[210:211], v2 offset:20736
    s_waitcnt lgkmcnt(10)
    v_mfma_f32_16x16x32_bf16 v[80:83], v[196:199], v[240:243], v[80:83]
    ds_read_b64_tr_b16 v[212:213], v2 offset:20256
    v_mfma_f32_16x16x32_bf16 v[84:87], v[196:199], v[244:247], v[84:87]
    ds_read_b64_tr_b16 v[214:215], v2 offset:20768
    s_waitcnt lgkmcnt(10)
    v_mfma_f32_16x16x32_bf16 v[72:75], v[192:195], v[248:251], v[72:75]
    ds_read_b64_tr_b16 v[216:217], v2 offset:24448
    v_mfma_f32_16x16x32_bf16 v[88:91], v[196:199], v[248:251], v[88:91]
    ds_read_b64_tr_b16 v[218:219], v2 offset:24960
    s_waitcnt lgkmcnt(10)
    v_mfma_f32_16x16x32_bf16 v[96:99], v[200:203], v[240:243], v[96:99]
    ds_read_b64_tr_b16 v[220:221], v2 offset:24480
    v_mfma_f32_16x16x32_bf16 v[100:103], v[200:203], v[244:247], v[100:103]
    ds_read_b64_tr_b16 v[222:223], v2 offset:24992
    v_mfma_f32_16x16x32_bf16 v[104:107], v[200:203], v[248:251], v[104:107]
    s_waitcnt lgkmcnt(10)
    v_mfma_f32_16x16x32_bf16 v[76:79], v[192:195], v[252:255], v[76:79]
    v_mfma_f32_16x16x32_bf16 v[92:95], v[196:199], v[252:255], v[92:95]
    v_mfma_f32_16x16x32_bf16 v[108:111], v[200:203], v[252:255], v[108:111]
    s_waitcnt lgkmcnt(8)
    v_mfma_f32_16x16x32_bf16 v[112:115], v[204:207], v[240:243], v[112:115]
    v_mfma_f32_16x16x32_bf16 v[116:119], v[204:207], v[244:247], v[116:119]
    v_mfma_f32_16x16x32_bf16 v[120:123], v[204:207], v[248:251], v[120:123]
    v_mfma_f32_16x16x32_bf16 v[124:127], v[204:207], v[252:255], v[124:127]
    s_waitcnt lgkmcnt(6)
    v_mfma_f32_16x16x32_bf16 v[128:131], v[208:211], v[240:243], v[128:131]
    ds_read_b64_tr_b16 v[192:193], v4 offset:11776
    v_mfma_f32_16x16x32_bf16 v[132:135], v[208:211], v[244:247], v[132:135]
    ds_read_b64_tr_b16 v[194:195], v4 offset:12288
    v_mfma_f32_16x16x32_bf16 v[136:139], v[208:211], v[248:251], v[136:139]
    ds_read_b64_tr_b16 v[224:225], v10 offset:28672
    v_mfma_f32_16x16x32_bf16 v[140:143], v[208:211], v[252:255], v[140:143]
    ds_read_b64_tr_b16 v[226:227], v10 offset:29184
    s_waitcnt lgkmcnt(8)
    v_mfma_f32_16x16x32_bf16 v[144:147], v[212:215], v[240:243], v[144:147]
    ds_read_b64_tr_b16 v[228:229], v10 offset:28704
    v_mfma_f32_16x16x32_bf16 v[148:151], v[212:215], v[244:247], v[148:151]
    ds_read_b64_tr_b16 v[230:231], v10 offset:29216
    v_mfma_f32_16x16x32_bf16 v[152:155], v[212:215], v[248:251], v[152:155]
    ds_read_b64_tr_b16 v[196:197], v4 offset:11808
    v_mfma_f32_16x16x32_bf16 v[156:159], v[212:215], v[252:255], v[156:159]
    ds_read_b64_tr_b16 v[198:199], v4 offset:12320
    s_waitcnt lgkmcnt(10)
    v_mfma_f32_16x16x32_bf16 v[160:163], v[216:219], v[240:243], v[160:163]
    ds_read_b64_tr_b16 v[232:233], v10 offset:28736
    v_mfma_f32_16x16x32_bf16 v[164:167], v[216:219], v[244:247], v[164:167]
    ds_read_b64_tr_b16 v[234:235], v10 offset:29248
    v_mfma_f32_16x16x32_bf16 v[168:171], v[216:219], v[248:251], v[168:171]
    ds_read_b64_tr_b16 v[200:201], v4 offset:16000
    v_mfma_f32_16x16x32_bf16 v[172:175], v[216:219], v[252:255], v[172:175]
    ds_read_b64_tr_b16 v[202:203], v4 offset:16512
    s_waitcnt lgkmcnt(12)
    v_mfma_f32_16x16x32_bf16 v[176:179], v[220:223], v[240:243], v[176:179]
    ds_read_b64_tr_b16 v[236:237], v10 offset:28768
    v_mfma_f32_16x16x32_bf16 v[180:183], v[220:223], v[244:247], v[180:183]
    ds_read_b64_tr_b16 v[238:239], v10 offset:29280
    v_mfma_f32_16x16x32_bf16 v[184:187], v[220:223], v[248:251], v[184:187]
    ds_read_b64_tr_b16 v[204:205], v4 offset:16032
    v_mfma_f32_16x16x32_bf16 v[188:191], v[220:223], v[252:255], v[188:191]
    ds_read_b64_tr_b16 v[206:207], v4 offset:16544
    s_barrier
    s_waitcnt lgkmcnt(14)
    s_waitcnt lgkmcnt(12)
    v_mfma_f32_16x16x32_bf16 v[64:67], v[192:195], v[224:227], v[64:67]
    ds_read_b64_tr_b16 v[208:209], v4 offset:20224
    s_waitcnt lgkmcnt(11)
    v_mfma_f32_16x16x32_bf16 v[68:71], v[192:195], v[228:231], v[68:71]
    ds_read_b64_tr_b16 v[210:211], v4 offset:20736
    s_waitcnt lgkmcnt(10)
    v_mfma_f32_16x16x32_bf16 v[80:83], v[196:199], v[224:227], v[80:83]
    ds_read_b64_tr_b16 v[212:213], v4 offset:20256
    v_mfma_f32_16x16x32_bf16 v[84:87], v[196:199], v[228:231], v[84:87]
    ds_read_b64_tr_b16 v[214:215], v4 offset:20768
    s_waitcnt lgkmcnt(10)
    v_mfma_f32_16x16x32_bf16 v[72:75], v[192:195], v[232:235], v[72:75]
    ds_read_b64_tr_b16 v[216:217], v4 offset:24448
    v_mfma_f32_16x16x32_bf16 v[88:91], v[196:199], v[232:235], v[88:91]
    ds_read_b64_tr_b16 v[218:219], v4 offset:24960
    s_waitcnt lgkmcnt(10)
    v_mfma_f32_16x16x32_bf16 v[96:99], v[200:203], v[224:227], v[96:99]
    ds_read_b64_tr_b16 v[220:221], v4 offset:24480
    v_mfma_f32_16x16x32_bf16 v[100:103], v[200:203], v[228:231], v[100:103]
    ds_read_b64_tr_b16 v[222:223], v4 offset:24992
    v_mfma_f32_16x16x32_bf16 v[104:107], v[200:203], v[232:235], v[104:107]
    s_waitcnt lgkmcnt(10)
    v_mfma_f32_16x16x32_bf16 v[76:79], v[192:195], v[236:239], v[76:79]
    v_mfma_f32_16x16x32_bf16 v[92:95], v[196:199], v[236:239], v[92:95]
    v_mfma_f32_16x16x32_bf16 v[108:111], v[200:203], v[236:239], v[108:111]
    s_waitcnt lgkmcnt(8)
    v_mfma_f32_16x16x32_bf16 v[112:115], v[204:207], v[224:227], v[112:115]
    v_mfma_f32_16x16x32_bf16 v[116:119], v[204:207], v[228:231], v[116:119]
    v_mfma_f32_16x16x32_bf16 v[120:123], v[204:207], v[232:235], v[120:123]
    v_mfma_f32_16x16x32_bf16 v[124:127], v[204:207], v[236:239], v[124:127]
    s_waitcnt lgkmcnt(6)
    v_mfma_f32_16x16x32_bf16 v[128:131], v[208:211], v[224:227], v[128:131]
    ds_read_b64_tr_b16 v[192:193], v4 offset:28672
    v_mfma_f32_16x16x32_bf16 v[132:135], v[208:211], v[228:231], v[132:135]
    ds_read_b64_tr_b16 v[194:195], v4 offset:29184
    v_mfma_f32_16x16x32_bf16 v[136:139], v[208:211], v[232:235], v[136:139]
    ds_read_b64_tr_b16 v[240:241], v10 offset:37120
    v_mfma_f32_16x16x32_bf16 v[140:143], v[208:211], v[236:239], v[140:143]
    ds_read_b64_tr_b16 v[242:243], v10 offset:37632
    s_waitcnt lgkmcnt(8)
    v_mfma_f32_16x16x32_bf16 v[144:147], v[212:215], v[224:227], v[144:147]
    ds_read_b64_tr_b16 v[244:245], v10 offset:37152
    v_mfma_f32_16x16x32_bf16 v[148:151], v[212:215], v[228:231], v[148:151]
    ds_read_b64_tr_b16 v[246:247], v10 offset:37664
    v_mfma_f32_16x16x32_bf16 v[152:155], v[212:215], v[232:235], v[152:155]
    ds_read_b64_tr_b16 v[196:197], v4 offset:28704
    v_mfma_f32_16x16x32_bf16 v[156:159], v[212:215], v[236:239], v[156:159]
    ds_read_b64_tr_b16 v[198:199], v4 offset:29216
    s_waitcnt lgkmcnt(10)
    v_mfma_f32_16x16x32_bf16 v[160:163], v[216:219], v[224:227], v[160:163]
    ds_read_b64_tr_b16 v[248:249], v10 offset:37184
    v_mfma_f32_16x16x32_bf16 v[164:167], v[216:219], v[228:231], v[164:167]
    ds_read_b64_tr_b16 v[250:251], v10 offset:37696
    v_mfma_f32_16x16x32_bf16 v[168:171], v[216:219], v[232:235], v[168:171]
    ds_read_b64_tr_b16 v[200:201], v4 offset:32896
    v_mfma_f32_16x16x32_bf16 v[172:175], v[216:219], v[236:239], v[172:175]
    ds_read_b64_tr_b16 v[202:203], v4 offset:33408
    s_waitcnt lgkmcnt(12)
    v_mfma_f32_16x16x32_bf16 v[176:179], v[220:223], v[224:227], v[176:179]
    ds_read_b64_tr_b16 v[252:253], v10 offset:37216
    v_mfma_f32_16x16x32_bf16 v[180:183], v[220:223], v[228:231], v[180:183]
    ds_read_b64_tr_b16 v[254:255], v10 offset:37728
    v_mfma_f32_16x16x32_bf16 v[184:187], v[220:223], v[232:235], v[184:187]
    ds_read_b64_tr_b16 v[204:205], v4 offset:32928
    v_mfma_f32_16x16x32_bf16 v[188:191], v[220:223], v[236:239], v[188:191]
    ds_read_b64_tr_b16 v[206:207], v4 offset:33440
    s_barrier
    s_waitcnt lgkmcnt(14)
    s_waitcnt lgkmcnt(12)
KMPG21:
    s_cbranch_execz KMPG29
    v_mfma_f32_16x16x32_bf16 v[64:67], v[192:195], v[240:243], v[64:67]
    ds_read_b64_tr_b16 v[208:209], v4 offset:37120
    s_waitcnt lgkmcnt(11)
    v_mfma_f32_16x16x32_bf16 v[68:71], v[192:195], v[244:247], v[68:71]
    ds_read_b64_tr_b16 v[210:211], v4 offset:37632
    s_waitcnt lgkmcnt(10)
    v_mfma_f32_16x16x32_bf16 v[80:83], v[196:199], v[240:243], v[80:83]
    ds_read_b64_tr_b16 v[212:213], v4 offset:37152
    v_mfma_f32_16x16x32_bf16 v[84:87], v[196:199], v[244:247], v[84:87]
    ds_read_b64_tr_b16 v[214:215], v4 offset:37664
    s_waitcnt lgkmcnt(10)
    v_mfma_f32_16x16x32_bf16 v[72:75], v[192:195], v[248:251], v[72:75]
    ds_read_b64_tr_b16 v[216:217], v4 offset:41344
    v_mfma_f32_16x16x32_bf16 v[88:91], v[196:199], v[248:251], v[88:91]
    ds_read_b64_tr_b16 v[218:219], v4 offset:41856
    s_waitcnt lgkmcnt(10)
    v_mfma_f32_16x16x32_bf16 v[96:99], v[200:203], v[240:243], v[96:99]
    ds_read_b64_tr_b16 v[220:221], v4 offset:41376
    v_mfma_f32_16x16x32_bf16 v[100:103], v[200:203], v[244:247], v[100:103]
    ds_read_b64_tr_b16 v[222:223], v4 offset:41888
    v_mfma_f32_16x16x32_bf16 v[104:107], v[200:203], v[248:251], v[104:107]
    s_waitcnt lgkmcnt(10)
    v_mfma_f32_16x16x32_bf16 v[76:79], v[192:195], v[252:255], v[76:79]
    v_mfma_f32_16x16x32_bf16 v[92:95], v[196:199], v[252:255], v[92:95]
    v_mfma_f32_16x16x32_bf16 v[108:111], v[200:203], v[252:255], v[108:111]
    s_waitcnt lgkmcnt(8)
    v_mfma_f32_16x16x32_bf16 v[112:115], v[204:207], v[240:243], v[112:115]
    v_mfma_f32_16x16x32_bf16 v[116:119], v[204:207], v[244:247], v[116:119]
    v_mfma_f32_16x16x32_bf16 v[120:123], v[204:207], v[248:251], v[120:123]
    v_mfma_f32_16x16x32_bf16 v[124:127], v[204:207], v[252:255], v[124:127]
    s_waitcnt lgkmcnt(6)
    v_mfma_f32_16x16x32_bf16 v[128:131], v[208:211], v[240:243], v[128:131]
    ds_read_b64_tr_b16 v[192:193], v4 offset:54016
    v_mfma_f32_16x16x32_bf16 v[132:135], v[208:211], v[244:247], v[132:135]
    ds_read_b64_tr_b16 v[194:195], v4 offset:54528
    v_mfma_f32_16x16x32_bf16 v[136:139], v[208:211], v[248:251], v[136:139]
    ds_read_b64_tr_b16 v[224:225], v11 offset:45568
    v_mfma_f32_16x16x32_bf16 v[140:143], v[208:211], v[252:255], v[140:143]
    ds_read_b64_tr_b16 v[226:227], v11 offset:46080
    s_waitcnt lgkmcnt(8)
    v_mfma_f32_16x16x32_bf16 v[144:147], v[212:215], v[240:243], v[144:147]
    ds_read_b64_tr_b16 v[228:229], v11 offset:45600
    v_mfma_f32_16x16x32_bf16 v[148:151], v[212:215], v[244:247], v[148:151]
    ds_read_b64_tr_b16 v[230:231], v11 offset:46112
    v_mfma_f32_16x16x32_bf16 v[152:155], v[212:215], v[248:251], v[152:155]
    ds_read_b64_tr_b16 v[196:197], v4 offset:54048
    v_mfma_f32_16x16x32_bf16 v[156:159], v[212:215], v[252:255], v[156:159]
    ds_read_b64_tr_b16 v[198:199], v4 offset:54560
    s_waitcnt lgkmcnt(10)
    v_mfma_f32_16x16x32_bf16 v[160:163], v[216:219], v[240:243], v[160:163]
    ds_read_b64_tr_b16 v[232:233], v11 offset:45632
    v_mfma_f32_16x16x32_bf16 v[164:167], v[216:219], v[244:247], v[164:167]
    ds_read_b64_tr_b16 v[234:235], v11 offset:46144
    v_mfma_f32_16x16x32_bf16 v[168:171], v[216:219], v[248:251], v[168:171]
    ds_read_b64_tr_b16 v[200:201], v4 offset:58240
    v_mfma_f32_16x16x32_bf16 v[172:175], v[216:219], v[252:255], v[172:175]
    ds_read_b64_tr_b16 v[202:203], v4 offset:58752
    s_waitcnt lgkmcnt(12)
    v_mfma_f32_16x16x32_bf16 v[176:179], v[220:223], v[240:243], v[176:179]
    ds_read_b64_tr_b16 v[236:237], v11 offset:45664
    v_mfma_f32_16x16x32_bf16 v[180:183], v[220:223], v[244:247], v[180:183]
    ds_read_b64_tr_b16 v[238:239], v11 offset:46176
    v_mfma_f32_16x16x32_bf16 v[184:187], v[220:223], v[248:251], v[184:187]
    ds_read_b64_tr_b16 v[204:205], v4 offset:58272
    v_mfma_f32_16x16x32_bf16 v[188:191], v[220:223], v[252:255], v[188:191]
    ds_read_b64_tr_b16 v[206:207], v4 offset:58784
    s_barrier
    s_waitcnt lgkmcnt(14)
    s_waitcnt lgkmcnt(12)
    v_mfma_f32_16x16x32_bf16 v[64:67], v[192:195], v[224:227], v[64:67]
    ds_read_b64_tr_b16 v[208:209], v2 offset:54016
    s_waitcnt lgkmcnt(11)
    v_mfma_f32_16x16x32_bf16 v[68:71], v[192:195], v[228:231], v[68:71]
    ds_read_b64_tr_b16 v[210:211], v2 offset:54528
    s_waitcnt lgkmcnt(10)
    v_mfma_f32_16x16x32_bf16 v[80:83], v[196:199], v[224:227], v[80:83]
    ds_read_b64_tr_b16 v[240:241], v9 offset:45568
    v_mfma_f32_16x16x32_bf16 v[84:87], v[196:199], v[228:231], v[84:87]
    ds_read_b64_tr_b16 v[242:243], v9 offset:46080
    s_waitcnt lgkmcnt(10)
    v_mfma_f32_16x16x32_bf16 v[72:75], v[192:195], v[232:235], v[72:75]
    ds_read_b64_tr_b16 v[244:245], v9 offset:45600
    v_mfma_f32_16x16x32_bf16 v[88:91], v[196:199], v[232:235], v[88:91]
    ds_read_b64_tr_b16 v[246:247], v9 offset:46112
    s_waitcnt lgkmcnt(10)
    v_mfma_f32_16x16x32_bf16 v[96:99], v[200:203], v[224:227], v[96:99]
    ds_read_b64_tr_b16 v[212:213], v2 offset:54048
    v_mfma_f32_16x16x32_bf16 v[100:103], v[200:203], v[228:231], v[100:103]
    ds_read_b64_tr_b16 v[214:215], v2 offset:54560
    v_mfma_f32_16x16x32_bf16 v[104:107], v[200:203], v[232:235], v[104:107]
    ds_read_b64_tr_b16 v[248:249], v9 offset:45632
    s_waitcnt lgkmcnt(11)
    v_mfma_f32_16x16x32_bf16 v[76:79], v[192:195], v[236:239], v[76:79]
    ds_read_b64_tr_b16 v[250:251], v9 offset:46144
    v_mfma_f32_16x16x32_bf16 v[92:95], v[196:199], v[236:239], v[92:95]
    ds_read_b64_tr_b16 v[216:217], v2 offset:58240
    v_mfma_f32_16x16x32_bf16 v[108:111], v[200:203], v[236:239], v[108:111]
    ds_read_b64_tr_b16 v[218:219], v2 offset:58752
    s_waitcnt lgkmcnt(12)
    v_mfma_f32_16x16x32_bf16 v[112:115], v[204:207], v[224:227], v[112:115]
    ds_read_b64_tr_b16 v[252:253], v9 offset:45664
    v_mfma_f32_16x16x32_bf16 v[116:119], v[204:207], v[228:231], v[116:119]
    ds_read_b64_tr_b16 v[254:255], v9 offset:46176
    v_mfma_f32_16x16x32_bf16 v[120:123], v[204:207], v[232:235], v[120:123]
    ds_read_b64_tr_b16 v[220:221], v2 offset:58272
    v_mfma_f32_16x16x32_bf16 v[124:127], v[204:207], v[236:239], v[124:127]
    ds_read_b64_tr_b16 v[222:223], v2 offset:58784
    s_waitcnt lgkmcnt(14)
    s_waitcnt lgkmcnt(12)
    v_mfma_f32_16x16x32_bf16 v[64:67], v[208:211], v[240:243], v[64:67]
    ds_read_b64_tr_b16 v[192:193], v3 offset:54016
    s_waitcnt lgkmcnt(11)
    v_mfma_f32_16x16x32_bf16 v[68:71], v[208:211], v[244:247], v[68:71]
    ds_read_b64_tr_b16 v[194:195], v3 offset:54528
    s_waitcnt lgkmcnt(10)
    v_mfma_f32_16x16x32_bf16 v[80:83], v[212:215], v[240:243], v[80:83]
    ds_read_b64_tr_b16 v[224:225], v10 offset:45568
    v_mfma_f32_16x16x32_bf16 v[84:87], v[212:215], v[244:247], v[84:87]
    ds_read_b64_tr_b16 v[226:227], v10 offset:46080
    s_waitcnt lgkmcnt(10)
    v_mfma_f32_16x16x32_bf16 v[72:75], v[208:211], v[248:251], v[72:75]
    ds_read_b64_tr_b16 v[228:229], v10 offset:45600
    v_mfma_f32_16x16x32_bf16 v[88:91], v[212:215], v[248:251], v[88:91]
    ds_read_b64_tr_b16 v[230:231], v10 offset:46112
    s_waitcnt lgkmcnt(10)
    v_mfma_f32_16x16x32_bf16 v[96:99], v[216:219], v[240:243], v[96:99]
    ds_read_b64_tr_b16 v[196:197], v3 offset:54048
    v_mfma_f32_16x16x32_bf16 v[100:103], v[216:219], v[244:247], v[100:103]
    ds_read_b64_tr_b16 v[198:199], v3 offset:54560
    v_mfma_f32_16x16x32_bf16 v[104:107], v[216:219], v[248:251], v[104:107]
    ds_read_b64_tr_b16 v[232:233], v10 offset:45632
    s_waitcnt lgkmcnt(11)
    v_mfma_f32_16x16x32_bf16 v[76:79], v[208:211], v[252:255], v[76:79]
    ds_read_b64_tr_b16 v[234:235], v10 offset:46144
    v_mfma_f32_16x16x32_bf16 v[92:95], v[212:215], v[252:255], v[92:95]
    ds_read_b64_tr_b16 v[200:201], v3 offset:58240
    v_mfma_f32_16x16x32_bf16 v[108:111], v[216:219], v[252:255], v[108:111]
    ds_read_b64_tr_b16 v[202:203], v3 offset:58752
    s_waitcnt lgkmcnt(12)
    v_mfma_f32_16x16x32_bf16 v[112:115], v[220:223], v[240:243], v[112:115]
    ds_read_b64_tr_b16 v[236:237], v10 offset:45664
KMPG22:
    s_cbranch_execz KMPG30
    v_mfma_f32_16x16x32_bf16 v[116:119], v[220:223], v[244:247], v[116:119]
    ds_read_b64_tr_b16 v[238:239], v10 offset:46176
    v_mfma_f32_16x16x32_bf16 v[120:123], v[220:223], v[248:251], v[120:123]
    ds_read_b64_tr_b16 v[204:205], v3 offset:58272
    v_mfma_f32_16x16x32_bf16 v[124:127], v[220:223], v[252:255], v[124:127]
    ds_read_b64_tr_b16 v[206:207], v3 offset:58784
    s_barrier
    s_waitcnt lgkmcnt(14)
    s_waitcnt lgkmcnt(12)
    v_mfma_f32_16x16x32_bf16 v[64:67], v[192:195], v[224:227], v[64:67]
    ds_read_b64_tr_b16 v[208:209], v3 offset:20224
    s_waitcnt lgkmcnt(11)
    v_mfma_f32_16x16x32_bf16 v[68:71], v[192:195], v[228:231], v[68:71]
    ds_read_b64_tr_b16 v[210:211], v3 offset:20736
    s_waitcnt lgkmcnt(10)
    v_mfma_f32_16x16x32_bf16 v[80:83], v[196:199], v[224:227], v[80:83]
    ds_read_b64_tr_b16 v[240:241], v10 offset:11776
    v_mfma_f32_16x16x32_bf16 v[84:87], v[196:199], v[228:231], v[84:87]
    ds_read_b64_tr_b16 v[242:243], v10 offset:12288
    s_waitcnt lgkmcnt(10)
    v_mfma_f32_16x16x32_bf16 v[72:75], v[192:195], v[232:235], v[72:75]
    ds_read_b64_tr_b16 v[244:245], v10 offset:11808
    v_mfma_f32_16x16x32_bf16 v[88:91], v[196:199], v[232:235], v[88:91]
    ds_read_b64_tr_b16 v[246:247], v10 offset:12320
    s_waitcnt lgkmcnt(10)
    v_mfma_f32_16x16x32_bf16 v[96:99], v[200:203], v[224:227], v[96:99]
    ds_read_b64_tr_b16 v[212:213], v3 offset:20256
    v_mfma_f32_16x16x32_bf16 v[100:103], v[200:203], v[228:231], v[100:103]
    ds_read_b64_tr_b16 v[214:215], v3 offset:20768
    v_mfma_f32_16x16x32_bf16 v[104:107], v[200:203], v[232:235], v[104:107]
    ds_read_b64_tr_b16 v[248:249], v10 offset:11840
    s_waitcnt lgkmcnt(11)
    v_mfma_f32_16x16x32_bf16 v[76:79], v[192:195], v[236:239], v[76:79]
    ds_read_b64_tr_b16 v[250:251], v10 offset:12352
    v_mfma_f32_16x16x32_bf16 v[92:95], v[196:199], v[236:239], v[92:95]
    ds_read_b64_tr_b16 v[216:217], v3 offset:24448
    v_mfma_f32_16x16x32_bf16 v[108:111], v[200:203], v[236:239], v[108:111]
    ds_read_b64_tr_b16 v[218:219], v3 offset:24960
    s_waitcnt lgkmcnt(12)
    v_mfma_f32_16x16x32_bf16 v[112:115], v[204:207], v[224:227], v[112:115]
    ds_read_b64_tr_b16 v[252:253], v10 offset:11872
    v_mfma_f32_16x16x32_bf16 v[116:119], v[204:207], v[228:231], v[116:119]
    ds_read_b64_tr_b16 v[254:255], v10 offset:12384
    v_mfma_f32_16x16x32_bf16 v[120:123], v[204:207], v[232:235], v[120:123]
    ds_read_b64_tr_b16 v[220:221], v3 offset:24480
    v_mfma_f32_16x16x32_bf16 v[124:127], v[204:207], v[236:239], v[124:127]
    ds_read_b64_tr_b16 v[222:223], v3 offset:24992
    s_waitcnt lgkmcnt(14)
    s_waitcnt lgkmcnt(12)
    v_mfma_f32_16x16x32_bf16 v[64:67], v[208:211], v[240:243], v[64:67]
    ds_read_b64_tr_b16 v[192:193], v2 offset:20224
    s_waitcnt lgkmcnt(11)
    v_mfma_f32_16x16x32_bf16 v[68:71], v[208:211], v[244:247], v[68:71]
    ds_read_b64_tr_b16 v[194:195], v2 offset:20736
    s_waitcnt lgkmcnt(10)
    v_mfma_f32_16x16x32_bf16 v[80:83], v[212:215], v[240:243], v[80:83]
    ds_read_b64_tr_b16 v[224:225], v9 offset:11776
    v_mfma_f32_16x16x32_bf16 v[84:87], v[212:215], v[244:247], v[84:87]
    ds_read_b64_tr_b16 v[226:227], v9 offset:12288
    s_waitcnt lgkmcnt(10)
    v_mfma_f32_16x16x32_bf16 v[72:75], v[208:211], v[248:251], v[72:75]
    ds_read_b64_tr_b16 v[228:229], v9 offset:11808
    v_mfma_f32_16x16x32_bf16 v[88:91], v[212:215], v[248:251], v[88:91]
    ds_read_b64_tr_b16 v[230:231], v9 offset:12320
    s_waitcnt lgkmcnt(10)
    v_mfma_f32_16x16x32_bf16 v[96:99], v[216:219], v[240:243], v[96:99]
    ds_read_b64_tr_b16 v[196:197], v2 offset:20256
    v_mfma_f32_16x16x32_bf16 v[100:103], v[216:219], v[244:247], v[100:103]
    ds_read_b64_tr_b16 v[198:199], v2 offset:20768
    v_mfma_f32_16x16x32_bf16 v[104:107], v[216:219], v[248:251], v[104:107]
    ds_read_b64_tr_b16 v[232:233], v9 offset:11840
    s_waitcnt lgkmcnt(11)
    v_mfma_f32_16x16x32_bf16 v[76:79], v[208:211], v[252:255], v[76:79]
    ds_read_b64_tr_b16 v[234:235], v9 offset:12352
    v_mfma_f32_16x16x32_bf16 v[92:95], v[212:215], v[252:255], v[92:95]
    ds_read_b64_tr_b16 v[200:201], v2 offset:24448
    v_mfma_f32_16x16x32_bf16 v[108:111], v[216:219], v[252:255], v[108:111]
    ds_read_b64_tr_b16 v[202:203], v2 offset:24960
    s_waitcnt lgkmcnt(12)
    v_mfma_f32_16x16x32_bf16 v[112:115], v[220:223], v[240:243], v[112:115]
    ds_read_b64_tr_b16 v[236:237], v9 offset:11872
    v_mfma_f32_16x16x32_bf16 v[116:119], v[220:223], v[244:247], v[116:119]
    ds_read_b64_tr_b16 v[238:239], v9 offset:12384
    v_mfma_f32_16x16x32_bf16 v[120:123], v[220:223], v[248:251], v[120:123]
    ds_read_b64_tr_b16 v[204:205], v2 offset:24480
    v_mfma_f32_16x16x32_bf16 v[124:127], v[220:223], v[252:255], v[124:127]
    ds_read_b64_tr_b16 v[206:207], v2 offset:24992
    s_barrier
    s_waitcnt lgkmcnt(14)
    s_waitcnt lgkmcnt(12)
    v_mfma_f32_16x16x32_bf16 v[64:67], v[192:195], v[224:227], v[64:67]
    ds_read_b64_tr_b16 v[208:209], v2 offset:37120
    s_waitcnt lgkmcnt(11)
    v_mfma_f32_16x16x32_bf16 v[68:71], v[192:195], v[228:231], v[68:71]
    ds_read_b64_tr_b16 v[210:211], v2 offset:37632
    s_waitcnt lgkmcnt(10)
    v_mfma_f32_16x16x32_bf16 v[80:83], v[196:199], v[224:227], v[80:83]
    ds_read_b64_tr_b16 v[240:241], v9 offset:28672
    v_mfma_f32_16x16x32_bf16 v[84:87], v[196:199], v[228:231], v[84:87]
    ds_read_b64_tr_b16 v[242:243], v9 offset:29184
    s_waitcnt lgkmcnt(10)
    v_mfma_f32_16x16x32_bf16 v[72:75], v[192:195], v[232:235], v[72:75]
    ds_read_b64_tr_b16 v[244:245], v9 offset:28704
    v_mfma_f32_16x16x32_bf16 v[88:91], v[196:199], v[232:235], v[88:91]
    ds_read_b64_tr_b16 v[246:247], v9 offset:29216
    s_waitcnt lgkmcnt(10)
    v_mfma_f32_16x16x32_bf16 v[96:99], v[200:203], v[224:227], v[96:99]
    ds_read_b64_tr_b16 v[212:213], v2 offset:37152
    v_mfma_f32_16x16x32_bf16 v[100:103], v[200:203], v[228:231], v[100:103]
    ds_read_b64_tr_b16 v[214:215], v2 offset:37664
    v_mfma_f32_16x16x32_bf16 v[104:107], v[200:203], v[232:235], v[104:107]
    ds_read_b64_tr_b16 v[248:249], v9 offset:28736
    s_waitcnt lgkmcnt(11)
    v_mfma_f32_16x16x32_bf16 v[76:79], v[192:195], v[236:239], v[76:79]
    ds_read_b64_tr_b16 v[250:251], v9 offset:29248
    v_mfma_f32_16x16x32_bf16 v[92:95], v[196:199], v[236:239], v[92:95]
    ds_read_b64_tr_b16 v[216:217], v2 offset:41344
    v_mfma_f32_16x16x32_bf16 v[108:111], v[200:203], v[236:239], v[108:111]
    ds_read_b64_tr_b16 v[218:219], v2 offset:41856
    s_waitcnt lgkmcnt(12)
    v_mfma_f32_16x16x32_bf16 v[112:115], v[204:207], v[224:227], v[112:115]
    ds_read_b64_tr_b16 v[252:253], v9 offset:28768
    v_mfma_f32_16x16x32_bf16 v[116:119], v[204:207], v[228:231], v[116:119]
    ds_read_b64_tr_b16 v[254:255], v9 offset:29280
    v_mfma_f32_16x16x32_bf16 v[120:123], v[204:207], v[232:235], v[120:123]
    ds_read_b64_tr_b16 v[220:221], v2 offset:41376
    v_mfma_f32_16x16x32_bf16 v[124:127], v[204:207], v[236:239], v[124:127]
    ds_read_b64_tr_b16 v[222:223], v2 offset:41888
    s_waitcnt lgkmcnt(14)
    s_waitcnt lgkmcnt(12)
    v_mfma_f32_16x16x32_bf16 v[64:67], v[208:211], v[240:243], v[64:67]
    ds_read_b64_tr_b16 v[192:193], v4 offset:20224
    s_waitcnt lgkmcnt(11)
    v_mfma_f32_16x16x32_bf16 v[68:71], v[208:211], v[244:247], v[68:71]
    ds_read_b64_tr_b16 v[194:195], v4 offset:20736
    s_waitcnt lgkmcnt(10)
    v_mfma_f32_16x16x32_bf16 v[80:83], v[212:215], v[240:243], v[80:83]
    ds_read_b64_tr_b16 v[224:225], v11 offset:11776
    v_mfma_f32_16x16x32_bf16 v[84:87], v[212:215], v[244:247], v[84:87]
    ds_read_b64_tr_b16 v[226:227], v11 offset:12288
    s_waitcnt lgkmcnt(10)
    v_mfma_f32_16x16x32_bf16 v[72:75], v[208:211], v[248:251], v[72:75]
    ds_read_b64_tr_b16 v[228:229], v11 offset:11808
KMPG23:
    s_cbranch_execz KMPG31
    v_mfma_f32_16x16x32_bf16 v[88:91], v[212:215], v[248:251], v[88:91]
    ds_read_b64_tr_b16 v[230:231], v11 offset:12320
    s_waitcnt lgkmcnt(10)
    v_mfma_f32_16x16x32_bf16 v[96:99], v[216:219], v[240:243], v[96:99]
    ds_read_b64_tr_b16 v[196:197], v4 offset:20256
    v_mfma_f32_16x16x32_bf16 v[100:103], v[216:219], v[244:247], v[100:103]
    ds_read_b64_tr_b16 v[198:199], v4 offset:20768
    v_mfma_f32_16x16x32_bf16 v[104:107], v[216:219], v[248:251], v[104:107]
    ds_read_b64_tr_b16 v[232:233], v11 offset:11840
    s_waitcnt lgkmcnt(11)
    v_mfma_f32_16x16x32_bf16 v[76:79], v[208:211], v[252:255], v[76:79]
    ds_read_b64_tr_b16 v[234:235], v11 offset:12352
    v_mfma_f32_16x16x32_bf16 v[92:95], v[212:215], v[252:255], v[92:95]
    ds_read_b64_tr_b16 v[200:201], v4 offset:24448
    v_mfma_f32_16x16x32_bf16 v[108:111], v[216:219], v[252:255], v[108:111]
    ds_read_b64_tr_b16 v[202:203], v4 offset:24960
    s_waitcnt lgkmcnt(12)
    v_mfma_f32_16x16x32_bf16 v[112:115], v[220:223], v[240:243], v[112:115]
    ds_read_b64_tr_b16 v[236:237], v11 offset:11872
    v_mfma_f32_16x16x32_bf16 v[116:119], v[220:223], v[244:247], v[116:119]
    ds_read_b64_tr_b16 v[238:239], v11 offset:12384
    v_mfma_f32_16x16x32_bf16 v[120:123], v[220:223], v[248:251], v[120:123]
    ds_read_b64_tr_b16 v[204:205], v4 offset:24480
    v_mfma_f32_16x16x32_bf16 v[124:127], v[220:223], v[252:255], v[124:127]
    ds_read_b64_tr_b16 v[206:207], v4 offset:24992
    s_barrier
    s_waitcnt lgkmcnt(14)
    s_waitcnt lgkmcnt(12)
    v_mfma_f32_16x16x32_bf16 v[64:67], v[192:195], v[224:227], v[64:67]
    ds_read_b64_tr_b16 v[208:209], v4 offset:37120
    ds_read_b64 v[16:17], v13 offset:10240
    s_waitcnt lgkmcnt(12)
    v_mfma_f32_16x16x32_bf16 v[68:71], v[192:195], v[228:231], v[68:71]
    ds_read_b64_tr_b16 v[210:211], v4 offset:37632
    ds_read_b64 v[18:19], v13 offset:10368
    s_waitcnt lgkmcnt(12)
    v_mfma_f32_16x16x32_bf16 v[80:83], v[196:199], v[224:227], v[80:83]
    ds_read_b64_tr_b16 v[240:241], v11 offset:28672
    ds_read_b64 v[20:21], v13 offset:10496
    v_mfma_f32_16x16x32_bf16 v[84:87], v[196:199], v[228:231], v[84:87]
    ds_read_b64_tr_b16 v[242:243], v11 offset:29184
    ds_read_b64 v[22:23], v13 offset:10624
    s_waitcnt lgkmcnt(14)
    v_mfma_f32_16x16x32_bf16 v[72:75], v[192:195], v[232:235], v[72:75]
    ds_read_b64_tr_b16 v[244:245], v11 offset:28704
    ds_read_b128 v[24:27], v12 offset:8192
    v_mfma_f32_16x16x32_bf16 v[88:91], v[196:199], v[232:235], v[88:91]
    ds_read_b64_tr_b16 v[246:247], v11 offset:29216
    ds_read_b128 v[28:31], v12 offset:8448
    s_waitcnt lgkmcnt(15)
    v_mfma_f32_16x16x32_bf16 v[96:99], v[200:203], v[224:227], v[96:99]
    ds_read_b64_tr_b16 v[212:213], v4 offset:37152
    ds_read_b128 v[32:35], v12 offset:8704
    v_mfma_f32_16x16x32_bf16 v[100:103], v[200:203], v[228:231], v[100:103]
    ds_read_b64_tr_b16 v[214:215], v4 offset:37664
    ds_read_b128 v[36:39], v12 offset:8960
    v_mfma_f32_16x16x32_bf16 v[104:107], v[200:203], v[232:235], v[104:107]
    ds_read_b64_tr_b16 v[248:249], v11 offset:28736
    ds_read_b128 v[40:43], v12 offset:8256
    s_waitcnt lgkmcnt(15)
    v_mfma_f32_16x16x32_bf16 v[76:79], v[192:195], v[236:239], v[76:79]
    ds_read_b64_tr_b16 v[250:251], v11 offset:29248
    ds_read_b128 v[44:47], v12 offset:8512
    v_mfma_f32_16x16x32_bf16 v[92:95], v[196:199], v[236:239], v[92:95]
    ds_read_b64_tr_b16 v[216:217], v4 offset:41344
    ds_read_b128 v[48:51], v12 offset:8768
    v_mfma_f32_16x16x32_bf16 v[108:111], v[200:203], v[236:239], v[108:111]
    ds_read_b64_tr_b16 v[218:219], v4 offset:41856
    ds_read_b128 v[52:55], v12 offset:9024
    v_mfma_f32_16x16x32_bf16 v[112:115], v[204:207], v[224:227], v[112:115]
    ds_read_b64_tr_b16 v[252:253], v11 offset:28768
    v_mfma_f32_16x16x32_bf16 v[116:119], v[204:207], v[228:231], v[116:119]
    ds_read_b64_tr_b16 v[254:255], v11 offset:29280
    v_mfma_f32_16x16x32_bf16 v[120:123], v[204:207], v[232:235], v[120:123]
    ds_read_b64_tr_b16 v[220:221], v4 offset:41376
    v_mfma_f32_16x16x32_bf16 v[124:127], v[204:207], v[236:239], v[124:127]
    ds_read_b64_tr_b16 v[222:223], v4 offset:41888
    s_waitcnt lgkmcnt(15)
    v_mfma_f32_16x16x32_bf16 v[64:67], v[208:211], v[240:243], v[64:67]
    ds_read_b64_tr_b16 v[192:193], v4 offset:54016
    v_mfma_f32_16x16x32_bf16 v[68:71], v[208:211], v[244:247], v[68:71]
    ds_read_b64_tr_b16 v[194:195], v4 offset:54528
    s_waitcnt lgkmcnt(15)
    v_mfma_f32_16x16x32_bf16 v[80:83], v[212:215], v[240:243], v[80:83]
    ds_read_b64_tr_b16 v[224:225], v11 offset:45568
    v_mfma_f32_16x16x32_bf16 v[84:87], v[212:215], v[244:247], v[84:87]
    ds_read_b64_tr_b16 v[226:227], v11 offset:46080
    s_waitcnt lgkmcnt(13)
    v_mfma_f32_16x16x32_bf16 v[72:75], v[208:211], v[248:251], v[72:75]
    ds_read_b64_tr_b16 v[228:229], v11 offset:45600
    v_mfma_f32_16x16x32_bf16 v[88:91], v[212:215], v[248:251], v[88:91]
    ds_read_b64_tr_b16 v[230:231], v11 offset:46112
    s_waitcnt lgkmcnt(11)
    v_mfma_f32_16x16x32_bf16 v[96:99], v[216:219], v[240:243], v[96:99]
    ds_read_b64_tr_b16 v[196:197], v4 offset:54048
    v_mfma_f32_16x16x32_bf16 v[100:103], v[216:219], v[244:247], v[100:103]
    ds_read_b64_tr_b16 v[198:199], v4 offset:54560
    v_mfma_f32_16x16x32_bf16 v[104:107], v[216:219], v[248:251], v[104:107]
    ds_read_b64_tr_b16 v[232:233], v11 offset:45632
    s_waitcnt lgkmcnt(11)
    v_mfma_f32_16x16x32_bf16 v[76:79], v[208:211], v[252:255], v[76:79]
    ds_read_b64_tr_b16 v[234:235], v11 offset:46144
    v_mfma_f32_16x16x32_bf16 v[92:95], v[212:215], v[252:255], v[92:95]
    ds_read_b64_tr_b16 v[200:201], v4 offset:58240
    v_mfma_f32_16x16x32_bf16 v[108:111], v[216:219], v[252:255], v[108:111]
    ds_read_b64_tr_b16 v[202:203], v4 offset:58752
    s_waitcnt lgkmcnt(12)
    v_mfma_f32_16x16x32_bf16 v[112:115], v[220:223], v[240:243], v[112:115]
    ds_read_b64_tr_b16 v[236:237], v11 offset:45664
    v_mfma_f32_16x16x32_bf16 v[116:119], v[220:223], v[244:247], v[116:119]
    ds_read_b64_tr_b16 v[238:239], v11 offset:46176
    v_mfma_f32_16x16x32_bf16 v[120:123], v[220:223], v[248:251], v[120:123]
    ds_read_b64_tr_b16 v[204:205], v4 offset:58272
    v_mfma_f32_16x16x32_bf16 v[124:127], v[220:223], v[252:255], v[124:127]
    ds_read_b64_tr_b16 v[206:207], v4 offset:58784
    v_pk_fma_f32 v[64:65], v[16:17], v[64:65], v[28:29] op_sel:[1,0,0] op_sel_hi:[1,1,1]
    v_pk_fma_f32 v[66:67], v[16:17], v[66:67], v[30:31] op_sel:[1,0,0] op_sel_hi:[1,1,1]
    v_pk_fma_f32 v[68:69], v[18:19], v[68:69], v[28:29] op_sel:[1,0,0] op_sel_hi:[1,1,1]
    v_pk_fma_f32 v[70:71], v[18:19], v[70:71], v[30:31] op_sel:[1,0,0] op_sel_hi:[1,1,1]
    v_pk_fma_f32 v[80:81], v[16:17], v[80:81], v[44:45] op_sel:[1,0,0] op_sel_hi:[1,1,1]
    v_pk_fma_f32 v[82:83], v[16:17], v[82:83], v[46:47] op_sel:[1,0,0] op_sel_hi:[1,1,1]
    v_pk_fma_f32 v[84:85], v[18:19], v[84:85], v[44:45] op_sel:[1,0,0] op_sel_hi:[1,1,1]
    v_pk_fma_f32 v[86:87], v[18:19], v[86:87], v[46:47] op_sel:[1,0,0] op_sel_hi:[1,1,1]
    v_pk_fma_f32 v[96:97], v[16:17], v[96:97], v[36:37] op_sel:[1,0,0] op_sel_hi:[1,1,1]
    v_pk_fma_f32 v[98:99], v[16:17], v[98:99], v[38:39] op_sel:[1,0,0] op_sel_hi:[1,1,1]
    v_pk_fma_f32 v[100:101], v[18:19], v[100:101], v[36:37] op_sel:[1,0,0] op_sel_hi:[1,1,1]
    v_pk_fma_f32 v[102:103], v[18:19], v[102:103], v[38:39] op_sel:[1,0,0] op_sel_hi:[1,1,1]
    v_pk_fma_f32 v[112:113], v[16:17], v[112:113], v[52:53] op_sel:[1,0,0] op_sel_hi:[1,1,1]
    v_pk_fma_f32 v[114:115], v[16:17], v[114:115], v[54:55] op_sel:[1,0,0] op_sel_hi:[1,1,1]
    v_pk_fma_f32 v[116:117], v[18:19], v[116:117], v[52:53] op_sel:[1,0,0] op_sel_hi:[1,1,1]
    v_pk_fma_f32 v[118:119], v[18:19], v[118:119], v[54:55] op_sel:[1,0,0] op_sel_hi:[1,1,1]
    v_pk_fma_f32 v[64:65], v[16:17], v[24:25], v[64:65] op_sel_hi:[0,1,1]
    v_pk_fma_f32 v[66:67], v[16:17], v[26:27], v[66:67] op_sel_hi:[0,1,1]
    v_pk_fma_f32 v[68:69], v[18:19], v[24:25], v[68:69] op_sel_hi:[0,1,1]
    v_pk_fma_f32 v[70:71], v[18:19], v[26:27], v[70:71] op_sel_hi:[0,1,1]
    v_pk_fma_f32 v[80:81], v[16:17], v[40:41], v[80:81] op_sel_hi:[0,1,1]
KMPG24:
    s_cbranch_execz KMPG32
    s_nop 0
    v_pk_fma_f32 v[82:83], v[16:17], v[42:43], v[82:83] op_sel_hi:[0,1,1]
    v_pk_fma_f32 v[84:85], v[18:19], v[40:41], v[84:85] op_sel_hi:[0,1,1]
    v_pk_fma_f32 v[86:87], v[18:19], v[42:43], v[86:87] op_sel_hi:[0,1,1]
    v_pk_fma_f32 v[96:97], v[16:17], v[32:33], v[96:97] op_sel_hi:[0,1,1]
    v_pk_fma_f32 v[98:99], v[16:17], v[34:35], v[98:99] op_sel_hi:[0,1,1]
    v_pk_fma_f32 v[100:101], v[18:19], v[32:33], v[100:101] op_sel_hi:[0,1,1]
    v_pk_fma_f32 v[102:103], v[18:19], v[34:35], v[102:103] op_sel_hi:[0,1,1]
    v_pk_fma_f32 v[112:113], v[16:17], v[48:49], v[112:113] op_sel_hi:[0,1,1]
    v_pk_fma_f32 v[114:115], v[16:17], v[50:51], v[114:115] op_sel_hi:[0,1,1]
    v_pk_fma_f32 v[116:117], v[18:19], v[48:49], v[116:117] op_sel_hi:[0,1,1]
    v_pk_fma_f32 v[118:119], v[18:19], v[50:51], v[118:119] op_sel_hi:[0,1,1]
    v_cvt_pk_bf16_f32 v64, v64, v65
    v_cvt_pk_bf16_f32 v66, v66, v67
    v_cvt_pk_bf16_f32 v68, v68, v69
    v_cvt_pk_bf16_f32 v70, v70, v71
    v_cvt_pk_bf16_f32 v80, v80, v81
    v_cvt_pk_bf16_f32 v82, v82, v83
    v_cvt_pk_bf16_f32 v84, v84, v85
    v_cvt_pk_bf16_f32 v86, v86, v87
    v_cvt_pk_bf16_f32 v96, v96, 0
    v_cvt_pk_bf16_f32 v98, v98, 0
    v_cvt_pk_bf16_f32 v100, v100, 0
    v_cvt_pk_bf16_f32 v102, v102, 0
    v_cvt_pk_bf16_f32 v112, v112, 0
    v_cvt_pk_bf16_f32 v114, v114, 0
    v_cvt_pk_bf16_f32 v116, v116, 0
    v_cvt_pk_bf16_f32 v118, v118, 0
    v_cvt_pk_bf16_f32 v97, 0, v97
    v_cvt_pk_bf16_f32 v99, 0, v99
    v_cvt_pk_bf16_f32 v101, 0, v101
    v_cvt_pk_bf16_f32 v103, 0, v103
    v_cvt_pk_bf16_f32 v113, 0, v113
    v_cvt_pk_bf16_f32 v115, 0, v115
    v_cvt_pk_bf16_f32 v117, 0, v117
    v_cvt_pk_bf16_f32 v119, 0, v119
    v_pk_max_i16 v64, v64, 0
    v_pk_max_i16 v66, v66, 0
    v_pk_max_i16 v68, v68, 0
    v_pk_max_i16 v70, v70, 0
    v_pk_max_i16 v80, v80, 0
    v_pk_max_i16 v82, v82, 0
    v_pk_max_i16 v84, v84, 0
    v_pk_max_i16 v86, v86, 0
    v_dot2_f32_bf16 v96, v64, v96, 0
    v_dot2_f32_bf16 v98, v66, v98, 0
    v_dot2_f32_bf16 v100, v68, v100, 0
    v_dot2_f32_bf16 v102, v70, v102, 0
    v_dot2_f32_bf16 v112, v80, v112, 0
    v_dot2_f32_bf16 v114, v82, v114, 0
    v_dot2_f32_bf16 v116, v84, v116, 0
    v_dot2_f32_bf16 v118, v86, v118, 0
    v_dot2_f32_bf16 v97, v64, v97, 0
    v_dot2_f32_bf16 v99, v66, v99, 0
    v_dot2_f32_bf16 v101, v68, v101, 0
    v_dot2_f32_bf16 v103, v70, v103, 0
    v_dot2_f32_bf16 v113, v80, v113, 0
    v_dot2_f32_bf16 v115, v82, v115, 0
    v_dot2_f32_bf16 v117, v84, v117, 0
    v_dot2_f32_bf16 v119, v86, v119, 0
    v_cvt_pk_bf16_f32 v64, v96, v97
    v_cvt_pk_bf16_f32 v65, v98, v99
    v_cvt_pk_bf16_f32 v68, v100, v101
    v_cvt_pk_bf16_f32 v69, v102, v103
    v_cvt_pk_bf16_f32 v66, v112, v113
    v_cvt_pk_bf16_f32 v67, v114, v115
    v_cvt_pk_bf16_f32 v70, v116, v117
    v_cvt_pk_bf16_f32 v71, v118, v119
    buffer_store_dwordx4 v[64:67], v6, s[24:27], s62 offen offset:0 sc1
    buffer_store_dwordx4 v[68:71], v6, s[24:27], s62 offen offset:1024 sc1
    v_pk_fma_f32 v[72:73], v[20:21], v[72:73], v[28:29] op_sel:[1,0,0] op_sel_hi:[1,1,1]
    v_pk_fma_f32 v[74:75], v[20:21], v[74:75], v[30:31] op_sel:[1,0,0] op_sel_hi:[1,1,1]
    v_pk_fma_f32 v[76:77], v[22:23], v[76:77], v[28:29] op_sel:[1,0,0] op_sel_hi:[1,1,1]
    v_pk_fma_f32 v[78:79], v[22:23], v[78:79], v[30:31] op_sel:[1,0,0] op_sel_hi:[1,1,1]
    v_pk_fma_f32 v[88:89], v[20:21], v[88:89], v[44:45] op_sel:[1,0,0] op_sel_hi:[1,1,1]
    v_pk_fma_f32 v[90:91], v[20:21], v[90:91], v[46:47] op_sel:[1,0,0] op_sel_hi:[1,1,1]
    v_pk_fma_f32 v[92:93], v[22:23], v[92:93], v[44:45] op_sel:[1,0,0] op_sel_hi:[1,1,1]
    v_pk_fma_f32 v[94:95], v[22:23], v[94:95], v[46:47] op_sel:[1,0,0] op_sel_hi:[1,1,1]
    v_pk_fma_f32 v[104:105], v[20:21], v[104:105], v[36:37] op_sel:[1,0,0] op_sel_hi:[1,1,1]
    v_pk_fma_f32 v[106:107], v[20:21], v[106:107], v[38:39] op_sel:[1,0,0] op_sel_hi:[1,1,1]
    v_pk_fma_f32 v[108:109], v[22:23], v[108:109], v[36:37] op_sel:[1,0,0] op_sel_hi:[1,1,1]
    v_pk_fma_f32 v[110:111], v[22:23], v[110:111], v[38:39] op_sel:[1,0,0] op_sel_hi:[1,1,1]
    v_pk_fma_f32 v[120:121], v[20:21], v[120:121], v[52:53] op_sel:[1,0,0] op_sel_hi:[1,1,1]
    v_pk_fma_f32 v[122:123], v[20:21], v[122:123], v[54:55] op_sel:[1,0,0] op_sel_hi:[1,1,1]
    v_pk_fma_f32 v[124:125], v[22:23], v[124:125], v[52:53] op_sel:[1,0,0] op_sel_hi:[1,1,1]
    v_pk_fma_f32 v[126:127], v[22:23], v[126:127], v[54:55] op_sel:[1,0,0] op_sel_hi:[1,1,1]
    v_pk_fma_f32 v[72:73], v[20:21], v[24:25], v[72:73] op_sel_hi:[0,1,1]
    v_pk_fma_f32 v[74:75], v[20:21], v[26:27], v[74:75] op_sel_hi:[0,1,1]
    v_pk_fma_f32 v[76:77], v[22:23], v[24:25], v[76:77] op_sel_hi:[0,1,1]
    v_pk_fma_f32 v[78:79], v[22:23], v[26:27], v[78:79] op_sel_hi:[0,1,1]
    v_pk_fma_f32 v[88:89], v[20:21], v[40:41], v[88:89] op_sel_hi:[0,1,1]
    v_pk_fma_f32 v[90:91], v[20:21], v[42:43], v[90:91] op_sel_hi:[0,1,1]
    v_pk_fma_f32 v[92:93], v[22:23], v[40:41], v[92:93] op_sel_hi:[0,1,1]
    v_pk_fma_f32 v[94:95], v[22:23], v[42:43], v[94:95] op_sel_hi:[0,1,1]
    v_pk_fma_f32 v[104:105], v[20:21], v[32:33], v[104:105] op_sel_hi:[0,1,1]
    v_pk_fma_f32 v[106:107], v[20:21], v[34:35], v[106:107] op_sel_hi:[0,1,1]
    v_pk_fma_f32 v[108:109], v[22:23], v[32:33], v[108:109] op_sel_hi:[0,1,1]
    v_pk_fma_f32 v[110:111], v[22:23], v[34:35], v[110:111] op_sel_hi:[0,1,1]
    v_pk_fma_f32 v[120:121], v[20:21], v[48:49], v[120:121] op_sel_hi:[0,1,1]
    v_pk_fma_f32 v[122:123], v[20:21], v[50:51], v[122:123] op_sel_hi:[0,1,1]
    v_pk_fma_f32 v[124:125], v[22:23], v[48:49], v[124:125] op_sel_hi:[0,1,1]
    v_pk_fma_f32 v[126:127], v[22:23], v[50:51], v[126:127] op_sel_hi:[0,1,1]
    v_cvt_pk_bf16_f32 v72, v72, v73
    v_cvt_pk_bf16_f32 v74, v74, v75
    v_cvt_pk_bf16_f32 v76, v76, v77
    v_cvt_pk_bf16_f32 v78, v78, v79
    v_cvt_pk_bf16_f32 v88, v88, v89
    v_cvt_pk_bf16_f32 v90, v90, v91
    v_cvt_pk_bf16_f32 v92, v92, v93
    v_cvt_pk_bf16_f32 v94, v94, v95
    v_cvt_pk_bf16_f32 v104, v104, 0
    v_cvt_pk_bf16_f32 v106, v106, 0
    v_cvt_pk_bf16_f32 v108, v108, 0
    v_cvt_pk_bf16_f32 v110, v110, 0
    v_cvt_pk_bf16_f32 v120, v120, 0
    v_cvt_pk_bf16_f32 v122, v122, 0
    v_cvt_pk_bf16_f32 v124, v124, 0
    v_cvt_pk_bf16_f32 v126, v126, 0
    v_cvt_pk_bf16_f32 v105, 0, v105
    v_cvt_pk_bf16_f32 v107, 0, v107
    v_cvt_pk_bf16_f32 v109, 0, v109
    v_cvt_pk_bf16_f32 v111, 0, v111
    v_cvt_pk_bf16_f32 v121, 0, v121
    v_cvt_pk_bf16_f32 v123, 0, v123
    v_cvt_pk_bf16_f32 v125, 0, v125
    v_cvt_pk_bf16_f32 v127, 0, v127
    v_pk_max_i16 v72, v72, 0
    v_pk_max_i16 v74, v74, 0
KMPG25:
    s_cbranch_execz KMPG33
    s_nop 0
    v_pk_max_i16 v76, v76, 0
    v_pk_max_i16 v78, v78, 0
    v_pk_max_i16 v88, v88, 0
    v_pk_max_i16 v90, v90, 0
    v_pk_max_i16 v92, v92, 0
    v_pk_max_i16 v94, v94, 0
    v_dot2_f32_bf16 v104, v72, v104, 0
    v_dot2_f32_bf16 v106, v74, v106, 0
    v_dot2_f32_bf16 v108, v76, v108, 0
    v_dot2_f32_bf16 v110, v78, v110, 0
    v_dot2_f32_bf16 v120, v88, v120, 0
    v_dot2_f32_bf16 v122, v90, v122, 0
    v_dot2_f32_bf16 v124, v92, v124, 0
    v_dot2_f32_bf16 v126, v94, v126, 0
    v_dot2_f32_bf16 v105, v72, v105, 0
    v_dot2_f32_bf16 v107, v74, v107, 0
    v_dot2_f32_bf16 v109, v76, v109, 0
    v_dot2_f32_bf16 v111, v78, v111, 0
    v_dot2_f32_bf16 v121, v88, v121, 0
    v_dot2_f32_bf16 v123, v90, v123, 0
    v_dot2_f32_bf16 v125, v92, v125, 0
    v_dot2_f32_bf16 v127, v94, v127, 0
    v_cvt_pk_bf16_f32 v72, v104, v105
    v_cvt_pk_bf16_f32 v73, v106, v107
    v_cvt_pk_bf16_f32 v76, v108, v109
    v_cvt_pk_bf16_f32 v77, v110, v111
    v_cvt_pk_bf16_f32 v74, v120, v121
    v_cvt_pk_bf16_f32 v75, v122, v123
    v_cvt_pk_bf16_f32 v78, v124, v125
    v_cvt_pk_bf16_f32 v79, v126, v127
    buffer_store_dwordx4 v[72:75], v6, s[24:27], s62 offen offset:2048 sc1
    buffer_store_dwordx4 v[76:79], v6, s[24:27], s62 offen offset:3072 sc1
    s_barrier
    s_waitcnt lgkmcnt(14)
    s_waitcnt lgkmcnt(12)
    v_mfma_f32_16x16x32_bf16 v[128:131], v[192:195], v[224:227], v[128:131]
    ds_read_b64_tr_b16 v[208:209], v2 offset:54016
    s_waitcnt lgkmcnt(11)
    v_mfma_f32_16x16x32_bf16 v[132:135], v[192:195], v[228:231], v[132:135]
    ds_read_b64_tr_b16 v[210:211], v2 offset:54528
    s_waitcnt lgkmcnt(10)
    v_mfma_f32_16x16x32_bf16 v[144:147], v[196:199], v[224:227], v[144:147]
    ds_read_b64_tr_b16 v[240:241], v9 offset:45568
    v_mfma_f32_16x16x32_bf16 v[148:151], v[196:199], v[228:231], v[148:151]
    ds_read_b64_tr_b16 v[242:243], v9 offset:46080
    s_waitcnt lgkmcnt(10)
    v_mfma_f32_16x16x32_bf16 v[136:139], v[192:195], v[232:235], v[136:139]
    ds_read_b64_tr_b16 v[244:245], v9 offset:45600
    v_mfma_f32_16x16x32_bf16 v[152:155], v[196:199], v[232:235], v[152:155]
    ds_read_b64_tr_b16 v[246:247], v9 offset:46112
    s_waitcnt lgkmcnt(10)
    v_mfma_f32_16x16x32_bf16 v[160:163], v[200:203], v[224:227], v[160:163]
    ds_read_b64_tr_b16 v[212:213], v2 offset:54048
    v_mfma_f32_16x16x32_bf16 v[164:167], v[200:203], v[228:231], v[164:167]
    ds_read_b64_tr_b16 v[214:215], v2 offset:54560
    v_mfma_f32_16x16x32_bf16 v[168:171], v[200:203], v[232:235], v[168:171]
    ds_read_b64_tr_b16 v[248:249], v9 offset:45632
    s_waitcnt lgkmcnt(11)
    v_mfma_f32_16x16x32_bf16 v[140:143], v[192:195], v[236:239], v[140:143]
    ds_read_b64_tr_b16 v[250:251], v9 offset:46144
    v_mfma_f32_16x16x32_bf16 v[156:159], v[196:199], v[236:239], v[156:159]
    ds_read_b64_tr_b16 v[216:217], v2 offset:58240
    v_mfma_f32_16x16x32_bf16 v[172:175], v[200:203], v[236:239], v[172:175]
    ds_read_b64_tr_b16 v[218:219], v2 offset:58752
    s_waitcnt lgkmcnt(12)
    v_mfma_f32_16x16x32_bf16 v[176:179], v[204:207], v[224:227], v[176:179]
    ds_read_b64_tr_b16 v[252:253], v9 offset:45664
    v_mfma_f32_16x16x32_bf16 v[180:183], v[204:207], v[228:231], v[180:183]
    ds_read_b64_tr_b16 v[254:255], v9 offset:46176
    v_mfma_f32_16x16x32_bf16 v[184:187], v[204:207], v[232:235], v[184:187]
    ds_read_b64_tr_b16 v[220:221], v2 offset:58272
    v_mfma_f32_16x16x32_bf16 v[188:191], v[204:207], v[236:239], v[188:191]
    ds_read_b64_tr_b16 v[222:223], v2 offset:58784
    s_waitcnt lgkmcnt(14)
    s_waitcnt lgkmcnt(12)
    v_mfma_f32_16x16x32_bf16 v[128:131], v[208:211], v[240:243], v[128:131]
    ds_read_b64_tr_b16 v[192:193], v3 offset:54016
    s_waitcnt lgkmcnt(11)
    v_mfma_f32_16x16x32_bf16 v[132:135], v[208:211], v[244:247], v[132:135]
    ds_read_b64_tr_b16 v[194:195], v3 offset:54528
    s_waitcnt lgkmcnt(10)
    v_mfma_f32_16x16x32_bf16 v[144:147], v[212:215], v[240:243], v[144:147]
    ds_read_b64_tr_b16 v[224:225], v10 offset:45568
    v_mfma_f32_16x16x32_bf16 v[148:151], v[212:215], v[244:247], v[148:151]
    ds_read_b64_tr_b16 v[226:227], v10 offset:46080
    s_waitcnt lgkmcnt(10)
    v_mfma_f32_16x16x32_bf16 v[136:139], v[208:211], v[248:251], v[136:139]
    ds_read_b64_tr_b16 v[228:229], v10 offset:45600
    v_mfma_f32_16x16x32_bf16 v[152:155], v[212:215], v[248:251], v[152:155]
    ds_read_b64_tr_b16 v[230:231], v10 offset:46112
    s_waitcnt lgkmcnt(10)
    v_mfma_f32_16x16x32_bf16 v[160:163], v[216:219], v[240:243], v[160:163]
    ds_read_b64_tr_b16 v[196:197], v3 offset:54048
    v_mfma_f32_16x16x32_bf16 v[164:167], v[216:219], v[244:247], v[164:167]
    ds_read_b64_tr_b16 v[198:199], v3 offset:54560
    v_mfma_f32_16x16x32_bf16 v[168:171], v[216:219], v[248:251], v[168:171]
    ds_read_b64_tr_b16 v[232:233], v10 offset:45632
    s_waitcnt lgkmcnt(11)
    v_mfma_f32_16x16x32_bf16 v[140:143], v[208:211], v[252:255], v[140:143]
    ds_read_b64_tr_b16 v[234:235], v10 offset:46144
    v_mfma_f32_16x16x32_bf16 v[156:159], v[212:215], v[252:255], v[156:159]
    ds_read_b64_tr_b16 v[200:201], v3 offset:58240
    v_mfma_f32_16x16x32_bf16 v[172:175], v[216:219], v[252:255], v[172:175]
    ds_read_b64_tr_b16 v[202:203], v3 offset:58752
    s_waitcnt lgkmcnt(12)
    v_mfma_f32_16x16x32_bf16 v[176:179], v[220:223], v[240:243], v[176:179]
    ds_read_b64_tr_b16 v[236:237], v10 offset:45664
    v_mfma_f32_16x16x32_bf16 v[180:183], v[220:223], v[244:247], v[180:183]
    ds_read_b64_tr_b16 v[238:239], v10 offset:46176
    v_mfma_f32_16x16x32_bf16 v[184:187], v[220:223], v[248:251], v[184:187]
    ds_read_b64_tr_b16 v[204:205], v3 offset:58272
    v_mfma_f32_16x16x32_bf16 v[188:191], v[220:223], v[252:255], v[188:191]
    ds_read_b64_tr_b16 v[206:207], v3 offset:58784
    s_barrier
    s_waitcnt lgkmcnt(14)
    s_waitcnt lgkmcnt(12)
    v_mfma_f32_16x16x32_bf16 v[128:131], v[192:195], v[224:227], v[128:131]
    ds_read_b64_tr_b16 v[208:209], v3 offset:20224
    s_waitcnt lgkmcnt(11)
    v_mfma_f32_16x16x32_bf16 v[132:135], v[192:195], v[228:231], v[132:135]
    ds_read_b64_tr_b16 v[210:211], v3 offset:20736
    s_waitcnt lgkmcnt(10)
    v_mfma_f32_16x16x32_bf16 v[144:147], v[196:199], v[224:227], v[144:147]
    ds_read_b64_tr_b16 v[240:241], v10 offset:11776
    v_mfma_f32_16x16x32_bf16 v[148:151], v[196:199], v[228:231], v[148:151]
    ds_read_b64_tr_b16 v[242:243], v10 offset:12288
    s_waitcnt lgkmcnt(10)
    v_mfma_f32_16x16x32_bf16 v[136:139], v[192:195], v[232:235], v[136:139]
    ds_read_b64_tr_b16 v[244:245], v10 offset:11808
    v_mfma_f32_16x16x32_bf16 v[152:155], v[196:199], v[232:235], v[152:155]
    ds_read_b64_tr_b16 v[246:247], v10 offset:12320
    s_waitcnt lgkmcnt(10)
    v_mfma_f32_16x16x32_bf16 v[160:163], v[200:203], v[224:227], v[160:163]
    ds_read_b64_tr_b16 v[212:213], v3 offset:20256
    v_mfma_f32_16x16x32_bf16 v[164:167], v[200:203], v[228:231], v[164:167]
    ds_read_b64_tr_b16 v[214:215], v3 offset:20768
    v_mfma_f32_16x16x32_bf16 v[168:171], v[200:203], v[232:235], v[168:171]
    ds_read_b64_tr_b16 v[248:249], v10 offset:11840
    s_waitcnt lgkmcnt(11)
    v_mfma_f32_16x16x32_bf16 v[140:143], v[192:195], v[236:239], v[140:143]
KMPG26:
    s_cbranch_execz KMPG34
    ds_read_b64_tr_b16 v[250:251], v10 offset:12352
    v_mfma_f32_16x16x32_bf16 v[156:159], v[196:199], v[236:239], v[156:159]
    ds_read_b64_tr_b16 v[216:217], v3 offset:24448
    v_mfma_f32_16x16x32_bf16 v[172:175], v[200:203], v[236:239], v[172:175]
    ds_read_b64_tr_b16 v[218:219], v3 offset:24960
    s_waitcnt lgkmcnt(12)
    v_mfma_f32_16x16x32_bf16 v[176:179], v[204:207], v[224:227], v[176:179]
    ds_read_b64_tr_b16 v[252:253], v10 offset:11872
    v_mfma_f32_16x16x32_bf16 v[180:183], v[204:207], v[228:231], v[180:183]
    ds_read_b64_tr_b16 v[254:255], v10 offset:12384
    v_mfma_f32_16x16x32_bf16 v[184:187], v[204:207], v[232:235], v[184:187]
    ds_read_b64_tr_b16 v[220:221], v3 offset:24480
    v_mfma_f32_16x16x32_bf16 v[188:191], v[204:207], v[236:239], v[188:191]
    ds_read_b64_tr_b16 v[222:223], v3 offset:24992
    s_waitcnt vmcnt(0)
    s_mov_b64 exec, 1
    buffer_store_dword v15, v14, s[24:27], s63 offen sc1
    s_mov_b64 exec, -1
    s_waitcnt lgkmcnt(14)
    s_waitcnt lgkmcnt(12)
    v_mfma_f32_16x16x32_bf16 v[128:131], v[208:211], v[240:243], v[128:131]
    ds_read_b64_tr_b16 v[192:193], v2 offset:20224
    s_waitcnt lgkmcnt(11)
    v_mfma_f32_16x16x32_bf16 v[132:135], v[208:211], v[244:247], v[132:135]
    ds_read_b64_tr_b16 v[194:195], v2 offset:20736
    s_waitcnt lgkmcnt(10)
    v_mfma_f32_16x16x32_bf16 v[144:147], v[212:215], v[240:243], v[144:147]
    ds_read_b64_tr_b16 v[224:225], v9 offset:11776
    v_mfma_f32_16x16x32_bf16 v[148:151], v[212:215], v[244:247], v[148:151]
    ds_read_b64_tr_b16 v[226:227], v9 offset:12288
    s_waitcnt lgkmcnt(10)
    v_mfma_f32_16x16x32_bf16 v[136:139], v[208:211], v[248:251], v[136:139]
    ds_read_b64_tr_b16 v[228:229], v9 offset:11808
    v_mfma_f32_16x16x32_bf16 v[152:155], v[212:215], v[248:251], v[152:155]
    ds_read_b64_tr_b16 v[230:231], v9 offset:12320
    s_waitcnt lgkmcnt(10)
    v_mfma_f32_16x16x32_bf16 v[160:163], v[216:219], v[240:243], v[160:163]
    ds_read_b64_tr_b16 v[196:197], v2 offset:20256
    v_mfma_f32_16x16x32_bf16 v[164:167], v[216:219], v[244:247], v[164:167]
    ds_read_b64_tr_b16 v[198:199], v2 offset:20768
    v_mfma_f32_16x16x32_bf16 v[168:171], v[216:219], v[248:251], v[168:171]
    ds_read_b64_tr_b16 v[232:233], v9 offset:11840
    s_waitcnt lgkmcnt(11)
    v_mfma_f32_16x16x32_bf16 v[140:143], v[208:211], v[252:255], v[140:143]
    ds_read_b64_tr_b16 v[234:235], v9 offset:12352
    v_mfma_f32_16x16x32_bf16 v[156:159], v[212:215], v[252:255], v[156:159]
    ds_read_b64_tr_b16 v[200:201], v2 offset:24448
    v_mfma_f32_16x16x32_bf16 v[172:175], v[216:219], v[252:255], v[172:175]
    ds_read_b64_tr_b16 v[202:203], v2 offset:24960
    s_waitcnt lgkmcnt(12)
    v_mfma_f32_16x16x32_bf16 v[176:179], v[220:223], v[240:243], v[176:179]
    ds_read_b64_tr_b16 v[236:237], v9 offset:11872
    v_mfma_f32_16x16x32_bf16 v[180:183], v[220:223], v[244:247], v[180:183]
    ds_read_b64_tr_b16 v[238:239], v9 offset:12384
    v_mfma_f32_16x16x32_bf16 v[184:187], v[220:223], v[248:251], v[184:187]
    ds_read_b64_tr_b16 v[204:205], v2 offset:24480
    v_mfma_f32_16x16x32_bf16 v[188:191], v[220:223], v[252:255], v[188:191]
    ds_read_b64_tr_b16 v[206:207], v2 offset:24992
    s_barrier
    s_waitcnt lgkmcnt(14)
    s_waitcnt lgkmcnt(12)
    v_mfma_f32_16x16x32_bf16 v[128:131], v[192:195], v[224:227], v[128:131]
    ds_read_b64_tr_b16 v[208:209], v2 offset:37120
    s_waitcnt lgkmcnt(11)
    v_mfma_f32_16x16x32_bf16 v[132:135], v[192:195], v[228:231], v[132:135]
    ds_read_b64_tr_b16 v[210:211], v2 offset:37632
    s_waitcnt lgkmcnt(10)
    v_mfma_f32_16x16x32_bf16 v[144:147], v[196:199], v[224:227], v[144:147]
    ds_read_b64_tr_b16 v[240:241], v9 offset:28672
    v_mfma_f32_16x16x32_bf16 v[148:151], v[196:199], v[228:231], v[148:151]
    ds_read_b64_tr_b16 v[242:243], v9 offset:29184
    s_waitcnt lgkmcnt(10)
    v_mfma_f32_16x16x32_bf16 v[136:139], v[192:195], v[232:235], v[136:139]
    ds_read_b64_tr_b16 v[244:245], v9 offset:28704
    v_mfma_f32_16x16x32_bf16 v[152:155], v[196:199], v[232:235], v[152:155]
    ds_read_b64_tr_b16 v[246:247], v9 offset:29216
    s_waitcnt lgkmcnt(10)
    v_mfma_f32_16x16x32_bf16 v[160:163], v[200:203], v[224:227], v[160:163]
    ds_read_b64_tr_b16 v[212:213], v2 offset:37152
    v_mfma_f32_16x16x32_bf16 v[164:167], v[200:203], v[228:231], v[164:167]
    ds_read_b64_tr_b16 v[214:215], v2 offset:37664
    v_mfma_f32_16x16x32_bf16 v[168:171], v[200:203], v[232:235], v[168:171]
    ds_read_b64_tr_b16 v[248:249], v9 offset:28736
    s_waitcnt lgkmcnt(11)
    v_mfma_f32_16x16x32_bf16 v[140:143], v[192:195], v[236:239], v[140:143]
    ds_read_b64_tr_b16 v[250:251], v9 offset:29248
    v_mfma_f32_16x16x32_bf16 v[156:159], v[196:199], v[236:239], v[156:159]
    ds_read_b64_tr_b16 v[216:217], v2 offset:41344
    v_mfma_f32_16x16x32_bf16 v[172:175], v[200:203], v[236:239], v[172:175]
    ds_read_b64_tr_b16 v[218:219], v2 offset:41856
    s_waitcnt lgkmcnt(12)
    v_mfma_f32_16x16x32_bf16 v[176:179], v[204:207], v[224:227], v[176:179]
    ds_read_b64_tr_b16 v[252:253], v9 offset:28768
    v_mfma_f32_16x16x32_bf16 v[180:183], v[204:207], v[228:231], v[180:183]
    ds_read_b64_tr_b16 v[254:255], v9 offset:29280
    v_mfma_f32_16x16x32_bf16 v[184:187], v[204:207], v[232:235], v[184:187]
    ds_read_b64_tr_b16 v[220:221], v2 offset:41376
    v_mfma_f32_16x16x32_bf16 v[188:191], v[204:207], v[236:239], v[188:191]
    ds_read_b64_tr_b16 v[222:223], v2 offset:41888
    s_waitcnt lgkmcnt(14)
    s_waitcnt lgkmcnt(12)
    v_mfma_f32_16x16x32_bf16 v[128:131], v[208:211], v[240:243], v[128:131]
    ds_read_b64_tr_b16 v[192:193], v4 offset:20224
    s_waitcnt lgkmcnt(11)
    v_mfma_f32_16x16x32_bf16 v[132:135], v[208:211], v[244:247], v[132:135]
    ds_read_b64_tr_b16 v[194:195], v4 offset:20736
    s_waitcnt lgkmcnt(10)
    v_mfma_f32_16x16x32_bf16 v[144:147], v[212:215], v[240:243], v[144:147]
    ds_read_b64_tr_b16 v[224:225], v11 offset:11776
    v_mfma_f32_16x16x32_bf16 v[148:151], v[212:215], v[244:247], v[148:151]
    ds_read_b64_tr_b16 v[226:227], v11 offset:12288
    s_waitcnt lgkmcnt(10)
    v_mfma_f32_16x16x32_bf16 v[136:139], v[208:211], v[248:251], v[136:139]
    ds_read_b64_tr_b16 v[228:229], v11 offset:11808
    v_mfma_f32_16x16x32_bf16 v[152:155], v[212:215], v[248:251], v[152:155]
    ds_read_b64_tr_b16 v[230:231], v11 offset:12320
    s_waitcnt lgkmcnt(10)
    v_mfma_f32_16x16x32_bf16 v[160:163], v[216:219], v[240:243], v[160:163]
    ds_read_b64_tr_b16 v[196:197], v4 offset:20256
    v_mfma_f32_16x16x32_bf16 v[164:167], v[216:219], v[244:247], v[164:167]
    ds_read_b64_tr_b16 v[198:199], v4 offset:20768
    v_mfma_f32_16x16x32_bf16 v[168:171], v[216:219], v[248:251], v[168:171]
    ds_read_b64_tr_b16 v[232:233], v11 offset:11840
    s_waitcnt lgkmcnt(11)
    v_mfma_f32_16x16x32_bf16 v[140:143], v[208:211], v[252:255], v[140:143]
    ds_read_b64_tr_b16 v[234:235], v11 offset:12352
    v_mfma_f32_16x16x32_bf16 v[156:159], v[212:215], v[252:255], v[156:159]
    ds_read_b64_tr_b16 v[200:201], v4 offset:24448
    v_mfma_f32_16x16x32_bf16 v[172:175], v[216:219], v[252:255], v[172:175]
    ds_read_b64_tr_b16 v[202:203], v4 offset:24960
    s_waitcnt lgkmcnt(12)
    v_mfma_f32_16x16x32_bf16 v[176:179], v[220:223], v[240:243], v[176:179]
    ds_read_b64_tr_b16 v[236:237], v11 offset:11872
    v_mfma_f32_16x16x32_bf16 v[180:183], v[220:223], v[244:247], v[180:183]
    ds_read_b64_tr_b16 v[238:239], v11 offset:12384
    v_mfma_f32_16x16x32_bf16 v[184:187], v[220:223], v[248:251], v[184:187]
    ds_read_b64_tr_b16 v[204:205], v4 offset:24480
    v_mfma_f32_16x16x32_bf16 v[188:191], v[220:223], v[252:255], v[188:191]
    ds_read_b64_tr_b16 v[206:207], v4 offset:24992
    s_barrier
    s_waitcnt lgkmcnt(14)
    s_waitcnt lgkmcnt(12)
    v_mfma_f32_16x16x32_bf16 v[128:131], v[192:195], v[224:227], v[128:131]
KMPG27:
    s_cbranch_execz KMPG35
    ds_read_b64_tr_b16 v[208:209], v4 offset:37120
    ds_read_b128 v[24:27], v12 offset:9216
    s_waitcnt lgkmcnt(12)
    v_mfma_f32_16x16x32_bf16 v[132:135], v[192:195], v[228:231], v[132:135]
    ds_read_b64_tr_b16 v[210:211], v4 offset:37632
    ds_read_b128 v[28:31], v12 offset:9472
    s_waitcnt lgkmcnt(12)
    v_mfma_f32_16x16x32_bf16 v[144:147], v[196:199], v[224:227], v[144:147]
    ds_read_b64_tr_b16 v[240:241], v11 offset:28672
    ds_read_b128 v[32:35], v12 offset:9728
    v_mfma_f32_16x16x32_bf16 v[148:151], v[196:199], v[228:231], v[148:151]
    ds_read_b64_tr_b16 v[242:243], v11 offset:29184
    ds_read_b128 v[36:39], v12 offset:9984
    s_waitcnt lgkmcnt(14)
    v_mfma_f32_16x16x32_bf16 v[136:139], v[192:195], v[232:235], v[136:139]
    ds_read_b64_tr_b16 v[244:245], v11 offset:28704
    ds_read_b128 v[40:43], v12 offset:9280
    v_mfma_f32_16x16x32_bf16 v[152:155], v[196:199], v[232:235], v[152:155]
    ds_read_b64_tr_b16 v[246:247], v11 offset:29216
    ds_read_b128 v[44:47], v12 offset:9536
    s_waitcnt lgkmcnt(15)
    v_mfma_f32_16x16x32_bf16 v[160:163], v[200:203], v[224:227], v[160:163]
    ds_read_b64_tr_b16 v[212:213], v4 offset:37152
    ds_read_b128 v[48:51], v12 offset:9792
    v_mfma_f32_16x16x32_bf16 v[164:167], v[200:203], v[228:231], v[164:167]
    ds_read_b64_tr_b16 v[214:215], v4 offset:37664
    ds_read_b128 v[52:55], v12 offset:10048
    v_mfma_f32_16x16x32_bf16 v[168:171], v[200:203], v[232:235], v[168:171]
    ds_read_b64_tr_b16 v[248:249], v11 offset:28736
    s_waitcnt lgkmcnt(15)
    v_mfma_f32_16x16x32_bf16 v[140:143], v[192:195], v[236:239], v[140:143]
    ds_read_b64_tr_b16 v[250:251], v11 offset:29248
    v_mfma_f32_16x16x32_bf16 v[156:159], v[196:199], v[236:239], v[156:159]
    ds_read_b64_tr_b16 v[216:217], v4 offset:41344
    v_mfma_f32_16x16x32_bf16 v[172:175], v[200:203], v[236:239], v[172:175]
    ds_read_b64_tr_b16 v[218:219], v4 offset:41856
    v_mfma_f32_16x16x32_bf16 v[176:179], v[204:207], v[224:227], v[176:179]
    ds_read_b64_tr_b16 v[252:253], v11 offset:28768
    v_mfma_f32_16x16x32_bf16 v[180:183], v[204:207], v[228:231], v[180:183]
    ds_read_b64_tr_b16 v[254:255], v11 offset:29280
    v_mfma_f32_16x16x32_bf16 v[184:187], v[204:207], v[232:235], v[184:187]
    ds_read_b64_tr_b16 v[220:221], v4 offset:41376
    v_mfma_f32_16x16x32_bf16 v[188:191], v[204:207], v[236:239], v[188:191]
    ds_read_b64_tr_b16 v[222:223], v4 offset:41888
    s_waitcnt lgkmcnt(15)
    v_mfma_f32_16x16x32_bf16 v[128:131], v[208:211], v[240:243], v[128:131]
    s_waitcnt lgkmcnt(13)
    v_mfma_f32_16x16x32_bf16 v[132:135], v[208:211], v[244:247], v[132:135]
    s_waitcnt lgkmcnt(9)
    v_mfma_f32_16x16x32_bf16 v[144:147], v[212:215], v[240:243], v[144:147]
    v_mfma_f32_16x16x32_bf16 v[148:151], v[212:215], v[244:247], v[148:151]
    s_waitcnt lgkmcnt(6)
    v_mfma_f32_16x16x32_bf16 v[136:139], v[208:211], v[248:251], v[136:139]
    v_mfma_f32_16x16x32_bf16 v[152:155], v[212:215], v[248:251], v[152:155]
    s_waitcnt lgkmcnt(4)
    v_mfma_f32_16x16x32_bf16 v[160:163], v[216:219], v[240:243], v[160:163]
    v_mfma_f32_16x16x32_bf16 v[164:167], v[216:219], v[244:247], v[164:167]
    v_mfma_f32_16x16x32_bf16 v[168:171], v[216:219], v[248:251], v[168:171]
    s_waitcnt lgkmcnt(2)
    v_mfma_f32_16x16x32_bf16 v[140:143], v[208:211], v[252:255], v[140:143]
    v_mfma_f32_16x16x32_bf16 v[156:159], v[212:215], v[252:255], v[156:159]
    v_mfma_f32_16x16x32_bf16 v[172:175], v[216:219], v[252:255], v[172:175]
    s_waitcnt lgkmcnt(0)
    v_mfma_f32_16x16x32_bf16 v[176:179], v[220:223], v[240:243], v[176:179]
    v_mfma_f32_16x16x32_bf16 v[180:183], v[220:223], v[244:247], v[180:183]
    v_mfma_f32_16x16x32_bf16 v[184:187], v[220:223], v[248:251], v[184:187]
    v_mfma_f32_16x16x32_bf16 v[188:191], v[220:223], v[252:255], v[188:191]
    s_setprio 3
    v_pk_fma_f32 v[128:129], v[16:17], v[128:129], v[28:29] op_sel:[1,0,0] op_sel_hi:[1,1,1]
    v_pk_fma_f32 v[130:131], v[16:17], v[130:131], v[30:31] op_sel:[1,0,0] op_sel_hi:[1,1,1]
    v_pk_fma_f32 v[132:133], v[18:19], v[132:133], v[28:29] op_sel:[1,0,0] op_sel_hi:[1,1,1]
    v_pk_fma_f32 v[134:135], v[18:19], v[134:135], v[30:31] op_sel:[1,0,0] op_sel_hi:[1,1,1]
    v_pk_fma_f32 v[144:145], v[16:17], v[144:145], v[44:45] op_sel:[1,0,0] op_sel_hi:[1,1,1]
    v_pk_fma_f32 v[146:147], v[16:17], v[146:147], v[46:47] op_sel:[1,0,0] op_sel_hi:[1,1,1]
    v_pk_fma_f32 v[148:149], v[18:19], v[148:149], v[44:45] op_sel:[1,0,0] op_sel_hi:[1,1,1]
    v_pk_fma_f32 v[150:151], v[18:19], v[150:151], v[46:47] op_sel:[1,0,0] op_sel_hi:[1,1,1]
    v_pk_fma_f32 v[160:161], v[16:17], v[160:161], v[36:37] op_sel:[1,0,0] op_sel_hi:[1,1,1]
    v_pk_fma_f32 v[162:163], v[16:17], v[162:163], v[38:39] op_sel:[1,0,0] op_sel_hi:[1,1,1]
    v_pk_fma_f32 v[164:165], v[18:19], v[164:165], v[36:37] op_sel:[1,0,0] op_sel_hi:[1,1,1]
    v_pk_fma_f32 v[166:167], v[18:19], v[166:167], v[38:39] op_sel:[1,0,0] op_sel_hi:[1,1,1]
    v_pk_fma_f32 v[176:177], v[16:17], v[176:177], v[52:53] op_sel:[1,0,0] op_sel_hi:[1,1,1]
    v_pk_fma_f32 v[178:179], v[16:17], v[178:179], v[54:55] op_sel:[1,0,0] op_sel_hi:[1,1,1]
    v_pk_fma_f32 v[180:181], v[18:19], v[180:181], v[52:53] op_sel:[1,0,0] op_sel_hi:[1,1,1]
    v_pk_fma_f32 v[182:183], v[18:19], v[182:183], v[54:55] op_sel:[1,0,0] op_sel_hi:[1,1,1]
    v_pk_fma_f32 v[128:129], v[16:17], v[24:25], v[128:129] op_sel_hi:[0,1,1]
    v_pk_fma_f32 v[130:131], v[16:17], v[26:27], v[130:131] op_sel_hi:[0,1,1]
    v_pk_fma_f32 v[132:133], v[18:19], v[24:25], v[132:133] op_sel_hi:[0,1,1]
    v_pk_fma_f32 v[134:135], v[18:19], v[26:27], v[134:135] op_sel_hi:[0,1,1]
    v_pk_fma_f32 v[144:145], v[16:17], v[40:41], v[144:145] op_sel_hi:[0,1,1]
    v_pk_fma_f32 v[146:147], v[16:17], v[42:43], v[146:147] op_sel_hi:[0,1,1]
    v_pk_fma_f32 v[148:149], v[18:19], v[40:41], v[148:149] op_sel_hi:[0,1,1]
    v_pk_fma_f32 v[150:151], v[18:19], v[42:43], v[150:151] op_sel_hi:[0,1,1]
    v_pk_fma_f32 v[160:161], v[16:17], v[32:33], v[160:161] op_sel_hi:[0,1,1]
    v_pk_fma_f32 v[162:163], v[16:17], v[34:35], v[162:163] op_sel_hi:[0,1,1]
    v_pk_fma_f32 v[164:165], v[18:19], v[32:33], v[164:165] op_sel_hi:[0,1,1]
    v_pk_fma_f32 v[166:167], v[18:19], v[34:35], v[166:167] op_sel_hi:[0,1,1]
    v_pk_fma_f32 v[176:177], v[16:17], v[48:49], v[176:177] op_sel_hi:[0,1,1]
    v_pk_fma_f32 v[178:179], v[16:17], v[50:51], v[178:179] op_sel_hi:[0,1,1]
    v_pk_fma_f32 v[180:181], v[18:19], v[48:49], v[180:181] op_sel_hi:[0,1,1]
    v_pk_fma_f32 v[182:183], v[18:19], v[50:51], v[182:183] op_sel_hi:[0,1,1]
    v_cvt_pk_bf16_f32 v128, v128, v129
    v_cvt_pk_bf16_f32 v130, v130, v131
    v_cvt_pk_bf16_f32 v132, v132, v133
    v_cvt_pk_bf16_f32 v134, v134, v135
    v_cvt_pk_bf16_f32 v144, v144, v145
    v_cvt_pk_bf16_f32 v146, v146, v147
    v_cvt_pk_bf16_f32 v148, v148, v149
    v_cvt_pk_bf16_f32 v150, v150, v151
    v_cvt_pk_bf16_f32 v160, v160, 0
    v_cvt_pk_bf16_f32 v162, v162, 0
    v_cvt_pk_bf16_f32 v164, v164, 0
    v_cvt_pk_bf16_f32 v166, v166, 0
    v_cvt_pk_bf16_f32 v176, v176, 0
    v_cvt_pk_bf16_f32 v178, v178, 0
    v_cvt_pk_bf16_f32 v180, v180, 0
    v_cvt_pk_bf16_f32 v182, v182, 0
    v_cvt_pk_bf16_f32 v161, 0, v161
    v_cvt_pk_bf16_f32 v163, 0, v163
    v_cvt_pk_bf16_f32 v165, 0, v165
    v_cvt_pk_bf16_f32 v167, 0, v167
    v_cvt_pk_bf16_f32 v177, 0, v177
    v_cvt_pk_bf16_f32 v179, 0, v179
    v_cvt_pk_bf16_f32 v181, 0, v181
    v_cvt_pk_bf16_f32 v183, 0, v183
    v_pk_max_i16 v128, v128, 0
    v_pk_max_i16 v130, v130, 0
    v_pk_max_i16 v132, v132, 0
    v_pk_max_i16 v134, v134, 0
    v_pk_max_i16 v144, v144, 0
    v_pk_max_i16 v146, v146, 0
    v_pk_max_i16 v148, v148, 0
    v_pk_max_i16 v150, v150, 0
    v_dot2_f32_bf16 v160, v128, v160, 0
    v_dot2_f32_bf16 v162, v130, v162, 0
KMPG28:
    s_cbranch_execz KMPG36
    s_nop 0
    v_dot2_f32_bf16 v164, v132, v164, 0
    v_dot2_f32_bf16 v166, v134, v166, 0
    v_dot2_f32_bf16 v176, v144, v176, 0
    v_dot2_f32_bf16 v178, v146, v178, 0
    v_dot2_f32_bf16 v180, v148, v180, 0
    v_dot2_f32_bf16 v182, v150, v182, 0
    v_dot2_f32_bf16 v161, v128, v161, 0
    v_dot2_f32_bf16 v163, v130, v163, 0
    v_dot2_f32_bf16 v165, v132, v165, 0
    v_dot2_f32_bf16 v167, v134, v167, 0
    v_dot2_f32_bf16 v177, v144, v177, 0
    v_dot2_f32_bf16 v179, v146, v179, 0
    v_dot2_f32_bf16 v181, v148, v181, 0
    v_dot2_f32_bf16 v183, v150, v183, 0
    v_cvt_pk_bf16_f32 v128, v160, v161
    v_cvt_pk_bf16_f32 v129, v162, v163
    v_cvt_pk_bf16_f32 v132, v164, v165
    v_cvt_pk_bf16_f32 v133, v166, v167
    v_cvt_pk_bf16_f32 v130, v176, v177
    v_cvt_pk_bf16_f32 v131, v178, v179
    v_cvt_pk_bf16_f32 v134, v180, v181
    v_cvt_pk_bf16_f32 v135, v182, v183
    buffer_store_dwordx4 v[128:131], v6, s[24:27], s21 offen offset:0 sc1
    buffer_store_dwordx4 v[132:135], v6, s[24:27], s21 offen offset:1024 sc1
    v_pk_fma_f32 v[136:137], v[20:21], v[136:137], v[28:29] op_sel:[1,0,0] op_sel_hi:[1,1,1]
    v_pk_fma_f32 v[138:139], v[20:21], v[138:139], v[30:31] op_sel:[1,0,0] op_sel_hi:[1,1,1]
    v_pk_fma_f32 v[140:141], v[22:23], v[140:141], v[28:29] op_sel:[1,0,0] op_sel_hi:[1,1,1]
    v_pk_fma_f32 v[142:143], v[22:23], v[142:143], v[30:31] op_sel:[1,0,0] op_sel_hi:[1,1,1]
    v_pk_fma_f32 v[152:153], v[20:21], v[152:153], v[44:45] op_sel:[1,0,0] op_sel_hi:[1,1,1]
    v_pk_fma_f32 v[154:155], v[20:21], v[154:155], v[46:47] op_sel:[1,0,0] op_sel_hi:[1,1,1]
    v_pk_fma_f32 v[156:157], v[22:23], v[156:157], v[44:45] op_sel:[1,0,0] op_sel_hi:[1,1,1]
    v_pk_fma_f32 v[158:159], v[22:23], v[158:159], v[46:47] op_sel:[1,0,0] op_sel_hi:[1,1,1]
    v_pk_fma_f32 v[168:169], v[20:21], v[168:169], v[36:37] op_sel:[1,0,0] op_sel_hi:[1,1,1]
    v_pk_fma_f32 v[170:171], v[20:21], v[170:171], v[38:39] op_sel:[1,0,0] op_sel_hi:[1,1,1]
    v_pk_fma_f32 v[172:173], v[22:23], v[172:173], v[36:37] op_sel:[1,0,0] op_sel_hi:[1,1,1]
    v_pk_fma_f32 v[174:175], v[22:23], v[174:175], v[38:39] op_sel:[1,0,0] op_sel_hi:[1,1,1]
    v_pk_fma_f32 v[184:185], v[20:21], v[184:185], v[52:53] op_sel:[1,0,0] op_sel_hi:[1,1,1]
    v_pk_fma_f32 v[186:187], v[20:21], v[186:187], v[54:55] op_sel:[1,0,0] op_sel_hi:[1,1,1]
    v_pk_fma_f32 v[188:189], v[22:23], v[188:189], v[52:53] op_sel:[1,0,0] op_sel_hi:[1,1,1]
    v_pk_fma_f32 v[190:191], v[22:23], v[190:191], v[54:55] op_sel:[1,0,0] op_sel_hi:[1,1,1]
    v_pk_fma_f32 v[136:137], v[20:21], v[24:25], v[136:137] op_sel_hi:[0,1,1]
    v_pk_fma_f32 v[138:139], v[20:21], v[26:27], v[138:139] op_sel_hi:[0,1,1]
    v_pk_fma_f32 v[140:141], v[22:23], v[24:25], v[140:141] op_sel_hi:[0,1,1]
    v_pk_fma_f32 v[142:143], v[22:23], v[26:27], v[142:143] op_sel_hi:[0,1,1]
    v_pk_fma_f32 v[152:153], v[20:21], v[40:41], v[152:153] op_sel_hi:[0,1,1]
    v_pk_fma_f32 v[154:155], v[20:21], v[42:43], v[154:155] op_sel_hi:[0,1,1]
    v_pk_fma_f32 v[156:157], v[22:23], v[40:41], v[156:157] op_sel_hi:[0,1,1]
    v_pk_fma_f32 v[158:159], v[22:23], v[42:43], v[158:159] op_sel_hi:[0,1,1]
    v_pk_fma_f32 v[168:169], v[20:21], v[32:33], v[168:169] op_sel_hi:[0,1,1]
    v_pk_fma_f32 v[170:171], v[20:21], v[34:35], v[170:171] op_sel_hi:[0,1,1]
    v_pk_fma_f32 v[172:173], v[22:23], v[32:33], v[172:173] op_sel_hi:[0,1,1]
    v_pk_fma_f32 v[174:175], v[22:23], v[34:35], v[174:175] op_sel_hi:[0,1,1]
    v_pk_fma_f32 v[184:185], v[20:21], v[48:49], v[184:185] op_sel_hi:[0,1,1]
    v_pk_fma_f32 v[186:187], v[20:21], v[50:51], v[186:187] op_sel_hi:[0,1,1]
    v_pk_fma_f32 v[188:189], v[22:23], v[48:49], v[188:189] op_sel_hi:[0,1,1]
    v_pk_fma_f32 v[190:191], v[22:23], v[50:51], v[190:191] op_sel_hi:[0,1,1]
    v_cvt_pk_bf16_f32 v136, v136, v137
    v_cvt_pk_bf16_f32 v138, v138, v139
    v_cvt_pk_bf16_f32 v140, v140, v141
    v_cvt_pk_bf16_f32 v142, v142, v143
    v_cvt_pk_bf16_f32 v152, v152, v153
    v_cvt_pk_bf16_f32 v154, v154, v155
    v_cvt_pk_bf16_f32 v156, v156, v157
    v_cvt_pk_bf16_f32 v158, v158, v159
    v_cvt_pk_bf16_f32 v168, v168, 0
    v_cvt_pk_bf16_f32 v170, v170, 0
    v_cvt_pk_bf16_f32 v172, v172, 0
    v_cvt_pk_bf16_f32 v174, v174, 0
    v_cvt_pk_bf16_f32 v184, v184, 0
    v_cvt_pk_bf16_f32 v186, v186, 0
    v_cvt_pk_bf16_f32 v188, v188, 0
    v_cvt_pk_bf16_f32 v190, v190, 0
    v_cvt_pk_bf16_f32 v169, 0, v169
    v_cvt_pk_bf16_f32 v171, 0, v171
    v_cvt_pk_bf16_f32 v173, 0, v173
    v_cvt_pk_bf16_f32 v175, 0, v175
    v_cvt_pk_bf16_f32 v185, 0, v185
    v_cvt_pk_bf16_f32 v187, 0, v187
    v_cvt_pk_bf16_f32 v189, 0, v189
    v_cvt_pk_bf16_f32 v191, 0, v191
    v_pk_max_i16 v136, v136, 0
    v_pk_max_i16 v138, v138, 0
    v_pk_max_i16 v140, v140, 0
    v_pk_max_i16 v142, v142, 0
    v_pk_max_i16 v152, v152, 0
    v_pk_max_i16 v154, v154, 0
    v_pk_max_i16 v156, v156, 0
    v_pk_max_i16 v158, v158, 0
    v_dot2_f32_bf16 v168, v136, v168, 0
    v_dot2_f32_bf16 v170, v138, v170, 0
    v_dot2_f32_bf16 v172, v140, v172, 0
    v_dot2_f32_bf16 v174, v142, v174, 0
    v_dot2_f32_bf16 v184, v152, v184, 0
    v_dot2_f32_bf16 v186, v154, v186, 0
    v_dot2_f32_bf16 v188, v156, v188, 0
    v_dot2_f32_bf16 v190, v158, v190, 0
    v_dot2_f32_bf16 v169, v136, v169, 0
    v_dot2_f32_bf16 v171, v138, v171, 0
    v_dot2_f32_bf16 v173, v140, v173, 0
    v_dot2_f32_bf16 v175, v142, v175, 0
    v_dot2_f32_bf16 v185, v152, v185, 0
    v_dot2_f32_bf16 v187, v154, v187, 0
    v_dot2_f32_bf16 v189, v156, v189, 0
    v_dot2_f32_bf16 v191, v158, v191, 0
    v_cvt_pk_bf16_f32 v136, v168, v169
    v_cvt_pk_bf16_f32 v137, v170, v171
    v_cvt_pk_bf16_f32 v140, v172, v173
    v_cvt_pk_bf16_f32 v141, v174, v175
    v_cvt_pk_bf16_f32 v138, v184, v185
    v_cvt_pk_bf16_f32 v139, v186, v187
    v_cvt_pk_bf16_f32 v142, v188, v189
    v_cvt_pk_bf16_f32 v143, v190, v191
    buffer_store_dwordx4 v[136:139], v6, s[24:27], s21 offen offset:2048 sc1
    buffer_store_dwordx4 v[140:143], v6, s[24:27], s21 offen offset:3072 sc1
    s_mul_i32 s17, s15, 4224
    v_add_u32_e64 v2, s17, v5
    v_add_u32 v3, 50688, v2
    v_add_u32 v4, 101376, v2
    s_lshl_b32 s36, s13, 1
    s_add_u32 s36, s36, s35
    s_lshl_b32 s36, s36, 1
    s_add_u32 s36, s36, 1
    s_mul_i32 s37, s15, 7
    s_mul_i32 s61, s36, 4224
    s_mul_i32 s39, s37, 128
    s_add_u32 s61, s61, s39
    s_add_u32 s61, s61, 27262976
    s_mul_i32 s36, s36, 28
    s_add_u32 s36, s36, s37
    s_lshl_b32 s36, s36, 12
    s_add_u32 s60, s36, 16777216
    v_mul_u32_u24 v15, 128, v1
KMPG29:
    s_cbranch_execz KMPG37
    s_add_u32 s4, s60, 0
    s_add_u32 s5, s60, 4096
    s_add_u32 s6, s60, 8192
    s_add_u32 s7, s60, 12288
    s_add_u32 s0, s60, 16384
    s_add_u32 s1, s60, 20480
    s_add_u32 s3, s60, 24576
    s_add_u32 s36, s33, 0
    s_and_b32 s36, s36, 3
    s_lshl_b32 s36, s36, 10
    v_add_u32 v9, s36, v6
    s_add_u32 s36, s33, 1
    s_and_b32 s36, s36, 3
    s_lshl_b32 s36, s36, 10
    v_add_u32 v10, s36, v6
    s_add_u32 s36, s33, 2
    s_and_b32 s36, s36, 3
    s_lshl_b32 s36, s36, 10
    v_add_u32 v11, s36, v6
    s_add_u32 s36, s33, 3
    s_and_b32 s36, s36, 3
    s_lshl_b32 s36, s36, 10
    v_add_u32 v12, s36, v6
    v_mov_b32 v17, 1
    s_waitcnt vmcnt(0)
    s_mov_b64 exec, 1
    buffer_store_dword v17, v14, s[24:27], s66 offen sc1
    s_mov_b64 exec, -1
    s_branch KM_CT
SV_C:
    v_lshlrev_b32 v20, 2, v0
    s_lshl_b32 s36, s32, 10
    s_add_u32 s36, s36, 25237504
    s_mov_b32 s37, s36
    buffer_load_dword v21, v20, s[24:27], s37 offen
    buffer_load_dword v22, v20, s[24:27], s37 offen offset:2048
    s_add_u32 s36, s22, 344064
    s_add_u32 m0, s23, 79360
    s_nop 0
    buffer_load_dwordx4 v12, s[44:47], s36 offen lds
    s_add_u32 m0, s23, 83584
    s_nop 0
    buffer_load_dwordx4 v12, s[48:51], s36 offen lds
    s_add_u32 s36, s22, 344192
    s_add_u32 m0, s23, 87808
    s_nop 0
    buffer_load_dwordx4 v12, s[44:47], s36 offen lds
    s_add_u32 m0, s23, 92032
    s_nop 0
    buffer_load_dwordx4 v12, s[48:51], s36 offen lds
    s_add_u32 s36, s22, 458752
    s_add_u32 m0, s23, 96256
    s_nop 0
    buffer_load_dwordx4 v12, s[44:47], s36 offen lds
    s_add_u32 m0, s23, 100480
    s_nop 0
    buffer_load_dwordx4 v12, s[48:51], s36 offen lds
    s_add_u32 s36, s22, 458880
    s_add_u32 m0, s23, 104704
    s_nop 0
    buffer_load_dwordx4 v12, s[44:47], s36 offen lds
    s_add_u32 m0, s23, 108928
    s_nop 0
    buffer_load_dwordx4 v12, s[48:51], s36 offen lds
    s_waitcnt lgkmcnt(0)
    s_mov_b64 exec, 0
    s_cmp_lg_u32 s15, 0
    s_cbranch_scc1 TCHcs0
    s_call_b64 s[68:69], KMPG1
TCHcs0:
    s_cmp_lg_u32 s15, 1
    s_cbranch_scc1 TCHcs1
    s_call_b64 s[68:69], KMPG2
TCHcs1:
    s_cmp_lg_u32 s15, 2
    s_cbranch_scc1 TCHcs2
    s_call_b64 s[68:69], KMPG3
TCHcs2:
    s_cmp_lg_u32 s15, 3
    s_cbranch_scc1 TCHcs3
    s_call_b64 s[68:69], KMPG4
TCHcs3:
    s_mov_b64 exec, -1
    v_readfirstlane_b32 s68, v0
    s_waitcnt lgkmcnt(0)
    s_mov_b64 exec, 0
    s_cmp_lg_u32 s15, 0
    s_nop 1
    s_cbranch_scc1 TCHas0
    s_call_b64 s[68:69], KMPG5
TCHas0:
    s_cmp_lg_u32 s15, 1
    s_cbranch_scc1 TCHas1
    s_call_b64 s[68:69], KMPG6
TCHas1:
    s_cmp_lg_u32 s15, 2
    s_cbranch_scc1 TCHas2
    s_call_b64 s[68:69], KMPG7
TCHas2:
    s_cmp_lg_u32 s15, 3
    s_cbranch_scc1 TCHas3
    s_call_b64 s[68:69], KMPG8
TCHas3:
    s_mov_b64 exec, -1
    v_readfirstlane_b32 s68, v0
    v_and_b32_e64 v23, 7, v0
    v_mul_u32_u24 v23, 1056, v23
    v_bfe_u32 v24, v0, 3, 2
    v_lshl_add_u32 v23, v24, 8, v23
    v_lshrrev_b32_e64 v24, 5, v0
    v_lshl_add_u32 v23, v24, 5, v23
    v_mov_b32 v24, 0
    v_mov_b32 v25, 0
    v_mov_b32 v26, 0
    v_mov_b32 v27, 0
    v_mov_b32 v28, 0
    v_mov_b32 v29, 0
    v_mov_b32 v30, 0
    v_mov_b32 v31, 0
    ds_write_b128 v23, v[28:31] offset:16
    s_mul_i32 s36, s15, 4224
    v_add_u32_e64 v2, s36, v5
    v_add_u32 v3, 50688, v2
    v_add_u32 v4, 101376, v2
    ds_read_b64_tr_b16 v[192:193], v4 offset:11776
    ds_read_b64_tr_b16 v[194:195], v4 offset:12288
    ds_read_b64_tr_b16 v[196:197], v4 offset:11808
    ds_read_b64_tr_b16 v[198:199], v4 offset:12320
    ds_read_b64_tr_b16 v[200:201], v4 offset:11840
    ds_read_b64_tr_b16 v[202:203], v4 offset:12352
    ds_read_b64_tr_b16 v[204:205], v4 offset:11872
    ds_read_b64_tr_b16 v[206:207], v4 offset:12384
    ds_read_b64_tr_b16 v[208:209], v4 offset:28672
    ds_read_b64_tr_b16 v[210:211], v4 offset:29184
    ds_read_b64_tr_b16 v[212:213], v4 offset:28704
    ds_read_b64_tr_b16 v[214:215], v4 offset:29216
    ds_read_b64_tr_b16 v[216:217], v4 offset:28736
    ds_read_b64_tr_b16 v[218:219], v4 offset:29248
    ds_read_b64_tr_b16 v[220:221], v4 offset:28768
    ds_read_b64_tr_b16 v[222:223], v4 offset:29280
    ds_read_b64_tr_b16 v[224:225], v4 offset:45568
    ds_read_b64_tr_b16 v[226:227], v4 offset:46080
    ds_read_b64_tr_b16 v[228:229], v4 offset:45600
    ds_read_b64_tr_b16 v[230:231], v4 offset:46112
    ds_read_b64_tr_b16 v[232:233], v4 offset:45632
    ds_read_b64_tr_b16 v[234:235], v4 offset:46144
    ds_read_b64_tr_b16 v[236:237], v4 offset:45664
    ds_read_b64_tr_b16 v[238:239], v4 offset:46176
    s_waitcnt vmcnt(8)
    v_add_f32 v22, 1.0, v22
    v_cvt_pk_bf16_f32 v24, v22, v21
    ds_write_b128 v23, v[24:27] offset:0
    s_waitcnt lgkmcnt(0)
    s_barrier
    s_add_u32 s36, s22, 573440
    s_add_u32 m0, s23, 113152
    s_nop 0
    buffer_load_dwordx4 v12, s[44:47], s36 offen lds
    s_add_u32 m0, s23, 117376
    s_nop 0
    buffer_load_dwordx4 v12, s[48:51], s36 offen lds
    s_add_u32 s36, s22, 573568
    s_add_u32 m0, s23, 121600
    s_nop 0
    buffer_load_dwordx4 v12, s[44:47], s36 offen lds
    s_add_u32 m0, s23, 125824
    s_nop 0
    buffer_load_dwordx4 v12, s[48:51], s36 offen lds
    s_add_u32 s36, s22, 688128
    s_add_u32 m0, s23, 130048
    s_nop 0
    buffer_load_dwordx4 v12, s[44:47], s36 offen lds
    s_add_u32 m0, s23, 134272
    s_nop 0
    buffer_load_dwordx4 v12, s[48:51], s36 offen lds
    s_add_u32 s36, s22, 688256
    s_add_u32 m0, s23, 138496
    s_nop 0
    buffer_load_dwordx4 v12, s[44:47], s36 offen lds
KMPG30:
    s_cbranch_execz KMPG38
    s_add_u32 m0, s23, 142720
    s_nop 0
    buffer_load_dwordx4 v12, s[48:51], s36 offen lds
    s_add_u32 s36, s22, 802816
    s_add_u32 m0, s23, 146944
    s_nop 0
    buffer_load_dwordx4 v12, s[44:47], s36 offen lds
    s_add_u32 m0, s23, 151168
    s_nop 0
    buffer_load_dwordx4 v12, s[48:51], s36 offen lds
    s_add_u32 s36, s22, 802944
    s_add_u32 m0, s23, 155392
    s_nop 0
    buffer_load_dwordx4 v12, s[44:47], s36 offen lds
    s_add_u32 m0, s23, 159616
    s_nop 0
    buffer_load_dwordx4 v12, s[48:51], s36 offen lds
    ds_read_b64_tr_b16 v[64:65], v18 offset:0
    ds_read_b64_tr_b16 v[66:67], v18 offset:512
    ds_read_b64_tr_b16 v[68:69], v18 offset:32
    ds_read_b64_tr_b16 v[70:71], v18 offset:544
    ds_read_b64_tr_b16 v[72:73], v18 offset:64
    ds_read_b64_tr_b16 v[74:75], v18 offset:576
    ds_read_b64_tr_b16 v[76:77], v18 offset:96
    ds_read_b64_tr_b16 v[78:79], v18 offset:608
    ds_read_b64_tr_b16 v[80:81], v18 offset:128
    ds_read_b64_tr_b16 v[82:83], v18 offset:640
    ds_read_b64_tr_b16 v[84:85], v18 offset:160
    ds_read_b64_tr_b16 v[86:87], v18 offset:672
    ds_read_b64_tr_b16 v[88:89], v18 offset:192
    ds_read_b64_tr_b16 v[90:91], v18 offset:704
    ds_read_b64_tr_b16 v[92:93], v18 offset:224
    ds_read_b64_tr_b16 v[94:95], v18 offset:736
    s_waitcnt lgkmcnt(0)
    v_mfma_f32_16x16x32_bf16 v[96:99], v[192:195], v[64:67], 0
    v_mfma_f32_16x16x32_bf16 v[100:103], v[196:199], v[64:67], 0
    v_mfma_f32_16x16x32_bf16 v[104:107], v[200:203], v[64:67], 0
    v_mfma_f32_16x16x32_bf16 v[108:111], v[204:207], v[64:67], 0
    v_mfma_f32_16x16x32_bf16 v[96:99], v[208:211], v[68:71], v[96:99]
    v_mfma_f32_16x16x32_bf16 v[100:103], v[212:215], v[68:71], v[100:103]
    v_mfma_f32_16x16x32_bf16 v[104:107], v[216:219], v[68:71], v[104:107]
    v_mfma_f32_16x16x32_bf16 v[108:111], v[220:223], v[68:71], v[108:111]
    v_mfma_f32_16x16x32_bf16 v[96:99], v[224:227], v[72:75], v[96:99]
    v_mfma_f32_16x16x32_bf16 v[100:103], v[228:231], v[72:75], v[100:103]
    v_mfma_f32_16x16x32_bf16 v[104:107], v[232:235], v[72:75], v[104:107]
    v_mfma_f32_16x16x32_bf16 v[108:111], v[236:239], v[72:75], v[108:111]
    s_waitcnt vmcnt(0)
    s_barrier
    ds_read_b64_tr_b16 v[240:241], v3 offset:28672
    ds_read_b64_tr_b16 v[242:243], v3 offset:29184
    ds_read_b64_tr_b16 v[244:245], v3 offset:28704
    ds_read_b64_tr_b16 v[246:247], v3 offset:29216
    ds_read_b64_tr_b16 v[248:249], v3 offset:28736
    ds_read_b64_tr_b16 v[250:251], v3 offset:29248
    ds_read_b64_tr_b16 v[252:253], v3 offset:28768
    ds_read_b64_tr_b16 v[254:255], v3 offset:29280
    ds_read_b64_tr_b16 v[192:193], v3 offset:45568
    ds_read_b64_tr_b16 v[194:195], v3 offset:46080
    ds_read_b64_tr_b16 v[196:197], v3 offset:45600
    ds_read_b64_tr_b16 v[198:199], v3 offset:46112
    ds_read_b64_tr_b16 v[200:201], v3 offset:45632
    ds_read_b64_tr_b16 v[202:203], v3 offset:46144
    ds_read_b64_tr_b16 v[204:205], v3 offset:45664
    ds_read_b64_tr_b16 v[206:207], v3 offset:46176
    s_waitcnt lgkmcnt(8)
    v_mfma_f32_16x16x32_bf16 v[96:99], v[240:243], v[76:79], v[96:99]
    v_mfma_f32_16x16x32_bf16 v[100:103], v[244:247], v[76:79], v[100:103]
    v_mfma_f32_16x16x32_bf16 v[104:107], v[248:251], v[76:79], v[104:107]
    v_mfma_f32_16x16x32_bf16 v[108:111], v[252:255], v[76:79], v[108:111]
    ds_read_b64_tr_b16 v[208:209], v4 offset:11776
    ds_read_b64_tr_b16 v[210:211], v4 offset:12288
    ds_read_b64_tr_b16 v[212:213], v4 offset:11808
    ds_read_b64_tr_b16 v[214:215], v4 offset:12320
    ds_read_b64_tr_b16 v[216:217], v4 offset:11840
    ds_read_b64_tr_b16 v[218:219], v4 offset:12352
    ds_read_b64_tr_b16 v[220:221], v4 offset:11872
    ds_read_b64_tr_b16 v[222:223], v4 offset:12384
    s_waitcnt lgkmcnt(8)
    v_mfma_f32_16x16x32_bf16 v[96:99], v[192:195], v[80:83], v[96:99]
    v_mfma_f32_16x16x32_bf16 v[100:103], v[196:199], v[80:83], v[100:103]
    v_mfma_f32_16x16x32_bf16 v[104:107], v[200:203], v[80:83], v[104:107]
    v_mfma_f32_16x16x32_bf16 v[108:111], v[204:207], v[80:83], v[108:111]
    ds_read_b64_tr_b16 v[224:225], v4 offset:28672
    ds_read_b64_tr_b16 v[226:227], v4 offset:29184
    ds_read_b64_tr_b16 v[228:229], v4 offset:28704
    ds_read_b64_tr_b16 v[230:231], v4 offset:29216
    ds_read_b64_tr_b16 v[232:233], v4 offset:28736
    ds_read_b64_tr_b16 v[234:235], v4 offset:29248
    ds_read_b64_tr_b16 v[236:237], v4 offset:28768
    ds_read_b64_tr_b16 v[238:239], v4 offset:29280
    s_waitcnt lgkmcnt(8)
    v_mfma_f32_16x16x32_bf16 v[96:99], v[208:211], v[84:87], v[96:99]
    v_mfma_f32_16x16x32_bf16 v[100:103], v[212:215], v[84:87], v[100:103]
    v_mfma_f32_16x16x32_bf16 v[104:107], v[216:219], v[84:87], v[104:107]
    v_mfma_f32_16x16x32_bf16 v[108:111], v[220:223], v[84:87], v[108:111]
    ds_read_b64_tr_b16 v[240:241], v4 offset:45568
    ds_read_b64_tr_b16 v[242:243], v4 offset:46080
    ds_read_b64_tr_b16 v[244:245], v4 offset:45600
    ds_read_b64_tr_b16 v[246:247], v4 offset:46112
    ds_read_b64_tr_b16 v[248:249], v4 offset:45632
    ds_read_b64_tr_b16 v[250:251], v4 offset:46144
    ds_read_b64_tr_b16 v[252:253], v4 offset:45664
    ds_read_b64_tr_b16 v[254:255], v4 offset:46176
    s_waitcnt lgkmcnt(8)
    v_mfma_f32_16x16x32_bf16 v[96:99], v[224:227], v[88:91], v[96:99]
    v_mfma_f32_16x16x32_bf16 v[100:103], v[228:231], v[88:91], v[100:103]
    v_mfma_f32_16x16x32_bf16 v[104:107], v[232:235], v[88:91], v[104:107]
    v_mfma_f32_16x16x32_bf16 v[108:111], v[236:239], v[88:91], v[108:111]
    s_waitcnt lgkmcnt(0)
    v_mfma_f32_16x16x32_bf16 v[96:99], v[240:243], v[92:95], v[96:99]
    v_mfma_f32_16x16x32_bf16 v[100:103], v[244:247], v[92:95], v[100:103]
    v_mfma_f32_16x16x32_bf16 v[104:107], v[248:251], v[92:95], v[104:107]
    v_mfma_f32_16x16x32_bf16 v[108:111], v[252:255], v[92:95], v[108:111]
    s_lshl_b32 s36, s12, 12
    s_lshl_b32 s37, s32, 11
    s_add_u32 s36, s36, s37
    s_lshl_b32 s37, s15, 9
    s_add_u32 s36, s36, s37
    s_add_u32 s36, s36, 28327936
    v_lshlrev_b32_e64 v20, 8, v7
    v_lshl_add_u32 v20, v8, 4, v20
    s_mov_b32 exec_lo, 0x00030003
    s_mov_b32 exec_hi, 0x00030003
    buffer_store_dwordx4 v[96:99], v20, s[24:27], s36 offen offset:0 sc1
    buffer_store_dwordx4 v[100:103], v20, s[24:27], s36 offen offset:64 sc1
    buffer_store_dwordx4 v[104:107], v20, s[24:27], s36 offen offset:128 sc1
    buffer_store_dwordx4 v[108:111], v20, s[24:27], s36 offen offset:192 sc1
    s_mov_b64 exec, -1
    s_lshl_b32 s36, s15, 5
    v_add_u32_e64 v2, s36, v5
    v_add_u32 v3, 33792, v2
    v_mov_b32 v24, 0x3f803f80
    v_mov_b32 v25, 0x3f803f80
    v_mov_b32 v26, 0x3f803f80
    v_mov_b32 v27, 0x3f803f80
    s_barrier
    ds_read_b64_tr_b16 v[64:65], v2 offset:11776
    ds_read_b64_tr_b16 v[66:67], v2 offset:12288
KMPG31:
    s_cbranch_execz KMPG39
    ds_read_b64_tr_b16 v[68:69], v2 offset:16000
    ds_read_b64_tr_b16 v[70:71], v2 offset:16512
    ds_read_b64_tr_b16 v[72:73], v2 offset:20224
    ds_read_b64_tr_b16 v[74:75], v2 offset:20736
    ds_read_b64_tr_b16 v[76:77], v2 offset:24448
    ds_read_b64_tr_b16 v[78:79], v2 offset:24960
    ds_read_b64_tr_b16 v[80:81], v2 offset:28672
    ds_read_b64_tr_b16 v[82:83], v2 offset:29184
    ds_read_b64_tr_b16 v[84:85], v2 offset:32896
    ds_read_b64_tr_b16 v[86:87], v2 offset:33408
    ds_read_b64_tr_b16 v[88:89], v2 offset:37120
    ds_read_b64_tr_b16 v[90:91], v2 offset:37632
    s_waitcnt lgkmcnt(12)
    v_mfma_f32_16x16x32_bf16 v[32:35], v[24:27], v[64:67], 0
    v_mfma_f32_16x16x32_bf16 v[36:39], v[64:67], v[64:67], 0
    ds_read_b64_tr_b16 v[92:93], v2 offset:41344
    ds_read_b64_tr_b16 v[94:95], v2 offset:41856
    s_waitcnt lgkmcnt(12)
    v_mfma_f32_16x16x32_bf16 v[40:43], v[24:27], v[68:71], 0
    v_mfma_f32_16x16x32_bf16 v[44:47], v[68:71], v[68:71], 0
    ds_read_b64_tr_b16 v[96:97], v3 offset:11776
    ds_read_b64_tr_b16 v[98:99], v3 offset:12288
    s_waitcnt lgkmcnt(12)
    v_mfma_f32_16x16x32_bf16 v[32:35], v[24:27], v[72:75], v[32:35]
    v_mfma_f32_16x16x32_bf16 v[36:39], v[72:75], v[72:75], v[36:39]
    ds_read_b64_tr_b16 v[100:101], v3 offset:16000
    ds_read_b64_tr_b16 v[102:103], v3 offset:16512
    s_waitcnt lgkmcnt(12)
    v_mfma_f32_16x16x32_bf16 v[40:43], v[24:27], v[76:79], v[40:43]
    v_mfma_f32_16x16x32_bf16 v[44:47], v[76:79], v[76:79], v[44:47]
    ds_read_b64_tr_b16 v[104:105], v3 offset:20224
    ds_read_b64_tr_b16 v[106:107], v3 offset:20736
    s_waitcnt lgkmcnt(12)
    v_mfma_f32_16x16x32_bf16 v[32:35], v[24:27], v[80:83], v[32:35]
    v_mfma_f32_16x16x32_bf16 v[36:39], v[80:83], v[80:83], v[36:39]
    ds_read_b64_tr_b16 v[108:109], v3 offset:24448
    ds_read_b64_tr_b16 v[110:111], v3 offset:24960
    s_waitcnt lgkmcnt(12)
    v_mfma_f32_16x16x32_bf16 v[40:43], v[24:27], v[84:87], v[40:43]
    v_mfma_f32_16x16x32_bf16 v[44:47], v[84:87], v[84:87], v[44:47]
    ds_read_b64_tr_b16 v[112:113], v3 offset:28672
    ds_read_b64_tr_b16 v[114:115], v3 offset:29184
    s_waitcnt lgkmcnt(12)
    v_mfma_f32_16x16x32_bf16 v[32:35], v[24:27], v[88:91], v[32:35]
    v_mfma_f32_16x16x32_bf16 v[36:39], v[88:91], v[88:91], v[36:39]
    ds_read_b64_tr_b16 v[116:117], v3 offset:32896
    ds_read_b64_tr_b16 v[118:119], v3 offset:33408
    s_waitcnt lgkmcnt(12)
    v_mfma_f32_16x16x32_bf16 v[40:43], v[24:27], v[92:95], v[40:43]
    v_mfma_f32_16x16x32_bf16 v[44:47], v[92:95], v[92:95], v[44:47]
    ds_read_b64_tr_b16 v[120:121], v3 offset:37120
    ds_read_b64_tr_b16 v[122:123], v3 offset:37632
    s_waitcnt lgkmcnt(12)
    v_mfma_f32_16x16x32_bf16 v[32:35], v[24:27], v[96:99], v[32:35]
    v_mfma_f32_16x16x32_bf16 v[36:39], v[96:99], v[96:99], v[36:39]
    ds_read_b64_tr_b16 v[124:125], v3 offset:41344
    ds_read_b64_tr_b16 v[126:127], v3 offset:41856
    s_waitcnt lgkmcnt(12)
    v_mfma_f32_16x16x32_bf16 v[40:43], v[24:27], v[100:103], v[40:43]
    v_mfma_f32_16x16x32_bf16 v[44:47], v[100:103], v[100:103], v[44:47]
    s_waitcnt lgkmcnt(10)
    v_mfma_f32_16x16x32_bf16 v[32:35], v[24:27], v[104:107], v[32:35]
    v_mfma_f32_16x16x32_bf16 v[36:39], v[104:107], v[104:107], v[36:39]
    s_waitcnt lgkmcnt(8)
    v_mfma_f32_16x16x32_bf16 v[40:43], v[24:27], v[108:111], v[40:43]
    v_mfma_f32_16x16x32_bf16 v[44:47], v[108:111], v[108:111], v[44:47]
    s_waitcnt lgkmcnt(6)
    v_mfma_f32_16x16x32_bf16 v[32:35], v[24:27], v[112:115], v[32:35]
    v_mfma_f32_16x16x32_bf16 v[36:39], v[112:115], v[112:115], v[36:39]
    s_waitcnt lgkmcnt(4)
    v_mfma_f32_16x16x32_bf16 v[40:43], v[24:27], v[116:119], v[40:43]
    v_mfma_f32_16x16x32_bf16 v[44:47], v[116:119], v[116:119], v[44:47]
    s_waitcnt lgkmcnt(2)
    v_mfma_f32_16x16x32_bf16 v[32:35], v[24:27], v[120:123], v[32:35]
    v_mfma_f32_16x16x32_bf16 v[36:39], v[120:123], v[120:123], v[36:39]
    s_waitcnt lgkmcnt(0)
    v_mfma_f32_16x16x32_bf16 v[40:43], v[24:27], v[124:127], v[40:43]
    v_mfma_f32_16x16x32_bf16 v[44:47], v[124:127], v[124:127], v[44:47]
    v_and_b32 v20, 3, v7
    v_lshrrev_b32 v21, 2, v7
    s_nop 4
    v_add_f32 v32, v32, v40
    v_add_f32 v36, v36, v44
    v_add_f32 v37, v37, v45
    v_add_f32 v38, v38, v46
    v_add_f32 v39, v39, v47
    v_mov_b32 v49, v36
    v_cmp_eq_u32 vcc, 1, v20
    s_nop 1
    v_cndmask_b32 v49, v49, v37, vcc
    v_cmp_eq_u32 vcc, 2, v20
    s_nop 1
    v_cndmask_b32 v49, v49, v38, vcc
    v_cmp_eq_u32 vcc, 3, v20
    s_nop 1
    v_cndmask_b32 v49, v49, v39, vcc
    v_cmp_eq_u32 vcc, v21, v8
    s_nop 1
    v_cndmask_b32 v49, 0, v49, vcc
    v_mov_b32 v22, v49
    s_nop 1
    v_permlane32_swap_b32 v49, v22
    v_add_f32 v49, v49, v22
    v_mov_b32 v22, v49
    s_nop 1
    v_permlane16_swap_b32 v49, v22
    v_add_f32_e64 v49, v49, v22
    v_mul_f32 v48, 0x3b000000, v32
    v_mul_f32 v49, 0x3b000000, v49
    v_fma_f32 v49, -v48, v48, v49
    v_max_f32_e64 v49, 0, v49
    v_cvt_pk_bf16_f32 v49, 0, v49
    v_cvt_pk_bf16_f32 v48, 0, v48
    v_add_f32 v49, 0x3727c5ac, v49
    v_cvt_pk_bf16_f32 v49, 0, v49
    v_sqrt_f32 v49, v49
    s_nop 0
    v_cvt_pk_bf16_f32 v49, 0, v49
    v_rcp_f32 v22, v49
    s_nop 0
    v_fma_f32 v49, -v49, v22, 1.0
    v_fma_f32 v49, v49, v22, v22
    v_mul_f32 v48, -v48, v49
    s_lshl_b32 s36, s13, 10
    s_lshl_b32 s37, s11, 9
    s_add_u32 s36, s36, s37
    s_lshl_b32 s37, s15, 7
    s_add_u32 s36, s36, s37
    s_add_u32 s36, s36, 28311552
    v_lshlrev_b32 v20, 3, v7
    s_mov_b64 exec, 0xffff
    buffer_store_dwordx2 v[48:49], v20, s[24:27], s36 offen sc1
    s_mov_b64 exec, -1
    s_barrier
    s_barrier
    s_mul_i32 s17, s15, 4224
    v_add_u32 v2, s17, v5
    v_add_u32 v3, 50688, v2
    v_add_u32 v4, 101376, v2
    s_lshl_b32 s36, s13, 1
    s_add_u32 s36, s36, s35
    s_lshl_b32 s36, s36, 1
    s_add_u32 s36, s36, 1
    s_mul_i32 s37, s15, 7
    s_mul_i32 s61, s36, 4224
    s_mul_i32 s39, s37, 128
    s_add_u32 s61, s61, s39
    s_add_u32 s61, s61, 27262976
    s_mul_i32 s36, s36, 28
    s_add_u32 s36, s36, s37
    s_lshl_b32 s36, s36, 12
    s_add_u32 s60, s36, 16777216
    v_mul_u32_u24 v15, 128, v1
    s_add_u32 s4, s60, 0
    s_add_u32 s5, s60, 4096
    s_add_u32 s6, s60, 8192
    s_add_u32 s7, s60, 12288
    s_add_u32 s0, s60, 16384
    s_add_u32 s1, s60, 20480
    s_add_u32 s3, s60, 24576
    s_add_u32 s36, s33, 0
    s_and_b32 s36, s36, 3
KMPG32:
    s_cbranch_execz KMPG40
    s_lshl_b32 s36, s36, 10
    v_add_u32 v9, s36, v6
    s_add_u32 s36, s33, 1
    s_and_b32 s36, s36, 3
    s_lshl_b32 s36, s36, 10
    v_add_u32 v10, s36, v6
    s_add_u32 s36, s33, 2
    s_and_b32 s36, s36, 3
    s_lshl_b32 s36, s36, 10
    v_add_u32 v11, s36, v6
    s_add_u32 s36, s33, 3
    s_and_b32 s36, s36, 3
    s_lshl_b32 s36, s36, 10
    v_add_u32 v12, s36, v6
    s_nop 1
KM_CT:
    s_waitcnt lgkmcnt(0)
    s_barrier
    ds_read_b64_tr_b16 v[192:193], v3 offset:28672
    ds_read_b64_tr_b16 v[194:195], v3 offset:29184
    ds_read_b64_tr_b16 v[196:197], v3 offset:28704
    ds_read_b64_tr_b16 v[198:199], v3 offset:29216
    ds_read_b64_tr_b16 v[200:201], v3 offset:28736
    ds_read_b64_tr_b16 v[202:203], v3 offset:29248
    ds_read_b64_tr_b16 v[204:205], v3 offset:28768
    ds_read_b64_tr_b16 v[206:207], v3 offset:29280
    ds_read_b64_tr_b16 v[208:209], v4 offset:45568
    ds_read_b64_tr_b16 v[210:211], v4 offset:46080
    ds_read_b64_tr_b16 v[212:213], v4 offset:45600
    ds_read_b64_tr_b16 v[214:215], v4 offset:46112
    ds_read_b64_tr_b16 v[216:217], v4 offset:45632
    ds_read_b64_tr_b16 v[218:219], v4 offset:46144
    ds_read_b64_tr_b16 v[220:221], v4 offset:45664
    ds_read_b64_tr_b16 v[222:223], v4 offset:46176
    ds_read_b64_tr_b16 v[224:225], v2 offset:45568
    ds_read_b64_tr_b16 v[226:227], v2 offset:46080
    ds_read_b64_tr_b16 v[228:229], v2 offset:45600
    ds_read_b64_tr_b16 v[230:231], v2 offset:46112
    ds_read_b64_tr_b16 v[232:233], v2 offset:45632
    ds_read_b64_tr_b16 v[234:235], v2 offset:46144
    ds_read_b64_tr_b16 v[236:237], v2 offset:45664
    ds_read_b64_tr_b16 v[238:239], v2 offset:46176
    ds_read_b64_tr_b16 v[128:129], v3 offset:45568
    ds_read_b64_tr_b16 v[130:131], v3 offset:46080
    ds_read_b64_tr_b16 v[132:133], v3 offset:45600
    ds_read_b64_tr_b16 v[134:135], v3 offset:46112
    ds_read_b64_tr_b16 v[136:137], v3 offset:45632
    ds_read_b64_tr_b16 v[138:139], v3 offset:46144
    ds_read_b64_tr_b16 v[140:141], v3 offset:45664
    ds_read_b64_tr_b16 v[142:143], v3 offset:46176
    ds_read_b64_tr_b16 v[144:145], v3 offset:11776
    ds_read_b64_tr_b16 v[146:147], v3 offset:12288
    ds_read_b64_tr_b16 v[148:149], v3 offset:11808
    ds_read_b64_tr_b16 v[150:151], v3 offset:12320
    ds_read_b64_tr_b16 v[152:153], v3 offset:11840
    ds_read_b64_tr_b16 v[154:155], v3 offset:12352
    ds_read_b64_tr_b16 v[156:157], v3 offset:11872
    ds_read_b64_tr_b16 v[158:159], v3 offset:12384
    ds_read_b64_tr_b16 v[160:161], v2 offset:11776
    ds_read_b64_tr_b16 v[162:163], v2 offset:12288
    ds_read_b64_tr_b16 v[164:165], v2 offset:11808
    ds_read_b64_tr_b16 v[166:167], v2 offset:12320
    ds_read_b64_tr_b16 v[168:169], v2 offset:11840
    ds_read_b64_tr_b16 v[170:171], v2 offset:12352
    ds_read_b64_tr_b16 v[172:173], v2 offset:11872
    ds_read_b64_tr_b16 v[174:175], v2 offset:12384
    ds_read_b64_tr_b16 v[176:177], v2 offset:28672
    ds_read_b64_tr_b16 v[178:179], v2 offset:29184
    ds_read_b64_tr_b16 v[180:181], v2 offset:28704
    ds_read_b64_tr_b16 v[182:183], v2 offset:29216
    ds_read_b64_tr_b16 v[184:185], v2 offset:28736
    ds_read_b64_tr_b16 v[186:187], v2 offset:29248
    ds_read_b64_tr_b16 v[188:189], v2 offset:28768
    ds_read_b64_tr_b16 v[190:191], v2 offset:29280
    s_mul_i32 s36, s15, 4224
    v_add_u32_e64 v5, s36, v6
    s_waitcnt lgkmcnt(0)
    s_barrier
    s_cmp_lg_u32 s14, 7
    s_cbranch_scc1 KM_CT2
    s_sleep 16
KM_CT2:
    s_sleep 16
    s_mov_b64 exec, 0x7f
    s_mov_b32 s38, 400000
    s_branch KM_P5L
KM_P5:
    v_cmp_ne_u32 vcc, 0, v18
    s_cmp_eq_u64 vcc, 0x7f
    s_nop 3
    s_cbranch_scc1 KM_P5R
    s_sleep 4
KM_P5L:
    buffer_load_dword v18, v15, s[24:27], s61 offen sc1
    s_waitcnt vmcnt(0)
    s_sub_u32 s38, s38, 1
    s_cmp_lg_u32 s38, 0
    s_cbranch_scc1 KM_P5
KM_P5R:
    s_mov_b64 exec, -1
    buffer_load_dwordx4 v[80:83], v9, s[24:27], s4 offen sc1
    buffer_load_dwordx4 v[84:87], v9, s[24:27], s5 offen sc1
    buffer_load_dwordx4 v[88:91], v9, s[24:27], s6 offen sc1
    buffer_load_dwordx4 v[92:95], v9, s[24:27], s7 offen sc1
    buffer_load_dwordx4 v[96:99], v9, s[24:27], s0 offen sc1
    buffer_load_dwordx4 v[100:103], v9, s[24:27], s1 offen sc1
    buffer_load_dwordx4 v[104:107], v9, s[24:27], s3 offen sc1
    buffer_load_dwordx4 v[108:111], v10, s[24:27], s4 offen sc1
    buffer_load_dwordx4 v[112:115], v10, s[24:27], s5 offen sc1
    buffer_load_dwordx4 v[116:119], v10, s[24:27], s6 offen sc1
    buffer_load_dwordx4 v[120:123], v10, s[24:27], s7 offen sc1
    buffer_load_dwordx4 v[124:127], v10, s[24:27], s0 offen sc1
    buffer_load_dwordx4 v[16:19], v10, s[24:27], s1 offen sc1
    buffer_load_dwordx4 v[20:23], v10, s[24:27], s3 offen sc1
    s_setprio 0
    s_waitcnt lgkmcnt(0)
    s_waitcnt vmcnt(13)
    v_mfma_f32_16x16x32_bf16 v[64:67], v[192:195], v[80:83], 0
    buffer_load_dwordx4 v[24:27], v11, s[24:27], s4 offen sc1
    v_mfma_f32_16x16x32_bf16 v[68:71], v[196:199], v[80:83], 0
    v_mfma_f32_16x16x32_bf16 v[72:75], v[200:203], v[80:83], 0
    v_mfma_f32_16x16x32_bf16 v[76:79], v[204:207], v[80:83], 0
    s_waitcnt vmcnt(13)
    v_mfma_f32_16x16x32_bf16 v[64:67], v[208:211], v[84:87], v[64:67]
    buffer_load_dwordx4 v[28:31], v11, s[24:27], s5 offen sc1
    v_mfma_f32_16x16x32_bf16 v[68:71], v[212:215], v[84:87], v[68:71]
    v_mfma_f32_16x16x32_bf16 v[72:75], v[216:219], v[84:87], v[72:75]
    v_mfma_f32_16x16x32_bf16 v[76:79], v[220:223], v[84:87], v[76:79]
    s_waitcnt vmcnt(13)
    v_mfma_f32_16x16x32_bf16 v[64:67], v[224:227], v[88:91], v[64:67]
    buffer_load_dwordx4 v[32:35], v11, s[24:27], s6 offen sc1
    v_mfma_f32_16x16x32_bf16 v[68:71], v[228:231], v[88:91], v[68:71]
    v_mfma_f32_16x16x32_bf16 v[72:75], v[232:235], v[88:91], v[72:75]
    v_mfma_f32_16x16x32_bf16 v[76:79], v[236:239], v[88:91], v[76:79]
    s_waitcnt vmcnt(13)
    v_mfma_f32_16x16x32_bf16 v[64:67], v[128:131], v[92:95], v[64:67]
    buffer_load_dwordx4 v[36:39], v11, s[24:27], s7 offen sc1
    v_mfma_f32_16x16x32_bf16 v[68:71], v[132:135], v[92:95], v[68:71]
    v_mfma_f32_16x16x32_bf16 v[72:75], v[136:139], v[92:95], v[72:75]
    v_mfma_f32_16x16x32_bf16 v[76:79], v[140:143], v[92:95], v[76:79]
    s_waitcnt vmcnt(13)
    v_mfma_f32_16x16x32_bf16 v[64:67], v[144:147], v[96:99], v[64:67]
    buffer_load_dwordx4 v[40:43], v11, s[24:27], s0 offen sc1
    v_mfma_f32_16x16x32_bf16 v[68:71], v[148:151], v[96:99], v[68:71]
    v_mfma_f32_16x16x32_bf16 v[72:75], v[152:155], v[96:99], v[72:75]
    v_mfma_f32_16x16x32_bf16 v[76:79], v[156:159], v[96:99], v[76:79]
    s_waitcnt vmcnt(13)
    v_mfma_f32_16x16x32_bf16 v[64:67], v[160:163], v[100:103], v[64:67]
    buffer_load_dwordx4 v[44:47], v11, s[24:27], s1 offen sc1
    v_mfma_f32_16x16x32_bf16 v[68:71], v[164:167], v[100:103], v[68:71]
    v_mfma_f32_16x16x32_bf16 v[72:75], v[168:171], v[100:103], v[72:75]
    v_mfma_f32_16x16x32_bf16 v[76:79], v[172:175], v[100:103], v[76:79]
    s_waitcnt vmcnt(13)
    v_mfma_f32_16x16x32_bf16 v[64:67], v[176:179], v[104:107], v[64:67]
KMPG33:
    s_cbranch_execz KMPG41
    buffer_load_dwordx4 v[48:51], v11, s[24:27], s3 offen sc1
    v_mfma_f32_16x16x32_bf16 v[68:71], v[180:183], v[104:107], v[68:71]
    v_mfma_f32_16x16x32_bf16 v[72:75], v[184:187], v[104:107], v[72:75]
    v_mfma_f32_16x16x32_bf16 v[76:79], v[188:191], v[104:107], v[76:79]
    s_waitcnt vmcnt(13)
    v_mfma_f32_16x16x32_bf16 v[80:83], v[192:195], v[108:111], 0
    buffer_load_dwordx4 v[52:55], v12, s[24:27], s4 offen sc1
    v_mfma_f32_16x16x32_bf16 v[84:87], v[196:199], v[108:111], 0
    v_mfma_f32_16x16x32_bf16 v[88:91], v[200:203], v[108:111], 0
    v_mfma_f32_16x16x32_bf16 v[92:95], v[204:207], v[108:111], 0
    s_waitcnt vmcnt(13)
    v_mfma_f32_16x16x32_bf16 v[80:83], v[208:211], v[112:115], v[80:83]
    v_add_u32 v4, 45568, v5
    ds_write_b128 v4, v[64:67] offset:0
    buffer_load_dwordx4 v[56:59], v12, s[24:27], s5 offen sc1
    v_mfma_f32_16x16x32_bf16 v[84:87], v[212:215], v[112:115], v[84:87]
    ds_write_b128 v4, v[68:71] offset:1024
    v_mfma_f32_16x16x32_bf16 v[88:91], v[216:219], v[112:115], v[88:91]
    ds_write_b128 v4, v[72:75] offset:2048
    v_mfma_f32_16x16x32_bf16 v[92:95], v[220:223], v[112:115], v[92:95]
    ds_write_b128 v4, v[76:79] offset:3072
    s_waitcnt vmcnt(13)
    v_mfma_f32_16x16x32_bf16 v[80:83], v[224:227], v[116:119], v[80:83]
    buffer_load_dwordx4 v[60:63], v12, s[24:27], s6 offen sc1
    v_mfma_f32_16x16x32_bf16 v[84:87], v[228:231], v[116:119], v[84:87]
    v_mfma_f32_16x16x32_bf16 v[88:91], v[232:235], v[116:119], v[88:91]
    v_mfma_f32_16x16x32_bf16 v[92:95], v[236:239], v[116:119], v[92:95]
    s_waitcnt vmcnt(13)
    v_mfma_f32_16x16x32_bf16 v[80:83], v[128:131], v[120:123], v[80:83]
    buffer_load_dwordx4 v[240:243], v12, s[24:27], s7 offen sc1
    v_mfma_f32_16x16x32_bf16 v[84:87], v[132:135], v[120:123], v[84:87]
    v_mfma_f32_16x16x32_bf16 v[88:91], v[136:139], v[120:123], v[88:91]
    v_mfma_f32_16x16x32_bf16 v[92:95], v[140:143], v[120:123], v[92:95]
    s_waitcnt vmcnt(13)
    v_mfma_f32_16x16x32_bf16 v[80:83], v[144:147], v[124:127], v[80:83]
    buffer_load_dwordx4 v[244:247], v12, s[24:27], s0 offen sc1
    v_mfma_f32_16x16x32_bf16 v[84:87], v[148:151], v[124:127], v[84:87]
    v_mfma_f32_16x16x32_bf16 v[88:91], v[152:155], v[124:127], v[88:91]
    v_mfma_f32_16x16x32_bf16 v[92:95], v[156:159], v[124:127], v[92:95]
    s_waitcnt vmcnt(13)
    v_mfma_f32_16x16x32_bf16 v[80:83], v[160:163], v[16:19], v[80:83]
    buffer_load_dwordx4 v[248:251], v12, s[24:27], s1 offen sc1
    v_mfma_f32_16x16x32_bf16 v[84:87], v[164:167], v[16:19], v[84:87]
    v_mfma_f32_16x16x32_bf16 v[88:91], v[168:171], v[16:19], v[88:91]
    v_mfma_f32_16x16x32_bf16 v[92:95], v[172:175], v[16:19], v[92:95]
    s_waitcnt vmcnt(13)
    v_mfma_f32_16x16x32_bf16 v[80:83], v[176:179], v[20:23], v[80:83]
    buffer_load_dwordx4 v[252:255], v12, s[24:27], s3 offen sc1
    v_mfma_f32_16x16x32_bf16 v[84:87], v[180:183], v[20:23], v[84:87]
    v_mfma_f32_16x16x32_bf16 v[88:91], v[184:187], v[20:23], v[88:91]
    v_mfma_f32_16x16x32_bf16 v[92:95], v[188:191], v[20:23], v[92:95]
    s_waitcnt vmcnt(13)
    v_mfma_f32_16x16x32_bf16 v[96:99], v[192:195], v[24:27], 0
    v_mfma_f32_16x16x32_bf16 v[100:103], v[196:199], v[24:27], 0
    v_mfma_f32_16x16x32_bf16 v[104:107], v[200:203], v[24:27], 0
    v_mfma_f32_16x16x32_bf16 v[108:111], v[204:207], v[24:27], 0
    s_waitcnt vmcnt(12)
    v_mfma_f32_16x16x32_bf16 v[96:99], v[208:211], v[28:31], v[96:99]
    v_add_u32 v4, 96256, v5
    ds_write_b128 v4, v[80:83] offset:0
    v_mfma_f32_16x16x32_bf16 v[100:103], v[212:215], v[28:31], v[100:103]
    ds_write_b128 v4, v[84:87] offset:1024
    v_mfma_f32_16x16x32_bf16 v[104:107], v[216:219], v[28:31], v[104:107]
    ds_write_b128 v4, v[88:91] offset:2048
    v_mfma_f32_16x16x32_bf16 v[108:111], v[220:223], v[28:31], v[108:111]
    ds_write_b128 v4, v[92:95] offset:3072
    s_waitcnt vmcnt(11)
    v_mfma_f32_16x16x32_bf16 v[96:99], v[224:227], v[32:35], v[96:99]
    v_mfma_f32_16x16x32_bf16 v[100:103], v[228:231], v[32:35], v[100:103]
    v_mfma_f32_16x16x32_bf16 v[104:107], v[232:235], v[32:35], v[104:107]
    v_mfma_f32_16x16x32_bf16 v[108:111], v[236:239], v[32:35], v[108:111]
    s_waitcnt vmcnt(10)
    v_mfma_f32_16x16x32_bf16 v[96:99], v[128:131], v[36:39], v[96:99]
    v_mfma_f32_16x16x32_bf16 v[100:103], v[132:135], v[36:39], v[100:103]
    v_mfma_f32_16x16x32_bf16 v[104:107], v[136:139], v[36:39], v[104:107]
    v_mfma_f32_16x16x32_bf16 v[108:111], v[140:143], v[36:39], v[108:111]
    s_waitcnt vmcnt(9)
    v_mfma_f32_16x16x32_bf16 v[96:99], v[144:147], v[40:43], v[96:99]
    v_mfma_f32_16x16x32_bf16 v[100:103], v[148:151], v[40:43], v[100:103]
    v_mfma_f32_16x16x32_bf16 v[104:107], v[152:155], v[40:43], v[104:107]
    v_mfma_f32_16x16x32_bf16 v[108:111], v[156:159], v[40:43], v[108:111]
    s_waitcnt vmcnt(8)
    v_mfma_f32_16x16x32_bf16 v[96:99], v[160:163], v[44:47], v[96:99]
    v_mfma_f32_16x16x32_bf16 v[100:103], v[164:167], v[44:47], v[100:103]
    v_mfma_f32_16x16x32_bf16 v[104:107], v[168:171], v[44:47], v[104:107]
    v_mfma_f32_16x16x32_bf16 v[108:111], v[172:175], v[44:47], v[108:111]
    s_waitcnt vmcnt(7)
    v_mfma_f32_16x16x32_bf16 v[96:99], v[176:179], v[48:51], v[96:99]
    v_mfma_f32_16x16x32_bf16 v[100:103], v[180:183], v[48:51], v[100:103]
    v_mfma_f32_16x16x32_bf16 v[104:107], v[184:187], v[48:51], v[104:107]
    v_mfma_f32_16x16x32_bf16 v[108:111], v[188:191], v[48:51], v[108:111]
    s_waitcnt vmcnt(6)
    v_mfma_f32_16x16x32_bf16 v[112:115], v[192:195], v[52:55], 0
    v_mfma_f32_16x16x32_bf16 v[116:119], v[196:199], v[52:55], 0
    v_mfma_f32_16x16x32_bf16 v[120:123], v[200:203], v[52:55], 0
    v_mfma_f32_16x16x32_bf16 v[124:127], v[204:207], v[52:55], 0
    s_waitcnt vmcnt(5)
    v_mfma_f32_16x16x32_bf16 v[112:115], v[208:211], v[56:59], v[112:115]
    v_add_u32 v4, 62464, v5
    ds_write_b128 v4, v[96:99] offset:0
    v_mfma_f32_16x16x32_bf16 v[116:119], v[212:215], v[56:59], v[116:119]
    ds_write_b128 v4, v[100:103] offset:1024
    v_mfma_f32_16x16x32_bf16 v[120:123], v[216:219], v[56:59], v[120:123]
    ds_write_b128 v4, v[104:107] offset:2048
    v_mfma_f32_16x16x32_bf16 v[124:127], v[220:223], v[56:59], v[124:127]
    ds_write_b128 v4, v[108:111] offset:3072
    s_waitcnt vmcnt(4)
    v_mfma_f32_16x16x32_bf16 v[112:115], v[224:227], v[60:63], v[112:115]
    v_mfma_f32_16x16x32_bf16 v[116:119], v[228:231], v[60:63], v[116:119]
    v_mfma_f32_16x16x32_bf16 v[120:123], v[232:235], v[60:63], v[120:123]
    v_mfma_f32_16x16x32_bf16 v[124:127], v[236:239], v[60:63], v[124:127]
    s_waitcnt vmcnt(3)
    v_mfma_f32_16x16x32_bf16 v[112:115], v[128:131], v[240:243], v[112:115]
    v_mfma_f32_16x16x32_bf16 v[116:119], v[132:135], v[240:243], v[116:119]
    v_mfma_f32_16x16x32_bf16 v[120:123], v[136:139], v[240:243], v[120:123]
    v_mfma_f32_16x16x32_bf16 v[124:127], v[140:143], v[240:243], v[124:127]
    s_waitcnt vmcnt(2)
    v_mfma_f32_16x16x32_bf16 v[112:115], v[144:147], v[244:247], v[112:115]
    v_mfma_f32_16x16x32_bf16 v[116:119], v[148:151], v[244:247], v[116:119]
    v_mfma_f32_16x16x32_bf16 v[120:123], v[152:155], v[244:247], v[120:123]
    v_mfma_f32_16x16x32_bf16 v[124:127], v[156:159], v[244:247], v[124:127]
    s_waitcnt vmcnt(1)
    v_mfma_f32_16x16x32_bf16 v[112:115], v[160:163], v[248:251], v[112:115]
    v_mfma_f32_16x16x32_bf16 v[116:119], v[164:167], v[248:251], v[116:119]
    v_mfma_f32_16x16x32_bf16 v[120:123], v[168:171], v[248:251], v[120:123]
    v_mfma_f32_16x16x32_bf16 v[124:127], v[172:175], v[248:251], v[124:127]
    s_waitcnt vmcnt(0)
    v_mfma_f32_16x16x32_bf16 v[112:115], v[176:179], v[252:255], v[112:115]
    v_mfma_f32_16x16x32_bf16 v[116:119], v[180:183], v[252:255], v[116:119]
    v_mfma_f32_16x16x32_bf16 v[120:123], v[184:187], v[252:255], v[120:123]
    v_mfma_f32_16x16x32_bf16 v[124:127], v[188:191], v[252:255], v[124:127]
    v_add_u32 v4, 11776, v5
    s_nop 3
    ds_write_b128 v4, v[112:115] offset:0
    ds_write_b128 v4, v[116:119] offset:1024
    ds_write_b128 v4, v[120:123] offset:2048
    ds_write_b128 v4, v[124:127] offset:3072
KM_FIN:
    s_lshr_b32 s16, s10, 1
    s_and_b32 s17, s10, 1
KMPG34:
    s_cbranch_execz KMPG42
    v_lshlrev_b32 v14, 4, v8
    s_lshl_b32 s36, s34, 8
    s_lshl_b32 s37, s17, 7
    s_add_u32 s36, s36, s37
    s_add_u32 s36, s36, 25241600
    buffer_load_dwordx4 v[16:19], v14, s[24:27], s36 offen
    buffer_load_dwordx4 v[20:23], v14, s[24:27], s36 offen offset:64
    s_mov_b32 s38, 113152
    s_mov_b32 s39, 45568
    s_cmp_eq_u32 s16, 1
    s_cselect_b32 s38, 130048, s38
    s_cselect_b32 s39, 96256, s39
    s_cmp_eq_u32 s16, 2
    s_cselect_b32 s38, 79360, s38
    s_cselect_b32 s39, 62464, s39
    s_cmp_eq_u32 s16, 3
    s_cselect_b32 s38, 146944, s38
    s_cselect_b32 s39, 11776, s39
    s_lshl_b32 s36, s17, 11
    s_add_u32 s38, s38, s36
    s_add_u32 s39, s39, s36
    v_add_u32 v2, s38, v6
    v_add_u32_e64 v3, s39, v6
    s_add_u32 s16, s16, s33
    s_and_b32 s16, s16, 3
    v_bfe_u32 v4, v1, 2, 2
    v_lshl_add_u32 v4, v8, 2, v4
    v_lshlrev_b32 v4, 7, v4
    v_and_b32 v5, 3, v1
    v_lshl_add_u32 v4, v5, 3, v4
    s_lshl_b32 s36, s17, 12
    s_lshl_b32 s37, s16, 5
    s_add_u32 s36, s36, s37
    v_add_u32 v4, s36, v4
    ds_read_b64_tr_b16 v[24:25], v4 offset:0
    ds_read_b64_tr_b16 v[26:27], v4 offset:2048
    v_and_b32 v5, 1, v8
    v_lshlrev_b32 v5, 5, v5
    v_lshl_add_u32 v5, v7, 10, v5
    v_lshrrev_b32_e64 v9, 1, v8
    v_lshl_add_u32 v5, v9, 4, v5
    s_lshl_b32 s36, s13, 3
    s_lshl_b32 s37, s35, 2
    s_add_u32 s36, s36, s37
    s_add_u32 s36, s36, s16
    s_lshl_b32 s36, s36, 14
    s_lshl_b32 s37, s34, 7
    s_add_u32 s36, s36, s37
    s_lshl_b32 s37, s17, 6
    s_add_u32 s21, s36, s37
    s_waitcnt lgkmcnt(0)
    s_barrier
    ds_read_b128 v[64:67], v2 offset:0
    ds_read_b128 v[68:71], v2 offset:1024
    ds_read_b128 v[72:75], v2 offset:4224
    ds_read_b128 v[76:79], v2 offset:5248
    ds_read_b128 v[80:83], v2 offset:8448
    ds_read_b128 v[84:87], v2 offset:9472
    ds_read_b128 v[88:91], v2 offset:12672
    ds_read_b128 v[92:95], v2 offset:13696
    ds_read_b128 v[96:99], v3 offset:0
    ds_read_b128 v[100:103], v3 offset:1024
    ds_read_b128 v[104:107], v3 offset:4224
    ds_read_b128 v[108:111], v3 offset:5248
    ds_read_b128 v[112:115], v3 offset:8448
    ds_read_b128 v[116:119], v3 offset:9472
    ds_read_b128 v[120:123], v3 offset:12672
    ds_read_b128 v[124:127], v3 offset:13696
    v_lshlrev_b32 v32, 16, v24
    v_and_b32 v33, 0xffff0000, v24
    v_lshlrev_b32_e64 v34, 16, v25
    v_and_b32 v35, 0xffff0000, v25
    v_lshlrev_b32_e64 v36, 16, v26
    v_and_b32 v37, 0xffff0000, v26
    v_lshlrev_b32_e64 v38, 16, v27
    v_and_b32 v39, 0xffff0000, v27
    s_waitcnt lgkmcnt(12)
    s_nop 0
    v_pk_add_f32 v[64:65], v[64:65], v[72:73]
    v_pk_add_f32 v[66:67], v[66:67], v[74:75]
    v_pk_add_f32 v[68:69], v[68:69], v[76:77]
    v_pk_add_f32 v[70:71], v[70:71], v[78:79]
    s_waitcnt lgkmcnt(10)
    s_nop 0
    v_pk_add_f32 v[64:65], v[64:65], v[80:81]
    v_pk_add_f32 v[66:67], v[66:67], v[82:83]
    v_pk_add_f32 v[68:69], v[68:69], v[84:85]
    v_pk_add_f32 v[70:71], v[70:71], v[86:87]
    s_waitcnt lgkmcnt(8)
    s_nop 0
    v_pk_add_f32 v[64:65], v[64:65], v[88:89]
    v_pk_add_f32 v[66:67], v[66:67], v[90:91]
    v_pk_add_f32 v[68:69], v[68:69], v[92:93]
    v_pk_add_f32 v[70:71], v[70:71], v[94:95]
    s_waitcnt lgkmcnt(6)
    s_nop 0
    v_pk_add_f32 v[64:65], v[64:65], v[96:97]
    v_pk_add_f32 v[66:67], v[66:67], v[98:99]
    v_pk_add_f32 v[68:69], v[68:69], v[100:101]
    v_pk_add_f32 v[70:71], v[70:71], v[102:103]
    s_waitcnt lgkmcnt(4)
    s_nop 0
    v_pk_add_f32 v[64:65], v[64:65], v[104:105]
    v_pk_add_f32 v[66:67], v[66:67], v[106:107]
    v_pk_add_f32 v[68:69], v[68:69], v[108:109]
    v_pk_add_f32 v[70:71], v[70:71], v[110:111]
    s_waitcnt lgkmcnt(2)
    s_nop 0
    v_pk_add_f32 v[64:65], v[64:65], v[112:113]
    v_pk_add_f32 v[66:67], v[66:67], v[114:115]
    v_pk_add_f32 v[68:69], v[68:69], v[116:117]
    v_pk_add_f32 v[70:71], v[70:71], v[118:119]
    s_waitcnt lgkmcnt(0)
    s_nop 0
    v_pk_add_f32 v[64:65], v[64:65], v[120:121]
    v_pk_add_f32 v[66:67], v[66:67], v[122:123]
    v_pk_add_f32 v[68:69], v[68:69], v[124:125]
    v_pk_add_f32 v[70:71], v[70:71], v[126:127]
    s_waitcnt vmcnt(0)
    s_nop 0
    v_cvt_pk_bf16_f32 v64, 0, v64
    v_cvt_pk_bf16_f32 v65, 0, v65
    v_cvt_pk_bf16_f32 v66, 0, v66
    v_cvt_pk_bf16_f32 v67, 0, v67
    v_cvt_pk_bf16_f32 v68, 0, v68
    v_cvt_pk_bf16_f32 v69, 0, v69
    v_cvt_pk_bf16_f32 v70, 0, v70
    v_cvt_pk_bf16_f32 v71, 0, v71
    v_pk_mul_f32 v[64:65], v[64:65], v[16:17]
    v_pk_mul_f32 v[66:67], v[66:67], v[18:19]
    v_pk_mul_f32 v[68:69], v[68:69], v[20:21]
    v_pk_mul_f32 v[70:71], v[70:71], v[22:23]
    v_cvt_pk_bf16_f32 v64, 0, v64
    v_cvt_pk_bf16_f32 v65, 0, v65
    v_cvt_pk_bf16_f32 v66, 0, v66
    v_cvt_pk_bf16_f32 v67, 0, v67
    v_cvt_pk_bf16_f32 v68, 0, v68
    v_cvt_pk_bf16_f32 v69, 0, v69
    v_cvt_pk_bf16_f32 v70, 0, v70
    v_cvt_pk_bf16_f32 v71, 0, v71
    v_pk_add_f32 v[64:65], v[64:65], v[32:33]
    v_pk_add_f32 v[66:67], v[66:67], v[34:35]
    v_pk_add_f32 v[68:69], v[68:69], v[36:37]
    v_pk_add_f32 v[70:71], v[70:71], v[38:39]
    v_cvt_pk_bf16_f32 v40, v64, v65
    v_cvt_pk_bf16_f32 v41, v66, v67
    v_cvt_pk_bf16_f32 v42, v68, v69
    v_cvt_pk_bf16_f32 v43, v70, v71
    s_nop 0
    v_permlane16_swap_b32 v40, v42
    v_permlane16_swap_b32 v41, v43
    buffer_store_dwordx4 v[40:43], v5, s[28:31], s21 offen
    s_nop 1
KM_END:
    s_endpgm
.text
KMPG35:
KMPG36:
KMPG37:
KMPG38:
KMPG39:
KMPG40:
KMPG41:
KMPG42:
KMPG43:
KMPG44:
KMPG45:
KMPG46:
KMPG47:
KMPG48:
KMPG49:
KMPG50:
KMRET:
    s_setpc_b64 s[68:69]
.section .rodata,"a"
.p2align 6
.amdhsa_kernel k1_main_kernel
  .amdhsa_next_free_vgpr 256
  .amdhsa_next_free_sgpr 72
  .amdhsa_accum_offset 256
  .amdhsa_group_segment_fixed_size 0
  .amdhsa_kernarg_size 120
  .amdhsa_user_sgpr_count 2
  .amdhsa_user_sgpr_kernarg_segment_ptr 1
  .amdhsa_system_sgpr_workgroup_id_x 1
  .amdhsa_float_denorm_mode_32 3
.end_amdhsa_kernel
```
